```python
import torch

def _softmax(x, axis=-1):
    return torch.softmax(x, dim=axis)
def _gelu(x):
    return torch.nn.functional.gelu(x, approximate="tanh")
def _silu(x):
    return torch.nn.functional.silu(x)
def _sigmoid(x):
    return torch.sigmoid(x)
def _layernorm(x, axis=-1, eps=1e-5):
    m = x.mean(dim=axis, keepdim=True)
    v = x.var(dim=axis, keepdim=True, unbiased=False)
    return (x - m) / torch.sqrt(v + eps)
def _scatter_add(tgt, idx, src, axis=0):
    return tgt.clone().index_add_(axis, idx, src)
def _segment_sum(src, seg, n):
    out = torch.zeros((n,) + src.shape[1:], dtype=src.dtype)
    return out.index_add_(0, seg, src)
def _pad(x, pw):
    flat = tuple(v for pair in reversed(pw) for v in pair)
    return torch.nn.functional.pad(x, flat)

kernel_name = 'gated_mix__grouped_kv_mqa__geglu_ffn__prompt'

def setup_inputs():

    _w = (lambda a: (lambda t: t.to(torch.bfloat16) if t.is_floating_point() else t)(torch.as_tensor(a)))
    def _A_setup():
        B, S, D, H = 1, 2048, 512, 32
        Dh = D // H
        return {
            "x": _w((lambda *s: torch.randn(*s, dtype=torch.bfloat16) * 0.05)(B, S, D)),
            "wq": _w((lambda *s: torch.randn(*s, dtype=torch.bfloat16) * 0.8)(D, H * Dh)),
            "wk": _w((lambda *s: torch.randn(*s, dtype=torch.bfloat16) * 0.8)(D, Dh)),
            "wv": _w((lambda *s: torch.randn(*s, dtype=torch.bfloat16) * 0.05)(D, Dh)),
            "wo": _w((lambda *s: torch.randn(*s, dtype=torch.bfloat16) * 0.05)(H * Dh, D)),
        }
    _A_in = _A_setup()

    def _B_setup():
        B, S, D, F = 1, 2048, 512, 1792
        return {
            "x": _w((lambda *s: torch.randn(*s, dtype=torch.bfloat16) * 0.05)(B, S, D)),
            "w_gate": _w((lambda *s: torch.randn(*s, dtype=torch.bfloat16) * 0.05)(D, F)),
            "w_up": _w((lambda *s: torch.randn(*s, dtype=torch.bfloat16) * 0.05)(D, F)),
            "w_down": _w((lambda *s: torch.randn(*s, dtype=torch.bfloat16) * 0.05)(F, D)),
        }
    _B_in = _B_setup()

    return {
        "A_x": _A_in["x"],
        "A_wq": _A_in["wq"],
        "A_wk": _A_in["wk"],
        "A_wv": _A_in["wv"],
        "A_wo": _A_in["wo"],
        "B_x": _B_in["x"],
        "B_w_gate": _B_in["w_gate"],
        "B_w_up": _B_in["w_up"],
        "B_w_down": _B_in["w_down"],
        "gate_w": _w((lambda *s: torch.randn(*s, dtype=torch.bfloat16) * 0.05)(512) * 16.0),
    }

def reference(A_x, A_wq, A_wk, A_wv, A_wo, B_x, B_w_gate, B_w_up, B_w_down, gate_w):
    def _A_ref(x, wq, wk, wv, wo):
        B, S, D = x.shape
        H = 32
        Dh = D // H
        q = (lambda x, *d: x.permute(*d))((x @ wq).reshape(B, S, H, Dh), 0, 2, 1, 3)
        k = x @ wk
        v = x @ wv
        scores = torch.einsum("bhqd,bkd->bhqk", q, k) * (Dh ** -0.5)
        p = _softmax(scores, axis=-1)
        o = torch.einsum("bhqk,bkd->bhqd", p, v)
        return (lambda x, *d: x.permute(*d))(o, 0, 2, 1, 3).reshape(B, S, H * Dh) @ wo

    def _B_ref(x, w_gate, w_up, w_down):
        return (_gelu(x @ w_gate) * (x @ w_up)) @ w_down

    x = A_x
    g = _sigmoid((x * gate_w).sum(-1, keepdims=True))
    a = _A_ref(x, A_wq, A_wk, A_wv, A_wo)
    b = _B_ref(x, B_w_gate, B_w_up, B_w_down)
    return g * a + (1 - g) * b
```

```asm
; @launch grid=(256,1,1) block=(512,1,1) lds=163840
.amdgcn_target "amdgcn-amd-amdhsa--gfx950"
.text
.globl gated_mix__grouped_kv_mqa__geglu_ffn__prompt_kernel
.p2align 8
.type gated_mix__grouped_kv_mqa__geglu_ffn__prompt_kernel,@function
gated_mix__grouped_kv_mqa__geglu_ffn__prompt_kernel:
    s_cmp_ge_u32 s2, 256
    s_cbranch_scc1 L_end
    s_load_dwordx16 s[4:19], s[0:1], 0
    s_load_dwordx8 s[20:27], s[0:1], 64
    s_load_dwordx2 s[28:29], s[0:1], 96
    s_getpc_b64 s[88:89]
L_pc:
    s_andn2_b32 s87, s2, 7
    s_lshl_b32 s87, s87, 8
    v_lshl_add_u32 v22, v0, 2, s87
    v_mov_b32 v23, 0
    v_min_u32 v22, L_last-L_pc-4, v22
    s_mov_b32 exec_lo, 1
    s_mov_b32 exec_hi, 1
    v_lshl_add_u64 v[22:23], v[22:23], 0, s[88:89]
    global_load_dword v28, v[22:23], off
    s_mov_b64 exec, -1
    v_readfirstlane_b32 s68, v0
    v_lshrrev_b32 v21, 4, v0
    v_lshrrev_b32 v20, 3, v0
    v_xor_b32 v21, v0, v21
    s_lshr_b32 s71, s2, 6
    s_bfe_u32 s78, s2, 0x30003
    v_and_b32 v21, 7, v21
    s_and_b32 s82, s2, 1
    s_lshl3_add_u32 s69, s82, s78
    v_lshlrev_b32 v21, 4, v21
    s_add_u32 s79, s71, s78
    s_and_b32 s79, s79, 1
    s_lshl_b32 s79, s79, 2
    s_bfe_u32 s70, s2, 0x20001
    s_mul_i32 s81, s70, 1
    s_add_u32 s79, s79, s81
    s_mul_i32 s81, s82, 2
    s_add_u32 s79, s79, s81
    s_add_u32 s79, s79, 1
    s_and_b32 s79, s79, 7
    v_lshl_add_u32 v1, v20, 10, v21
    s_lshl_b32 s80, s69, 17
    s_lshl_b32 s73, s79, 7
    s_add_u32 s73, s73, s80
    s_lshl_b32 s76, s68, 4
    s_mov_b32 m0, s76
    s_mov_b32 s34, 2097152
    s_mov_b32 s35, 0x20000
    s_bfe_u32 s81, s68, 0x10006
    s_lshl_b32 s81, s81, 2
    v_and_or_b32 v21, v20, 2, s81
    s_bfe_u32 s70, s2, 0x20001
    v_xor_b32 v21, v0, v21
    s_mov_b32 s84, 0x65306540
    s_mov_b32 s85, 0x54306430
    s_lshl2_add_u32 s81, s70, s71
    s_lshl_b32 s81, s81, 2
    s_lshr_b64 s[84:85], s[84:85], s81
    s_and_b32 s84, s84, 7
    s_mul_i32 s81, s70, 7
    s_add_u32 s81, s81, s84
    v_and_b32 v21, 7, v21
    s_lshl_b32 s82, s70, 1
    s_movk_i32 s83, 3584
    v_lshlrev_b32 v27, 4, v21
    s_mov_b32 s39, 0x20000
    s_mov_b32 s43, 0x20000
    s_cmp_eq_u32 s71, 0
    s_cselect_b32 s81, s82, s81
    s_cselect_b32 s83, 1024, s83
    s_cselect_b32 s82, 128, 0
    v_mad_u32_u24 v3, v20, s83, v27
    s_lshl_b32 s38, s83, 9
    s_mov_b32 s42, s38
    s_mul_i32 s74, s79, s83
    s_lshl1_add_u32 s74, s81, s74
    s_lshl_b32 s74, s74, 6
    s_cmp_eq_u32 s71, 0
    s_waitcnt lgkmcnt(0)
    s_mov_b64 s[32:33], s[4:5]
    s_cselect_b64 s[36:37], s[6:7], s[16:17]
    s_cselect_b64 s[40:41], s[6:7], s[18:19]
    buffer_load_dwordx4 v1, s[32:35], s73 offen lds
    s_add_u32 m0, s76, 65536
    s_add_u32 s73, s73, 65536
    buffer_load_dwordx4 v3, s[36:39], s74 offen lds
    s_add_u32 m0, s76, 73728
    s_add_u32 s74, s74, s82
    buffer_load_dwordx4 v3, s[40:43], s74 offen lds
    s_add_u32 m0, s76, 8192
    s_nop 0
    buffer_load_dwordx4 v1, s[32:35], s73 offen lds
    s_lshr_b32 s84, s68, 7
    s_lshr_b32 s85, s78, 1
    s_cmp_lg_u32 s84, s85
    s_cbranch_scc1 L_nowt
    s_add_u32 s84, s79, 1
    s_and_b32 s84, s84, 7
    s_mul_i32 s84, s84, s83
    s_lshl1_add_u32 s84, s81, s84
    s_lshl_b32 s84, s84, 6
    buffer_load_dword v32, v3, s[36:39], s84 offen
    s_add_u32 s84, s84, s82
    buffer_load_dword v33, v3, s[40:43], s84 offen
L_nowt:
    s_lshr_b32 s68, s68, 6
    v_add_u32 v1, s80, v1
    v_add_u32 v2, 0x10000, v1
    s_sub_u32 s73, s73, s80
    s_mov_b32 s0, s81
    s_lshl_b32 s81, s81, 7
    s_sub_u32 s74, s74, s81
    v_add_u32 v3, s81, v3
    s_movk_i32 s83, 3584
    v_mad_u32_u24 v27, v20, s83, v27
    s_mov_b32 s84, 0x4123012
    s_mov_b32 s85, 0x26011502
    s_lshl2_add_u32 s3, s70, s71
    s_lshl_b32 s3, s3, 2
    s_lshr_b64 s[84:85], s[84:85], s3
    s_and_b32 s84, s84, 7
    s_mul_i32 s3, s70, 7
    s_add_u32 s3, s3, s84
    s_lshl_b32 s81, s3, 7
    v_add_u32 v27, s81, v27
    v_and_b32 v15, 63, v0
    v_lshlrev_b32 v14, 4, v15
    s_and_b32 s80, s2, 7
    s_lshl2_add_u32 s77, s80, s71
    s_add_u32 s72, s79, 1
    s_and_b32 s72, s72, 7
    s_lshl_b32 s75, s68, 11
    s_mov_b32 s52, s28
    s_mov_b32 s53, s29
    s_mov_b32 s54, 16777216
    s_mov_b32 s55, 0x20000
    s_mov_b32 s56, s26
    s_mov_b32 s57, s27
    s_mov_b32 s58, 256
    s_mov_b32 s59, 0x20000
    s_mov_b32 s60, s20
    s_mov_b32 s61, s21
    s_mov_b32 s62, 1835008
    s_mov_b32 s63, 0x20000
    s_mov_b32 s64, s12
    s_mov_b32 s65, s13
    s_mov_b32 s66, 524288
    s_mov_b32 s67, 0x20000
    s_mov_b32 s92, s24
    s_mov_b32 s93, s25
    s_mov_b32 s94, 2097152
    s_mov_b32 s95, 0x20000
    s_and_b32 s80, s68, 3
    s_lshr_b32 s81, s68, 2
    s_xor_b32 s85, s81, s70
    s_and_b32 s85, s85, 1
    s_lshl1_add_u32 s80, s80, s85
    s_lshl_b32 s80, s80, 11
    v_and_b32 v20, 15, v15
    v_bfe_u32 v21, v15, 1, 3
    v_lshrrev_b32 v22, 4, v15
    v_xor_b32 v21, v21, v22
    v_lshlrev_b32 v21, 4, v21
    v_lshl_add_u32 v21, v20, 7, v21
    v_add_u32 v5, s80, v21
    v_xor_b32 v6, 0x800, v5
    v_xor_b32 v7, 64, v5
    v_xor_b32 v8, 64, v6
    s_lshl_b32 s82, s85, 8
    v_xor_b32 v4, s82, v14
    v_lshrrev_b32 v23, 5, v15
    v_lshrrev_b32 v20, 1, v15
    v_lshlrev_b32 v29, 4, v20
    v_bfe_u32 v20, v15, 2, 2
    v_lshl_add_u32 v21, v22, 3, v20
    v_lshlrev_b32 v21, 7, v21
    v_bfe_u32 v22, v15, 3, 2
    s_lshl_b32 s81, s81, 1
    v_xor_b32 v22, s81, v22
    v_lshl_add_u32 v21, v22, 5, v21
    v_and_b32 v22, 3, v15
    v_lshl_add_u32 v21, v22, 3, v21
    v_add_u32 v9, 65536, v21
    v_xor_b32 v10, 32, v9
    v_lshl_add_u32 v23, v23, 3, v20
    v_lshlrev_b32 v23, 7, v23
    v_lshrrev_b32 v20, 1, v20
    v_lshl_add_u32 v23, v20, 6, v23
    v_lshl_add_u32 v23, v22, 3, v23
    v_bfe_u32 v22, v15, 4, 1
    v_lshl_add_u32 v31, v22, 5, v23
    v_lshlrev_b32 v22, 2, v22
    v_and_b32 v21, 7, v15
    v_xor_b32 v21, v21, v22
    v_lshlrev_b32 v21, 4, v21
    v_lshrrev_b32 v20, 3, v15
    v_lshl_add_u32 v20, v20, 10, v21
    s_lshl_b32 s80, s78, 7
    v_add_u32 v0, s80, v20
    v_mov_b32 v17, 0
    v_mov_b32 v16, 0xc0135761
    s_mov_b32 s96, 0xbdd2d3e8
    s_lshr_b32 s83, s68, 2
    s_and_b32 s81, s68, 3
    s_lshl2_add_u32 s80, s69, s81
    s_lshl_b32 s88, s80, 5
    s_and_b32 s82, s80, 15
    s_lshr_b32 s80, s80, 4
    s_mul_i32 s80, s80, 112
    s_lshl1_add_u32 s80, s83, s80
    s_lshl4_add_u32 s80, s80, s82
    s_lshl_b32 s80, s80, 10
    s_add_u32 s80, s80, 5242880
    s_lshl_b32 s3, s3, 16
    s_add_u32 s3, s3, s80
    s_lshl_b32 s0, s0, 16
    s_add_u32 s0, s0, s80
    s_lshl3_add_u32 s84, s70, s88
    s_lshl1_add_u32 s84, s83, s84
    s_lshl_b32 s84, s84, 10
    s_lshl2_add_u32 s98, s69, s70
    s_lshl_b32 s98, s98, 5
    s_add_u32 s98, s98, s71
    s_lshl_b32 s98, s98, 2
    s_add_u32 s98, s98, 204800
    s_lshl1_add_u32 s81, s77, s83
    s_lshl3_add_u32 s82, s81, s78
    s_and_b32 s81, s68, 3
    s_lshl2_add_u32 s82, s82, s81
    s_lshl_b32 s101, s82, 10
    s_lshl_b32 s100, s68, 13
    s_add_u32 s100, s100, 98304
    s_lshl1_add_u32 s99, s78, s71
    s_and_b32 s99, s99, 3
    s_mul_i32 s99, s99, 7
    s_lshr_b32 s99, s99, 1
    s_and_b32 s81, s2, 3
    s_add_u32 s99, s99, s81
    s_cmp_ge_u32 s99, 14
    s_cselect_b32 s81, 14, 0
    s_sub_u32 s99, s99, s81
    s_lshl_b32 s99, s99, 14
    s_mul_i32 s81, s68, 229376
    s_add_u32 s60, s60, s81
    s_addc_u32 s61, s61, 0
    s_sub_u32 s62, s62, s81
    s_lshl_b32 s81, s68, 16
    s_add_u32 s64, s64, s81
    s_addc_u32 s65, s65, 0
    s_sub_u32 s66, s66, s81
    s_lshr_b32 s81, s68, 2
    s_lshl1_add_u32 s80, s71, s81
    s_lshr_b32 s81, s70, 1
    s_lshl1_add_u32 s80, s80, s81
    s_cmp_eq_u32 s80, 0
    s_cbranch_scc1 L_pathK
    s_cmp_eq_u32 s80, 1
    s_cbranch_scc1 L_pathV
    s_cmp_lt_u32 s80, 4
    s_cbranch_scc1 L_pathP
    s_cmp_eq_u32 s80, 4
    s_cbranch_scc1 L_pathS
    s_add_u32 s80, s76, s2
    s_cmp_eq_u32 s80, 1152
    s_cbranch_scc1 L_pathC
    s_branch L_pathG
.p2align 12
.fill 144, 4, 0xbf800000
L_pathG:
    s_cmp_eq_u32 s71, 2
    s_cselect_b64 s[48:49], s[60:61], s[64:65]
    s_cselect_b32 s50, s62, s66
    s_cselect_b32 s80, 28, 8
    s_mov_b32 s51, 0x20000
    s_cmp_eq_u32 s71, 1
    s_cselect_b32 s50, 0, s50
    s_and_b32 s81, s2, 63
    s_mul_i32 s81, s81, s80
    s_sub_u32 s80, s80, 1
    v_min_u32 v11, s80, v15
    v_add_lshl_u32 v11, v11, s81, 7
    s_add_u32 m0, s76, 16384
    s_lshl_b32 s73, s72, 7
    buffer_load_dwordx4 v1, s[32:35], s73 offen lds
    s_add_u32 m0, s76, 81920
    s_mul_i32 s74, s72, 229376
    buffer_load_dwordx4 v3, s[36:39], s74 offen lds
    s_add_u32 m0, s76, 90112
    s_add_u32 s72, s72, 1
    buffer_load_dwordx4 v3, s[40:43], s74 offen lds
    s_add_u32 m0, s76, 24576
    s_and_b32 s72, s72, 7
    buffer_load_dwordx4 v2, s[32:35], s73 offen lds
    s_lshr_b32 s80, s68, 2
    s_lshl_b32 s81, s80, 16
    v_add_u32 v26, s81, v14
    s_and_b32 s81, s68, 1
    s_mul_i32 s81, s81, 49152
    v_add_u32 v24, s81, v14
    v_add_u32 v25, s81, v29
    s_mul_i32 s81, s80, 49152
    s_and_b32 s86, s68, 3
    s_lshl_b32 s87, s86, 11
    s_add_u32 s83, s87, s81
    s_lshl_b32 s87, s2, 2
    s_add_u32 s86, s86, s87
    s_and_b32 s86, s86, 31
    s_lshl_b32 s85, s86, 11
    s_add_u32 s1, s101, 3145728
    s_xor_b32 s1, s1, 1024
    s_lshl1_add_u32 s79, s77, s80
    s_lshl_b32 s79, s79, 7
    s_add_u32 s79, s79, 131072
    s_lshr_b32 s86, s77, 3
    s_lshl3_add_u32 s86, s86, s68
    s_mul_i32 s86, s86, 224
    s_and_b32 s87, s77, 7
    s_lshl1_add_u32 s87, s87, s80
    s_add_u32 s86, s86, s87
    s_lshl_b32 s86, s86, 10
    s_add_u32 s89, s86, 5242880
    s_lshr_b32 s97, s77, 1
    s_lshl_b32 s97, s97, 9
    s_add_u32 s97, s97, 204800
    s_lshl_b32 s81, s68, 24
    s_add_u32 s98, s98, s81
    s_mul_i32 s86, s68, 2304
    s_add_u32 s86, s86, 65536
    s_xor_b32 s87, s68, 1
    s_mul_i32 s87, s87, 2304
    s_add_u32 s87, s87, 65536
    s_waitcnt vmcnt(4)
    s_setprio 3
    s_barrier
    s_add_u32 m0, s76, 32768
    s_lshl_b32 s73, s72, 7
    buffer_load_dwordx4 v1, s[32:35], s73 offen lds
    ds_read_b128 v[128:131], v5 offset:0
    ds_read_b128 v[132:135], v6 offset:0
    ds_read_b64_tr_b16 v[32:33], v9 offset:0
    ds_read_b64_tr_b16 v[34:35], v9 offset:512
    ds_read_b64_tr_b16 v[36:37], v9 offset:8192
    ds_read_b64_tr_b16 v[38:39], v9 offset:8704
    ds_read_b64_tr_b16 v[40:41], v10 offset:0
    ds_read_b64_tr_b16 v[42:43], v10 offset:512
    ds_read_b64_tr_b16 v[44:45], v10 offset:8192
    ds_read_b64_tr_b16 v[46:47], v10 offset:8704
    s_add_u32 m0, s76, 98304
    s_mul_i32 s74, s72, 229376
    buffer_load_dwordx4 v3, s[36:39], s74 offen lds
    s_add_u32 m0, s76, 106496
    s_add_u32 s72, s72, 1
    buffer_load_dwordx4 v3, s[40:43], s74 offen lds
    s_add_u32 m0, s76, 40960
    s_and_b32 s72, s72, 7
    buffer_load_dwordx4 v2, s[32:35], s73 offen lds
    s_waitcnt lgkmcnt(0)
    v_mfma_f32_16x16x32_bf16 v[64:67], v[32:35], v[128:131], 0
    ds_read_b128 v[136:139], v7 offset:0
    ds_read_b128 v[140:143], v8 offset:0
    v_mfma_f32_16x16x32_bf16 v[68:71], v[32:35], v[132:135], 0
    ds_read_b64_tr_b16 v[48:49], v9 offset:4096
    v_mfma_f32_16x16x32_bf16 v[72:75], v[36:39], v[128:131], 0
    ds_read_b64_tr_b16 v[50:51], v9 offset:4608
    ds_read_b64_tr_b16 v[52:53], v9 offset:12288
    v_mfma_f32_16x16x32_bf16 v[76:79], v[36:39], v[132:135], 0
    ds_read_b64_tr_b16 v[54:55], v9 offset:12800
    v_mfma_f32_16x16x32_bf16 v[80:83], v[40:43], v[128:131], 0
    ds_read_b64_tr_b16 v[56:57], v10 offset:4096
    ds_read_b64_tr_b16 v[58:59], v10 offset:4608
    v_mfma_f32_16x16x32_bf16 v[84:87], v[40:43], v[132:135], 0
    ds_read_b64_tr_b16 v[60:61], v10 offset:12288
    v_mfma_f32_16x16x32_bf16 v[88:91], v[44:47], v[128:131], 0
    ds_read_b64_tr_b16 v[62:63], v10 offset:12800
    v_mfma_f32_16x16x32_bf16 v[92:95], v[44:47], v[132:135], 0
    s_waitcnt vmcnt(4)
    s_setprio 3
    s_barrier
    s_add_u32 m0, s76, 49152
    s_lshl_b32 s73, s72, 7
    buffer_load_dwordx4 v1, s[32:35], s73 offen lds
    s_waitcnt lgkmcnt(0)
    v_mfma_f32_16x16x32_bf16 v[64:67], v[48:51], v[136:139], v[64:67]
    ds_read_b128 v[144:147], v5 offset:16384
    ds_read_b128 v[148:151], v6 offset:16384
    v_mfma_f32_16x16x32_bf16 v[68:71], v[48:51], v[140:143], v[68:71]
    ds_read_b64_tr_b16 v[32:33], v9 offset:16384
    v_mfma_f32_16x16x32_bf16 v[72:75], v[52:55], v[136:139], v[72:75]
    ds_read_b64_tr_b16 v[34:35], v9 offset:16896
    ds_read_b64_tr_b16 v[36:37], v9 offset:24576
    v_mfma_f32_16x16x32_bf16 v[76:79], v[52:55], v[140:143], v[76:79]
    ds_read_b64_tr_b16 v[38:39], v9 offset:25088
    v_mfma_f32_16x16x32_bf16 v[80:83], v[56:59], v[136:139], v[80:83]
    ds_read_b64_tr_b16 v[40:41], v10 offset:16384
    ds_read_b64_tr_b16 v[42:43], v10 offset:16896
    v_mfma_f32_16x16x32_bf16 v[84:87], v[56:59], v[140:143], v[84:87]
    ds_read_b64_tr_b16 v[44:45], v10 offset:24576
    v_mfma_f32_16x16x32_bf16 v[88:91], v[60:63], v[136:139], v[88:91]
    ds_read_b64_tr_b16 v[46:47], v10 offset:25088
    v_mfma_f32_16x16x32_bf16 v[92:95], v[60:63], v[140:143], v[92:95]
    s_setprio 2
    s_add_u32 m0, s76, 114688
    s_mul_i32 s74, s72, 229376
    buffer_load_dwordx4 v3, s[36:39], s74 offen lds
    s_add_u32 m0, s76, 122880
    s_add_u32 s72, s72, 1
    buffer_load_dwordx4 v3, s[40:43], s74 offen lds
    s_add_u32 m0, s76, 57344
    s_and_b32 s72, s72, 7
    buffer_load_dwordx4 v2, s[32:35], s73 offen lds
    s_waitcnt lgkmcnt(0)
    v_mfma_f32_16x16x32_bf16 v[64:67], v[32:35], v[144:147], v[64:67]
    ds_read_b128 v[152:155], v7 offset:16384
    ds_read_b128 v[156:159], v8 offset:16384
    v_mfma_f32_16x16x32_bf16 v[68:71], v[32:35], v[148:151], v[68:71]
    ds_read_b64_tr_b16 v[48:49], v9 offset:20480
    v_mfma_f32_16x16x32_bf16 v[72:75], v[36:39], v[144:147], v[72:75]
    ds_read_b64_tr_b16 v[50:51], v9 offset:20992
    ds_read_b64_tr_b16 v[52:53], v9 offset:28672
    v_mfma_f32_16x16x32_bf16 v[76:79], v[36:39], v[148:151], v[76:79]
    ds_read_b64_tr_b16 v[54:55], v9 offset:29184
    v_mfma_f32_16x16x32_bf16 v[80:83], v[40:43], v[144:147], v[80:83]
    ds_read_b64_tr_b16 v[56:57], v10 offset:20480
    ds_read_b64_tr_b16 v[58:59], v10 offset:20992
    v_mfma_f32_16x16x32_bf16 v[84:87], v[40:43], v[148:151], v[84:87]
    ds_read_b64_tr_b16 v[60:61], v10 offset:28672
    v_mfma_f32_16x16x32_bf16 v[88:91], v[44:47], v[144:147], v[88:91]
    ds_read_b64_tr_b16 v[62:63], v10 offset:29184
    v_mfma_f32_16x16x32_bf16 v[92:95], v[44:47], v[148:151], v[92:95]
    s_waitcnt vmcnt(4)
    s_setprio 3
    s_barrier
    s_add_u32 m0, s76, 0
    s_lshl_b32 s73, s72, 7
    buffer_load_dwordx4 v1, s[32:35], s73 offen lds
    s_waitcnt lgkmcnt(0)
    v_mfma_f32_16x16x32_bf16 v[64:67], v[48:51], v[152:155], v[64:67]
    ds_read_b128 v[160:163], v5 offset:32768
    ds_read_b128 v[164:167], v6 offset:32768
    v_mfma_f32_16x16x32_bf16 v[68:71], v[48:51], v[156:159], v[68:71]
    ds_read_b64_tr_b16 v[32:33], v9 offset:32768
    v_mfma_f32_16x16x32_bf16 v[72:75], v[52:55], v[152:155], v[72:75]
    ds_read_b64_tr_b16 v[34:35], v9 offset:33280
    ds_read_b64_tr_b16 v[36:37], v9 offset:40960
    v_mfma_f32_16x16x32_bf16 v[76:79], v[52:55], v[156:159], v[76:79]
    ds_read_b64_tr_b16 v[38:39], v9 offset:41472
    v_mfma_f32_16x16x32_bf16 v[80:83], v[56:59], v[152:155], v[80:83]
    ds_read_b64_tr_b16 v[40:41], v10 offset:32768
    ds_read_b64_tr_b16 v[42:43], v10 offset:33280
    v_mfma_f32_16x16x32_bf16 v[84:87], v[56:59], v[156:159], v[84:87]
    ds_read_b64_tr_b16 v[44:45], v10 offset:40960
    v_mfma_f32_16x16x32_bf16 v[88:91], v[60:63], v[152:155], v[88:91]
    ds_read_b64_tr_b16 v[46:47], v10 offset:41472
    v_mfma_f32_16x16x32_bf16 v[92:95], v[60:63], v[156:159], v[92:95]
    s_setprio 2
    s_add_u32 m0, s76, 65536
    s_mul_i32 s74, s72, 229376
    buffer_load_dwordx4 v3, s[36:39], s74 offen lds
    s_add_u32 m0, s76, 73728
    s_add_u32 s72, s72, 1
    buffer_load_dwordx4 v3, s[40:43], s74 offen lds
    s_add_u32 m0, s76, 8192
    s_and_b32 s72, s72, 7
    buffer_load_dwordx4 v2, s[32:35], s73 offen lds
    s_waitcnt lgkmcnt(0)
    v_mfma_f32_16x16x32_bf16 v[64:67], v[32:35], v[160:163], v[64:67]
    ds_read_b128 v[168:171], v7 offset:32768
    ds_read_b128 v[172:175], v8 offset:32768
    v_mfma_f32_16x16x32_bf16 v[68:71], v[32:35], v[164:167], v[68:71]
    ds_read_b64_tr_b16 v[48:49], v9 offset:36864
    v_mfma_f32_16x16x32_bf16 v[72:75], v[36:39], v[160:163], v[72:75]
    ds_read_b64_tr_b16 v[50:51], v9 offset:37376
    ds_read_b64_tr_b16 v[52:53], v9 offset:45056
    v_mfma_f32_16x16x32_bf16 v[76:79], v[36:39], v[164:167], v[76:79]
    ds_read_b64_tr_b16 v[54:55], v9 offset:45568
    v_mfma_f32_16x16x32_bf16 v[80:83], v[40:43], v[160:163], v[80:83]
    ds_read_b64_tr_b16 v[56:57], v10 offset:36864
    ds_read_b64_tr_b16 v[58:59], v10 offset:37376
    v_mfma_f32_16x16x32_bf16 v[84:87], v[40:43], v[164:167], v[84:87]
    ds_read_b64_tr_b16 v[60:61], v10 offset:45056
    v_mfma_f32_16x16x32_bf16 v[88:91], v[44:47], v[160:163], v[88:91]
    ds_read_b64_tr_b16 v[62:63], v10 offset:45568
    v_mfma_f32_16x16x32_bf16 v[92:95], v[44:47], v[164:167], v[92:95]
    s_waitcnt vmcnt(4)
    s_setprio 3
    s_barrier
    s_add_u32 m0, s76, 16384
    s_lshl_b32 s73, s72, 7
    buffer_load_dwordx4 v1, s[32:35], s73 offen lds
    s_waitcnt lgkmcnt(0)
    v_mfma_f32_16x16x32_bf16 v[64:67], v[48:51], v[168:171], v[64:67]
    ds_read_b128 v[176:179], v5 offset:49152
    ds_read_b128 v[180:183], v6 offset:49152
    v_mfma_f32_16x16x32_bf16 v[68:71], v[48:51], v[172:175], v[68:71]
    ds_read_b64_tr_b16 v[32:33], v9 offset:49152
    v_mfma_f32_16x16x32_bf16 v[72:75], v[52:55], v[168:171], v[72:75]
    ds_read_b64_tr_b16 v[34:35], v9 offset:49664
    ds_read_b64_tr_b16 v[36:37], v9 offset:57344
    v_mfma_f32_16x16x32_bf16 v[76:79], v[52:55], v[172:175], v[76:79]
    ds_read_b64_tr_b16 v[38:39], v9 offset:57856
    v_mfma_f32_16x16x32_bf16 v[80:83], v[56:59], v[168:171], v[80:83]
    ds_read_b64_tr_b16 v[40:41], v10 offset:49152
    ds_read_b64_tr_b16 v[42:43], v10 offset:49664
    v_mfma_f32_16x16x32_bf16 v[84:87], v[56:59], v[172:175], v[84:87]
    ds_read_b64_tr_b16 v[44:45], v10 offset:57344
    v_mfma_f32_16x16x32_bf16 v[88:91], v[60:63], v[168:171], v[88:91]
    ds_read_b64_tr_b16 v[46:47], v10 offset:57856
    v_mfma_f32_16x16x32_bf16 v[92:95], v[60:63], v[172:175], v[92:95]
    s_setprio 2
    s_add_u32 m0, s76, 81920
    s_mul_i32 s74, s72, 229376
    buffer_load_dwordx4 v3, s[36:39], s74 offen lds
    s_add_u32 m0, s76, 90112
    s_add_u32 s72, s72, 1
    buffer_load_dwordx4 v3, s[40:43], s74 offen lds
    s_add_u32 m0, s76, 24576
    s_and_b32 s72, s72, 7
    buffer_load_dwordx4 v2, s[32:35], s73 offen lds
    s_waitcnt lgkmcnt(0)
    v_mfma_f32_16x16x32_bf16 v[64:67], v[32:35], v[176:179], v[64:67]
    ds_read_b128 v[184:187], v7 offset:49152
    ds_read_b128 v[188:191], v8 offset:49152
    v_mfma_f32_16x16x32_bf16 v[68:71], v[32:35], v[180:183], v[68:71]
    ds_read_b64_tr_b16 v[48:49], v9 offset:53248
    v_mfma_f32_16x16x32_bf16 v[72:75], v[36:39], v[176:179], v[72:75]
    ds_read_b64_tr_b16 v[50:51], v9 offset:53760
    ds_read_b64_tr_b16 v[52:53], v9 offset:61440
    v_mfma_f32_16x16x32_bf16 v[76:79], v[36:39], v[180:183], v[76:79]
    ds_read_b64_tr_b16 v[54:55], v9 offset:61952
    v_mfma_f32_16x16x32_bf16 v[80:83], v[40:43], v[176:179], v[80:83]
    ds_read_b64_tr_b16 v[56:57], v10 offset:53248
    ds_read_b64_tr_b16 v[58:59], v10 offset:53760
    v_mfma_f32_16x16x32_bf16 v[84:87], v[40:43], v[180:183], v[84:87]
    ds_read_b64_tr_b16 v[60:61], v10 offset:61440
    v_mfma_f32_16x16x32_bf16 v[88:91], v[44:47], v[176:179], v[88:91]
    ds_read_b64_tr_b16 v[62:63], v10 offset:61952
    v_mfma_f32_16x16x32_bf16 v[92:95], v[44:47], v[180:183], v[92:95]
    s_waitcnt vmcnt(4)
    s_setprio 3
    s_barrier
    s_add_u32 m0, s76, 32768
    s_lshl_b32 s73, s72, 7
    buffer_load_dwordx4 v1, s[32:35], s73 offen lds
    s_waitcnt lgkmcnt(0)
    v_mfma_f32_16x16x32_bf16 v[64:67], v[48:51], v[184:187], v[64:67]
    ds_read_b128 v[192:195], v5 offset:0
    ds_read_b128 v[196:199], v6 offset:0
    v_mfma_f32_16x16x32_bf16 v[68:71], v[48:51], v[188:191], v[68:71]
    ds_read_b64_tr_b16 v[32:33], v9 offset:0
    v_mfma_f32_16x16x32_bf16 v[72:75], v[52:55], v[184:187], v[72:75]
    ds_read_b64_tr_b16 v[34:35], v9 offset:512
    ds_read_b64_tr_b16 v[36:37], v9 offset:8192
    v_mfma_f32_16x16x32_bf16 v[76:79], v[52:55], v[188:191], v[76:79]
    ds_read_b64_tr_b16 v[38:39], v9 offset:8704
    v_mfma_f32_16x16x32_bf16 v[80:83], v[56:59], v[184:187], v[80:83]
    ds_read_b64_tr_b16 v[40:41], v10 offset:0
    ds_read_b64_tr_b16 v[42:43], v10 offset:512
    v_mfma_f32_16x16x32_bf16 v[84:87], v[56:59], v[188:191], v[84:87]
    ds_read_b64_tr_b16 v[44:45], v10 offset:8192
    v_mfma_f32_16x16x32_bf16 v[88:91], v[60:63], v[184:187], v[88:91]
    ds_read_b64_tr_b16 v[46:47], v10 offset:8704
    v_mfma_f32_16x16x32_bf16 v[92:95], v[60:63], v[188:191], v[92:95]
    s_setprio 2
    s_add_u32 m0, s76, 98304
    s_mul_i32 s74, s72, 229376
    buffer_load_dwordx4 v3, s[36:39], s74 offen lds
    s_add_u32 m0, s76, 106496
    s_add_u32 s72, s72, 1
    buffer_load_dwordx4 v3, s[40:43], s74 offen lds
    s_add_u32 m0, s76, 40960
    s_and_b32 s72, s72, 7
    buffer_load_dwordx4 v2, s[32:35], s73 offen lds
    s_waitcnt lgkmcnt(0)
    v_mfma_f32_16x16x32_bf16 v[64:67], v[32:35], v[192:195], v[64:67]
    ds_read_b128 v[200:203], v7 offset:0
    ds_read_b128 v[204:207], v8 offset:0
    v_mfma_f32_16x16x32_bf16 v[68:71], v[32:35], v[196:199], v[68:71]
    ds_read_b64_tr_b16 v[48:49], v9 offset:4096
    v_mfma_f32_16x16x32_bf16 v[72:75], v[36:39], v[192:195], v[72:75]
    ds_read_b64_tr_b16 v[50:51], v9 offset:4608
    ds_read_b64_tr_b16 v[52:53], v9 offset:12288
    v_mfma_f32_16x16x32_bf16 v[76:79], v[36:39], v[196:199], v[76:79]
    ds_read_b64_tr_b16 v[54:55], v9 offset:12800
    v_mfma_f32_16x16x32_bf16 v[80:83], v[40:43], v[192:195], v[80:83]
    ds_read_b64_tr_b16 v[56:57], v10 offset:4096
    ds_read_b64_tr_b16 v[58:59], v10 offset:4608
    v_mfma_f32_16x16x32_bf16 v[84:87], v[40:43], v[196:199], v[84:87]
    ds_read_b64_tr_b16 v[60:61], v10 offset:12288
    v_mfma_f32_16x16x32_bf16 v[88:91], v[44:47], v[192:195], v[88:91]
    ds_read_b64_tr_b16 v[62:63], v10 offset:12800
    v_mfma_f32_16x16x32_bf16 v[92:95], v[44:47], v[196:199], v[92:95]
    s_waitcnt vmcnt(4)
    s_setprio 3
    s_barrier
    s_add_u32 m0, s76, 49152
    s_lshl_b32 s73, s72, 7
    buffer_load_dwordx4 v1, s[32:35], s73 offen lds
    s_waitcnt lgkmcnt(0)
    v_mfma_f32_16x16x32_bf16 v[64:67], v[48:51], v[200:203], v[64:67]
    ds_read_b128 v[208:211], v5 offset:16384
    ds_read_b128 v[212:215], v6 offset:16384
    v_mfma_f32_16x16x32_bf16 v[68:71], v[48:51], v[204:207], v[68:71]
    ds_read_b64_tr_b16 v[32:33], v9 offset:16384
    v_mfma_f32_16x16x32_bf16 v[72:75], v[52:55], v[200:203], v[72:75]
    ds_read_b64_tr_b16 v[34:35], v9 offset:16896
    ds_read_b64_tr_b16 v[36:37], v9 offset:24576
    v_mfma_f32_16x16x32_bf16 v[76:79], v[52:55], v[204:207], v[76:79]
    ds_read_b64_tr_b16 v[38:39], v9 offset:25088
    v_mfma_f32_16x16x32_bf16 v[80:83], v[56:59], v[200:203], v[80:83]
    ds_read_b64_tr_b16 v[40:41], v10 offset:16384
    ds_read_b64_tr_b16 v[42:43], v10 offset:16896
    v_mfma_f32_16x16x32_bf16 v[84:87], v[56:59], v[204:207], v[84:87]
    ds_read_b64_tr_b16 v[44:45], v10 offset:24576
    v_mfma_f32_16x16x32_bf16 v[88:91], v[60:63], v[200:203], v[88:91]
    ds_read_b64_tr_b16 v[46:47], v10 offset:25088
    v_mfma_f32_16x16x32_bf16 v[92:95], v[60:63], v[204:207], v[92:95]
    s_setprio 2
    s_add_u32 m0, s76, 114688
    s_mul_i32 s74, s72, 229376
    buffer_load_dwordx4 v3, s[36:39], s74 offen lds
    s_add_u32 m0, s76, 122880
    s_add_u32 s72, s72, 1
    buffer_load_dwordx4 v3, s[40:43], s74 offen lds
    s_add_u32 m0, s76, 57344
    s_and_b32 s72, s72, 7
    buffer_load_dwordx4 v2, s[32:35], s73 offen lds
    s_waitcnt lgkmcnt(0)
    v_mfma_f32_16x16x32_bf16 v[64:67], v[32:35], v[208:211], v[64:67]
    ds_read_b128 v[216:219], v7 offset:16384
    ds_read_b128 v[220:223], v8 offset:16384
    v_mfma_f32_16x16x32_bf16 v[68:71], v[32:35], v[212:215], v[68:71]
    ds_read_b64_tr_b16 v[48:49], v9 offset:20480
    v_mfma_f32_16x16x32_bf16 v[72:75], v[36:39], v[208:211], v[72:75]
    ds_read_b64_tr_b16 v[50:51], v9 offset:20992
    ds_read_b64_tr_b16 v[52:53], v9 offset:28672
    v_mfma_f32_16x16x32_bf16 v[76:79], v[36:39], v[212:215], v[76:79]
    ds_read_b64_tr_b16 v[54:55], v9 offset:29184
    v_mfma_f32_16x16x32_bf16 v[80:83], v[40:43], v[208:211], v[80:83]
    ds_read_b64_tr_b16 v[56:57], v10 offset:20480
    ds_read_b64_tr_b16 v[58:59], v10 offset:20992
    v_mfma_f32_16x16x32_bf16 v[84:87], v[40:43], v[212:215], v[84:87]
    ds_read_b64_tr_b16 v[60:61], v10 offset:28672
    v_mfma_f32_16x16x32_bf16 v[88:91], v[44:47], v[208:211], v[88:91]
    ds_read_b64_tr_b16 v[62:63], v10 offset:29184
    v_mfma_f32_16x16x32_bf16 v[92:95], v[44:47], v[212:215], v[92:95]
    s_waitcnt vmcnt(4)
    s_setprio 3
    s_barrier
    s_add_u32 m0, s76, 65536
    s_mul_i32 s74, s72, 229376
    buffer_load_dwordx4 v27, s[36:39], s74 offen lds
    s_waitcnt lgkmcnt(0)
    v_mfma_f32_16x16x32_bf16 v[64:67], v[48:51], v[216:219], v[64:67]
    ds_read_b128 v[224:227], v5 offset:32768
    ds_read_b128 v[228:231], v6 offset:32768
    v_mfma_f32_16x16x32_bf16 v[68:71], v[48:51], v[220:223], v[68:71]
    ds_read_b64_tr_b16 v[32:33], v9 offset:32768
    v_mfma_f32_16x16x32_bf16 v[72:75], v[52:55], v[216:219], v[72:75]
    ds_read_b64_tr_b16 v[34:35], v9 offset:33280
    ds_read_b64_tr_b16 v[36:37], v9 offset:40960
    v_mfma_f32_16x16x32_bf16 v[76:79], v[52:55], v[220:223], v[76:79]
    ds_read_b64_tr_b16 v[38:39], v9 offset:41472
    v_mfma_f32_16x16x32_bf16 v[80:83], v[56:59], v[216:219], v[80:83]
    ds_read_b64_tr_b16 v[40:41], v10 offset:32768
    ds_read_b64_tr_b16 v[42:43], v10 offset:33280
    v_mfma_f32_16x16x32_bf16 v[84:87], v[56:59], v[220:223], v[84:87]
    ds_read_b64_tr_b16 v[44:45], v10 offset:40960
    v_mfma_f32_16x16x32_bf16 v[88:91], v[60:63], v[216:219], v[88:91]
    ds_read_b64_tr_b16 v[46:47], v10 offset:41472
    v_mfma_f32_16x16x32_bf16 v[92:95], v[60:63], v[220:223], v[92:95]
    s_setprio 2
    s_add_u32 m0, s76, 73728
    s_add_u32 s72, s72, 1
    s_and_b32 s72, s72, 7
    buffer_load_dwordx4 v27, s[40:43], s74 offen lds
    s_add_u32 m0, s76, 0
    s_mul_i32 s74, s72, 229376
    buffer_load_dwordx4 v27, s[36:39], s74 offen lds
    s_add_u32 m0, s76, 8192
    s_add_u32 s72, s72, 1
    s_and_b32 s72, s72, 7
    buffer_load_dwordx4 v27, s[40:43], s74 offen lds
    s_waitcnt lgkmcnt(0)
    v_mfma_f32_16x16x32_bf16 v[64:67], v[32:35], v[224:227], v[64:67]
    ds_read_b128 v[232:235], v7 offset:32768
    ds_read_b128 v[236:239], v8 offset:32768
    v_mfma_f32_16x16x32_bf16 v[68:71], v[32:35], v[228:231], v[68:71]
    ds_read_b64_tr_b16 v[48:49], v9 offset:36864
    v_mfma_f32_16x16x32_bf16 v[72:75], v[36:39], v[224:227], v[72:75]
    ds_read_b64_tr_b16 v[50:51], v9 offset:37376
    ds_read_b64_tr_b16 v[52:53], v9 offset:45056
    v_mfma_f32_16x16x32_bf16 v[76:79], v[36:39], v[228:231], v[76:79]
    ds_read_b64_tr_b16 v[54:55], v9 offset:45568
    v_mfma_f32_16x16x32_bf16 v[80:83], v[40:43], v[224:227], v[80:83]
    ds_read_b64_tr_b16 v[56:57], v10 offset:36864
    ds_read_b64_tr_b16 v[58:59], v10 offset:37376
    v_mfma_f32_16x16x32_bf16 v[84:87], v[40:43], v[228:231], v[84:87]
    ds_read_b64_tr_b16 v[60:61], v10 offset:45056
    v_mfma_f32_16x16x32_bf16 v[88:91], v[44:47], v[224:227], v[88:91]
    ds_read_b64_tr_b16 v[62:63], v10 offset:45568
    v_mfma_f32_16x16x32_bf16 v[92:95], v[44:47], v[228:231], v[92:95]
    s_waitcnt vmcnt(4)
    s_setprio 3
    s_barrier
    s_add_u32 m0, s76, 81920
    s_mul_i32 s74, s72, 229376
    buffer_load_dwordx4 v27, s[36:39], s74 offen lds
    s_waitcnt lgkmcnt(0)
    v_mfma_f32_16x16x32_bf16 v[64:67], v[48:51], v[232:235], v[64:67]
    ds_read_b128 v[240:243], v5 offset:49152
    ds_read_b128 v[244:247], v6 offset:49152
    v_mfma_f32_16x16x32_bf16 v[68:71], v[48:51], v[236:239], v[68:71]
    ds_read_b64_tr_b16 v[32:33], v9 offset:49152
    v_mfma_f32_16x16x32_bf16 v[72:75], v[52:55], v[232:235], v[72:75]
    ds_read_b64_tr_b16 v[34:35], v9 offset:49664
    ds_read_b64_tr_b16 v[36:37], v9 offset:57344
    v_mfma_f32_16x16x32_bf16 v[76:79], v[52:55], v[236:239], v[76:79]
    ds_read_b64_tr_b16 v[38:39], v9 offset:57856
    v_mfma_f32_16x16x32_bf16 v[80:83], v[56:59], v[232:235], v[80:83]
    ds_read_b64_tr_b16 v[40:41], v10 offset:49152
    ds_read_b64_tr_b16 v[42:43], v10 offset:49664
    v_mfma_f32_16x16x32_bf16 v[84:87], v[56:59], v[236:239], v[84:87]
    ds_read_b64_tr_b16 v[44:45], v10 offset:57344
    v_mfma_f32_16x16x32_bf16 v[88:91], v[60:63], v[232:235], v[88:91]
    ds_read_b64_tr_b16 v[46:47], v10 offset:57856
    v_mfma_f32_16x16x32_bf16 v[92:95], v[60:63], v[236:239], v[92:95]
    s_setprio 2
    s_add_u32 m0, s76, 90112
    s_add_u32 s72, s72, 1
    s_and_b32 s72, s72, 7
    buffer_load_dwordx4 v27, s[40:43], s74 offen lds
    s_add_u32 m0, s76, 16384
    s_mul_i32 s74, s72, 229376
    buffer_load_dwordx4 v27, s[36:39], s74 offen lds
    s_add_u32 m0, s76, 24576
    s_add_u32 s72, s72, 1
    s_and_b32 s72, s72, 7
    buffer_load_dwordx4 v27, s[40:43], s74 offen lds
    s_waitcnt lgkmcnt(0)
    v_mfma_f32_16x16x32_bf16 v[64:67], v[32:35], v[240:243], v[64:67]
    ds_read_b128 v[248:251], v7 offset:49152
    ds_read_b128 v[252:255], v8 offset:49152
    v_mfma_f32_16x16x32_bf16 v[68:71], v[32:35], v[244:247], v[68:71]
    ds_read_b64_tr_b16 v[48:49], v9 offset:53248
    v_mfma_f32_16x16x32_bf16 v[72:75], v[36:39], v[240:243], v[72:75]
    ds_read_b64_tr_b16 v[50:51], v9 offset:53760
    ds_read_b64_tr_b16 v[52:53], v9 offset:61440
    v_mfma_f32_16x16x32_bf16 v[76:79], v[36:39], v[244:247], v[76:79]
    ds_read_b64_tr_b16 v[54:55], v9 offset:61952
    v_mfma_f32_16x16x32_bf16 v[80:83], v[40:43], v[240:243], v[80:83]
    ds_read_b64_tr_b16 v[56:57], v10 offset:53248
    ds_read_b64_tr_b16 v[58:59], v10 offset:53760
    v_mfma_f32_16x16x32_bf16 v[84:87], v[40:43], v[244:247], v[84:87]
    ds_read_b64_tr_b16 v[60:61], v10 offset:61440
    v_mfma_f32_16x16x32_bf16 v[88:91], v[44:47], v[240:243], v[88:91]
    ds_read_b64_tr_b16 v[62:63], v10 offset:61952
    v_mfma_f32_16x16x32_bf16 v[92:95], v[44:47], v[244:247], v[92:95]
    s_setprio 1
    v_subrev_u32 v5, 65536, v9
    v_subrev_u32 v6, 65536, v10
    v_add_u32 v7, 65536, v9
    v_add_u32 v8, 65536, v10
    s_waitcnt lgkmcnt(0)
    v_mfma_f32_16x16x32_bf16 v[64:67], v[48:51], v[248:251], v[64:67]
    v_mfma_f32_16x16x32_bf16 v[68:71], v[48:51], v[252:255], v[68:71]
    v_mfma_f32_16x16x32_bf16 v[72:75], v[52:55], v[248:251], v[72:75]
    v_mfma_f32_16x16x32_bf16 v[76:79], v[52:55], v[252:255], v[76:79]
    v_mfma_f32_16x16x32_bf16 v[80:83], v[56:59], v[248:251], v[80:83]
    v_mfma_f32_16x16x32_bf16 v[84:87], v[56:59], v[252:255], v[84:87]
    v_mfma_f32_16x16x32_bf16 v[88:91], v[60:63], v[248:251], v[88:91]
    v_mfma_f32_16x16x32_bf16 v[92:95], v[60:63], v[252:255], v[92:95]
    s_setprio 0
    v_mul_f32 v18, v64, v64
    v_mul_f32 v19, v65, v65
    v_fma_f32 v18, v18, s96, v16
    v_fma_f32 v19, v19, s96, v16
    v_mul_f32 v18, v18, v64
    v_mul_f32 v19, v19, v65
    v_exp_f32 v18, v18
    v_exp_f32 v19, v19
    v_mul_f32 v64, v64, v72
    v_add_f32 v18, 1.0, v18
    v_add_f32 v19, 1.0, v19
    v_rcp_f32 v18, v18
    v_rcp_f32 v19, v19
    v_mul_f32 v65, v65, v73
    v_mul_f32 v64, v64, v18
    v_mul_f32 v65, v65, v19
    v_cvt_pk_bf16_f32 v64, v64, v65
    s_waitcnt vmcnt(4)
    s_setprio 3
    s_barrier
    ds_read_b64_tr_b16 v[32:33], v9 offset:0
    ds_read_b64_tr_b16 v[34:35], v9 offset:512
    ds_read_b64_tr_b16 v[36:37], v9 offset:4096
    ds_read_b64_tr_b16 v[38:39], v9 offset:4608
    ds_read_b64_tr_b16 v[40:41], v5 offset:0
    ds_read_b64_tr_b16 v[42:43], v5 offset:512
    ds_read_b64_tr_b16 v[44:45], v5 offset:4096
    ds_read_b64_tr_b16 v[46:47], v5 offset:4608
    s_add_u32 m0, s76, 98304
    s_mul_i32 s74, s72, 229376
    buffer_load_dwordx4 v27, s[36:39], s74 offen lds
    s_add_u32 m0, s76, 106496
    s_add_u32 s72, s72, 1
    s_and_b32 s72, s72, 7
    buffer_load_dwordx4 v27, s[40:43], s74 offen lds
    v_mul_f32 v18, v66, v66
    v_mul_f32 v19, v67, v67
    v_fma_f32 v18, v18, s96, v16
    v_fma_f32 v19, v19, s96, v16
    v_mul_f32 v18, v18, v66
    v_mul_f32 v19, v19, v67
    v_exp_f32 v18, v18
    v_exp_f32 v19, v19
    v_mul_f32 v66, v66, v74
    v_add_f32 v18, 1.0, v18
    s_waitcnt lgkmcnt(0)
    v_mfma_f32_16x16x32_bf16 v[96:99], v[32:35], v[128:131], 0
    ds_read_b64_tr_b16 v[48:49], v9 offset:8192
    ds_read_b64_tr_b16 v[50:51], v9 offset:8704
    v_mfma_f32_16x16x32_bf16 v[96:99], v[36:39], v[136:139], v[96:99]
    ds_read_b64_tr_b16 v[52:53], v9 offset:12288
    v_mfma_f32_16x16x32_bf16 v[96:99], v[40:43], v[144:147], v[96:99]
    ds_read_b64_tr_b16 v[54:55], v9 offset:12800
    v_mfma_f32_16x16x32_bf16 v[96:99], v[44:47], v[152:155], v[96:99]
    ds_read_b64_tr_b16 v[56:57], v5 offset:8192
    v_mfma_f32_16x16x32_bf16 v[100:103], v[32:35], v[132:135], 0
    ds_read_b64_tr_b16 v[58:59], v5 offset:8704
    v_mfma_f32_16x16x32_bf16 v[100:103], v[36:39], v[140:143], v[100:103]
    ds_read_b64_tr_b16 v[60:61], v5 offset:12288
    v_mfma_f32_16x16x32_bf16 v[100:103], v[40:43], v[148:151], v[100:103]
    ds_read_b64_tr_b16 v[62:63], v5 offset:12800
    v_mfma_f32_16x16x32_bf16 v[100:103], v[44:47], v[156:159], v[100:103]
    s_setprio 2
    s_add_u32 m0, s76, 32768
    s_mul_i32 s74, s72, 229376
    buffer_load_dwordx4 v27, s[36:39], s74 offen lds
    s_add_u32 m0, s76, 40960
    s_add_u32 s72, s72, 1
    s_and_b32 s72, s72, 7
    buffer_load_dwordx4 v27, s[40:43], s74 offen lds
    v_add_f32 v19, 1.0, v19
    v_rcp_f32 v18, v18
    v_rcp_f32 v19, v19
    v_mul_f32 v67, v67, v75
    v_mul_f32 v66, v66, v18
    v_mul_f32 v67, v67, v19
    v_cvt_pk_bf16_f32 v65, v66, v67
    v_mul_f32 v18, v68, v68
    v_mul_f32 v19, v69, v69
    v_fma_f32 v18, v18, s96, v16
    s_waitcnt lgkmcnt(0)
    v_mfma_f32_16x16x32_bf16 v[104:107], v[48:51], v[128:131], 0
    ds_read_b64_tr_b16 v[32:33], v10 offset:0
    ds_read_b64_tr_b16 v[34:35], v10 offset:512
    v_mfma_f32_16x16x32_bf16 v[104:107], v[52:55], v[136:139], v[104:107]
    ds_read_b64_tr_b16 v[36:37], v10 offset:4096
    v_mfma_f32_16x16x32_bf16 v[104:107], v[56:59], v[144:147], v[104:107]
    ds_read_b64_tr_b16 v[38:39], v10 offset:4608
    v_mfma_f32_16x16x32_bf16 v[104:107], v[60:63], v[152:155], v[104:107]
    ds_read_b64_tr_b16 v[40:41], v6 offset:0
    v_mfma_f32_16x16x32_bf16 v[108:111], v[48:51], v[132:135], 0
    ds_read_b64_tr_b16 v[42:43], v6 offset:512
    v_mfma_f32_16x16x32_bf16 v[108:111], v[52:55], v[140:143], v[108:111]
    ds_read_b64_tr_b16 v[44:45], v6 offset:4096
    v_mfma_f32_16x16x32_bf16 v[108:111], v[56:59], v[148:151], v[108:111]
    ds_read_b64_tr_b16 v[46:47], v6 offset:4608
    v_mfma_f32_16x16x32_bf16 v[108:111], v[60:63], v[156:159], v[108:111]
    s_setprio 1
    s_add_u32 m0, s76, 131072
    s_mul_i32 s74, s72, 229376
    buffer_load_dwordx4 v27, s[36:39], s74 offen lds
    s_add_u32 m0, s76, 139264
    s_add_u32 s72, s72, 1
    s_and_b32 s72, s72, 7
    buffer_load_dwordx4 v27, s[40:43], s74 offen lds
    s_add_u32 m0, s76, 147456
    s_mul_i32 s74, s72, 229376
    buffer_load_dwordx4 v27, s[36:39], s74 offen lds
    s_cmp_lg_u32 s68, 0
    s_cbranch_scc1 L_nos0lG
    buffer_load_dword v28, v17, s[56:59], 0 offen sc1
L_nos0lG:
    s_add_u32 m0, s76, 155648
    s_add_u32 s72, s72, 1
    s_and_b32 s72, s72, 7
    buffer_load_dwordx4 v27, s[40:43], s74 offen lds
    v_fma_f32 v19, v19, s96, v16
    v_mul_f32 v18, v18, v68
    v_mul_f32 v19, v19, v69
    v_exp_f32 v18, v18
    v_exp_f32 v19, v19
    v_mul_f32 v68, v68, v76
    v_add_f32 v18, 1.0, v18
    v_add_f32 v19, 1.0, v19
    v_rcp_f32 v18, v18
    v_rcp_f32 v19, v19
    s_waitcnt lgkmcnt(0)
    v_mfma_f32_16x16x32_bf16 v[112:115], v[32:35], v[128:131], 0
    ds_read_b64_tr_b16 v[48:49], v10 offset:8192
    ds_read_b64_tr_b16 v[50:51], v10 offset:8704
    v_mfma_f32_16x16x32_bf16 v[112:115], v[36:39], v[136:139], v[112:115]
    ds_read_b64_tr_b16 v[52:53], v10 offset:12288
    v_mfma_f32_16x16x32_bf16 v[112:115], v[40:43], v[144:147], v[112:115]
    ds_read_b64_tr_b16 v[54:55], v10 offset:12800
    v_mfma_f32_16x16x32_bf16 v[112:115], v[44:47], v[152:155], v[112:115]
    ds_read_b64_tr_b16 v[56:57], v6 offset:8192
    v_mfma_f32_16x16x32_bf16 v[116:119], v[32:35], v[132:135], 0
    ds_read_b64_tr_b16 v[58:59], v6 offset:8704
    v_mfma_f32_16x16x32_bf16 v[116:119], v[36:39], v[140:143], v[116:119]
    ds_read_b64_tr_b16 v[60:61], v6 offset:12288
    v_mfma_f32_16x16x32_bf16 v[116:119], v[40:43], v[148:151], v[116:119]
    ds_read_b64_tr_b16 v[62:63], v6 offset:12800
    v_mfma_f32_16x16x32_bf16 v[116:119], v[44:47], v[156:159], v[116:119]
    s_waitcnt vmcnt(8)
    s_setprio 3
    s_barrier
    s_waitcnt lgkmcnt(0)
    v_mfma_f32_16x16x32_bf16 v[120:123], v[48:51], v[128:131], 0
    ds_read_b64_tr_b16 v[32:33], v9 offset:16384
    ds_read_b64_tr_b16 v[34:35], v9 offset:16896
    v_mfma_f32_16x16x32_bf16 v[120:123], v[52:55], v[136:139], v[120:123]
    ds_read_b64_tr_b16 v[36:37], v9 offset:20480
    v_mfma_f32_16x16x32_bf16 v[120:123], v[56:59], v[144:147], v[120:123]
    ds_read_b64_tr_b16 v[38:39], v9 offset:20992
    v_mfma_f32_16x16x32_bf16 v[120:123], v[60:63], v[152:155], v[120:123]
    ds_read_b64_tr_b16 v[40:41], v5 offset:16384
    v_mfma_f32_16x16x32_bf16 v[124:127], v[48:51], v[132:135], 0
    ds_read_b64_tr_b16 v[42:43], v5 offset:16896
    v_mfma_f32_16x16x32_bf16 v[124:127], v[52:55], v[140:143], v[124:127]
    ds_read_b64_tr_b16 v[44:45], v5 offset:20480
    v_mfma_f32_16x16x32_bf16 v[124:127], v[56:59], v[148:151], v[124:127]
    ds_read_b64_tr_b16 v[46:47], v5 offset:20992
    v_mfma_f32_16x16x32_bf16 v[124:127], v[60:63], v[156:159], v[124:127]
    s_setprio 2
    v_mul_f32 v69, v69, v77
    v_mul_f32 v68, v68, v18
    v_mul_f32 v69, v69, v19
    v_cvt_pk_bf16_f32 v66, v68, v69
    v_mul_f32 v18, v70, v70
    v_mul_f32 v19, v71, v71
    v_fma_f32 v18, v18, s96, v16
    v_fma_f32 v19, v19, s96, v16
    v_mul_f32 v18, v18, v70
    v_mul_f32 v19, v19, v71
    v_exp_f32 v18, v18
    v_and_b32 v152, 31, v15
    v_lshlrev_b32 v152, 2, v152
    v_mov_b32 v154, 0xdddddddd
    v_mov_b32 v141, 0x3f803f80
    s_waitcnt lgkmcnt(0)
    v_mfma_f32_16x16x32_bf16 v[96:99], v[32:35], v[160:163], v[96:99]
    ds_read_b64_tr_b16 v[48:49], v9 offset:24576
    ds_read_b64_tr_b16 v[50:51], v9 offset:25088
    v_mfma_f32_16x16x32_bf16 v[96:99], v[36:39], v[168:171], v[96:99]
    ds_read_b64_tr_b16 v[52:53], v9 offset:28672
    v_mfma_f32_16x16x32_bf16 v[96:99], v[40:43], v[176:179], v[96:99]
    ds_read_b64_tr_b16 v[54:55], v9 offset:29184
    v_mfma_f32_16x16x32_bf16 v[96:99], v[44:47], v[184:187], v[96:99]
    ds_read_b64_tr_b16 v[56:57], v5 offset:24576
    v_mfma_f32_16x16x32_bf16 v[100:103], v[44:47], v[188:191], v[100:103]
    ds_read_b64_tr_b16 v[58:59], v5 offset:25088
    v_mfma_f32_16x16x32_bf16 v[100:103], v[40:43], v[180:183], v[100:103]
    ds_read_b64_tr_b16 v[60:61], v5 offset:28672
    v_mfma_f32_16x16x32_bf16 v[100:103], v[36:39], v[172:175], v[100:103]
    ds_read_b64_tr_b16 v[62:63], v5 offset:29184
    v_mfma_f32_16x16x32_bf16 v[100:103], v[32:35], v[164:167], v[100:103]
    s_setprio 1
    buffer_load_dword v11, v11, s[48:51], 0 offen
    v_exp_f32 v19, v19
    v_mul_f32 v70, v70, v78
    v_add_f32 v18, 1.0, v18
    v_add_f32 v19, 1.0, v19
    v_rcp_f32 v18, v18
    v_rcp_f32 v19, v19
    v_mul_f32 v71, v71, v79
    v_mul_f32 v70, v70, v18
    v_mul_f32 v71, v71, v19
    v_cvt_pk_bf16_f32 v67, v70, v71
    s_mov_b32 vcc_lo, 0x22
    s_mov_b32 vcc_hi, 0x22
    v_cndmask_b32 v140, 0, v141, vcc
    v_mov_b32 v141, v140
    v_mov_b64 v[142:143], v[140:141]
    v_mov_b64 v[144:145], v[140:141]
    s_waitcnt lgkmcnt(0)
    v_mfma_f32_16x16x32_bf16 v[104:107], v[48:51], v[160:163], v[104:107]
    ds_read_b64_tr_b16 v[32:33], v10 offset:16384
    ds_read_b64_tr_b16 v[34:35], v10 offset:16896
    v_mfma_f32_16x16x32_bf16 v[104:107], v[52:55], v[168:171], v[104:107]
    ds_read_b64_tr_b16 v[36:37], v10 offset:20480
    v_mfma_f32_16x16x32_bf16 v[104:107], v[56:59], v[176:179], v[104:107]
    ds_read_b64_tr_b16 v[38:39], v10 offset:20992
    v_mfma_f32_16x16x32_bf16 v[104:107], v[60:63], v[184:187], v[104:107]
    ds_read_b64_tr_b16 v[40:41], v6 offset:16384
    v_mfma_f32_16x16x32_bf16 v[108:111], v[60:63], v[188:191], v[108:111]
    ds_read_b64_tr_b16 v[42:43], v6 offset:16896
    v_mfma_f32_16x16x32_bf16 v[108:111], v[56:59], v[180:183], v[108:111]
    ds_read_b64_tr_b16 v[44:45], v6 offset:20480
    v_mfma_f32_16x16x32_bf16 v[108:111], v[52:55], v[172:175], v[108:111]
    ds_read_b64_tr_b16 v[46:47], v6 offset:20992
    v_mfma_f32_16x16x32_bf16 v[108:111], v[48:51], v[164:167], v[108:111]
    s_setprio 0
    v_permlane16_swap_b32 v64, v66
    v_permlane16_swap_b32 v65, v67
    v_mul_f32 v18, v80, v80
    v_mul_f32 v19, v81, v81
    v_fma_f32 v18, v18, s96, v16
    v_fma_f32 v19, v19, s96, v16
    v_mul_f32 v18, v18, v80
    v_mul_f32 v19, v19, v81
    v_exp_f32 v18, v18
    v_exp_f32 v19, v19
    v_mov_b64 v[146:147], v[140:141]
    v_mov_b64 v[148:149], v[140:141]
    v_mov_b64 v[150:151], v[140:141]
    s_waitcnt lgkmcnt(0)
    v_mfma_f32_16x16x32_bf16 v[112:115], v[32:35], v[160:163], v[112:115]
    ds_read_b64_tr_b16 v[48:49], v10 offset:24576
    ds_read_b64_tr_b16 v[50:51], v10 offset:25088
    v_mfma_f32_16x16x32_bf16 v[112:115], v[36:39], v[168:171], v[112:115]
    ds_read_b64_tr_b16 v[52:53], v10 offset:28672
    v_mfma_f32_16x16x32_bf16 v[112:115], v[40:43], v[176:179], v[112:115]
    ds_read_b64_tr_b16 v[54:55], v10 offset:29184
    v_mfma_f32_16x16x32_bf16 v[112:115], v[44:47], v[184:187], v[112:115]
    ds_read_b64_tr_b16 v[56:57], v6 offset:24576
    v_mfma_f32_16x16x32_bf16 v[116:119], v[44:47], v[188:191], v[116:119]
    ds_read_b64_tr_b16 v[58:59], v6 offset:25088
    v_mfma_f32_16x16x32_bf16 v[116:119], v[40:43], v[180:183], v[116:119]
    ds_read_b64_tr_b16 v[60:61], v6 offset:28672
    v_mfma_f32_16x16x32_bf16 v[116:119], v[36:39], v[172:175], v[116:119]
    ds_read_b64_tr_b16 v[62:63], v6 offset:29184
    v_mfma_f32_16x16x32_bf16 v[116:119], v[32:35], v[164:167], v[116:119]
    s_waitcnt vmcnt(1)
    s_setprio 3
    s_barrier
    s_waitcnt lgkmcnt(0)
    v_mfma_f32_16x16x32_bf16 v[120:123], v[48:51], v[160:163], v[120:123]
    ds_read_b64_tr_b16 v[32:33], v9 offset:32768
    ds_read_b64_tr_b16 v[34:35], v9 offset:33280
    v_mfma_f32_16x16x32_bf16 v[120:123], v[52:55], v[168:171], v[120:123]
    ds_read_b64_tr_b16 v[36:37], v9 offset:36864
    v_mfma_f32_16x16x32_bf16 v[120:123], v[56:59], v[176:179], v[120:123]
    ds_read_b64_tr_b16 v[38:39], v9 offset:37376
    v_mfma_f32_16x16x32_bf16 v[120:123], v[60:63], v[184:187], v[120:123]
    ds_read_b64_tr_b16 v[40:41], v5 offset:32768
    v_mfma_f32_16x16x32_bf16 v[124:127], v[60:63], v[188:191], v[124:127]
    ds_read_b64_tr_b16 v[42:43], v5 offset:33280
    v_mfma_f32_16x16x32_bf16 v[124:127], v[56:59], v[180:183], v[124:127]
    ds_read_b64_tr_b16 v[44:45], v5 offset:36864
    v_mfma_f32_16x16x32_bf16 v[124:127], v[52:55], v[172:175], v[124:127]
    ds_read_b64_tr_b16 v[46:47], v5 offset:37376
    v_mfma_f32_16x16x32_bf16 v[124:127], v[48:51], v[164:167], v[124:127]
    s_setprio 2
    v_mul_f32 v80, v80, v88
    v_add_f32 v18, 1.0, v18
    v_add_f32 v19, 1.0, v19
    v_rcp_f32 v18, v18
    v_rcp_f32 v19, v19
    v_mul_f32 v81, v81, v89
    v_mul_f32 v80, v80, v18
    v_mul_f32 v81, v81, v19
    v_cvt_pk_bf16_f32 v80, v80, v81
    v_mul_f32 v18, v82, v82
    s_add_u32 s82, s0, 0
    buffer_store_dwordx4 v[64:67], v4, s[52:55], s82 offen sc1
    v_add_u32 v159, s100, v31
    v_xor_b32 v160, 64, v159
    v_add_u32 v158, 7168, v0
    v_add_u32 v161, s89, v14
    v_xor_b32 v162, 0x400, v161
    s_waitcnt lgkmcnt(0)
    v_mfma_f32_16x16x32_bf16 v[96:99], v[32:35], v[192:195], v[96:99]
    ds_read_b64_tr_b16 v[48:49], v9 offset:40960
    ds_read_b64_tr_b16 v[50:51], v9 offset:41472
    v_mfma_f32_16x16x32_bf16 v[96:99], v[36:39], v[200:203], v[96:99]
    ds_read_b64_tr_b16 v[52:53], v9 offset:45056
    v_mfma_f32_16x16x32_bf16 v[96:99], v[40:43], v[208:211], v[96:99]
    ds_read_b64_tr_b16 v[54:55], v9 offset:45568
    v_mfma_f32_16x16x32_bf16 v[96:99], v[44:47], v[216:219], v[96:99]
    ds_read_b64_tr_b16 v[56:57], v5 offset:40960
    v_mfma_f32_16x16x32_bf16 v[100:103], v[44:47], v[220:223], v[100:103]
    ds_read_b64_tr_b16 v[58:59], v5 offset:41472
    v_mfma_f32_16x16x32_bf16 v[100:103], v[40:43], v[212:215], v[100:103]
    ds_read_b64_tr_b16 v[60:61], v5 offset:45056
    v_mfma_f32_16x16x32_bf16 v[100:103], v[36:39], v[204:207], v[100:103]
    ds_read_b64_tr_b16 v[62:63], v5 offset:45568
    v_mfma_f32_16x16x32_bf16 v[100:103], v[32:35], v[196:199], v[100:103]
    s_setprio 1
    v_mul_f32 v19, v83, v83
    v_fma_f32 v18, v18, s96, v16
    v_fma_f32 v19, v19, s96, v16
    v_mul_f32 v18, v18, v82
    v_mul_f32 v19, v19, v83
    v_exp_f32 v18, v18
    v_exp_f32 v19, v19
    v_mul_f32 v82, v82, v90
    v_add_f32 v18, 1.0, v18
    v_add_f32 v19, 1.0, v19
    v_rcp_f32 v18, v18
    v_lshlrev_b32 v163, 7, v15
    v_mov_b32 v168, 1
    v_lshl_add_u32 v171, v15, 2, s86
    v_lshl_add_u32 v172, v15, 2, s87
    s_waitcnt lgkmcnt(0)
    v_mfma_f32_16x16x32_bf16 v[104:107], v[48:51], v[192:195], v[104:107]
    ds_read_b64_tr_b16 v[32:33], v10 offset:32768
    ds_read_b64_tr_b16 v[34:35], v10 offset:33280
    v_mfma_f32_16x16x32_bf16 v[104:107], v[52:55], v[200:203], v[104:107]
    ds_read_b64_tr_b16 v[36:37], v10 offset:36864
    v_mfma_f32_16x16x32_bf16 v[104:107], v[56:59], v[208:211], v[104:107]
    ds_read_b64_tr_b16 v[38:39], v10 offset:37376
    v_mfma_f32_16x16x32_bf16 v[104:107], v[60:63], v[216:219], v[104:107]
    ds_read_b64_tr_b16 v[40:41], v6 offset:32768
    v_mfma_f32_16x16x32_bf16 v[108:111], v[60:63], v[220:223], v[108:111]
    ds_read_b64_tr_b16 v[42:43], v6 offset:33280
    v_mfma_f32_16x16x32_bf16 v[108:111], v[56:59], v[212:215], v[108:111]
    ds_read_b64_tr_b16 v[44:45], v6 offset:36864
    v_mfma_f32_16x16x32_bf16 v[108:111], v[52:55], v[204:207], v[108:111]
    ds_read_b64_tr_b16 v[46:47], v6 offset:37376
    v_mfma_f32_16x16x32_bf16 v[108:111], v[48:51], v[196:199], v[108:111]
    s_setprio 0
    v_rcp_f32 v19, v19
    v_mul_f32 v83, v83, v91
    v_mul_f32 v82, v82, v18
    v_mul_f32 v83, v83, v19
    v_cvt_pk_bf16_f32 v81, v82, v83
    v_mul_f32 v18, v84, v84
    v_mul_f32 v19, v85, v85
    v_fma_f32 v18, v18, s96, v16
    v_fma_f32 v19, v19, s96, v16
    v_mul_f32 v18, v18, v84
    v_mov_b64 v[176:177], 0
    v_mov_b64 v[178:179], 0
    v_mov_b64 v[180:181], 0
    v_mov_b64 v[182:183], 0
    s_waitcnt lgkmcnt(0)
    v_mfma_f32_16x16x32_bf16 v[112:115], v[32:35], v[192:195], v[112:115]
    ds_read_b64_tr_b16 v[48:49], v10 offset:40960
    ds_read_b64_tr_b16 v[50:51], v10 offset:41472
    v_mfma_f32_16x16x32_bf16 v[112:115], v[36:39], v[200:203], v[112:115]
    ds_read_b64_tr_b16 v[52:53], v10 offset:45056
    v_mfma_f32_16x16x32_bf16 v[112:115], v[40:43], v[208:211], v[112:115]
    ds_read_b64_tr_b16 v[54:55], v10 offset:45568
    v_mfma_f32_16x16x32_bf16 v[112:115], v[44:47], v[216:219], v[112:115]
    ds_read_b64_tr_b16 v[56:57], v6 offset:40960
    v_mfma_f32_16x16x32_bf16 v[116:119], v[44:47], v[220:223], v[116:119]
    ds_read_b64_tr_b16 v[58:59], v6 offset:41472
    v_mfma_f32_16x16x32_bf16 v[116:119], v[40:43], v[212:215], v[116:119]
    ds_read_b64_tr_b16 v[60:61], v6 offset:45056
    v_mfma_f32_16x16x32_bf16 v[116:119], v[36:39], v[204:207], v[116:119]
    ds_read_b64_tr_b16 v[62:63], v6 offset:45568
    v_mfma_f32_16x16x32_bf16 v[116:119], v[32:35], v[196:199], v[116:119]
    s_setprio 3
    s_barrier
    s_waitcnt lgkmcnt(0)
    v_mfma_f32_16x16x32_bf16 v[120:123], v[48:51], v[192:195], v[120:123]
    ds_read_b64_tr_b16 v[32:33], v7 offset:0
    ds_read_b64_tr_b16 v[34:35], v7 offset:512
    v_mfma_f32_16x16x32_bf16 v[120:123], v[52:55], v[200:203], v[120:123]
    ds_read_b64_tr_b16 v[36:37], v7 offset:4096
    v_mfma_f32_16x16x32_bf16 v[120:123], v[56:59], v[208:211], v[120:123]
    ds_read_b64_tr_b16 v[38:39], v7 offset:4608
    v_mfma_f32_16x16x32_bf16 v[120:123], v[60:63], v[216:219], v[120:123]
    ds_read_b64_tr_b16 v[40:41], v7 offset:16384
    v_mfma_f32_16x16x32_bf16 v[124:127], v[60:63], v[220:223], v[124:127]
    ds_read_b64_tr_b16 v[42:43], v7 offset:16896
    v_mfma_f32_16x16x32_bf16 v[124:127], v[56:59], v[212:215], v[124:127]
    ds_read_b64_tr_b16 v[44:45], v7 offset:20480
    v_mfma_f32_16x16x32_bf16 v[124:127], v[52:55], v[204:207], v[124:127]
    ds_read_b64_tr_b16 v[46:47], v7 offset:20992
    v_mfma_f32_16x16x32_bf16 v[124:127], v[48:51], v[196:199], v[124:127]
    s_setprio 2
    v_mul_f32 v19, v19, v85
    v_exp_f32 v18, v18
    v_exp_f32 v19, v19
    v_mul_f32 v84, v84, v92
    v_add_f32 v18, 1.0, v18
    v_add_f32 v19, 1.0, v19
    v_rcp_f32 v18, v18
    v_rcp_f32 v19, v19
    v_mul_f32 v85, v85, v93
    v_mul_f32 v84, v84, v18
    v_mov_b64 v[184:185], 0
    v_mov_b64 v[186:187], 0
    v_mov_b64 v[188:189], 0
    v_mov_b64 v[190:191], 0
    s_waitcnt lgkmcnt(0)
    v_mfma_f32_16x16x32_bf16 v[96:99], v[32:35], v[224:227], v[96:99]
    ds_read_b64_tr_b16 v[48:49], v7 offset:8192
    ds_read_b64_tr_b16 v[50:51], v7 offset:8704
    v_mfma_f32_16x16x32_bf16 v[96:99], v[36:39], v[232:235], v[96:99]
    ds_read_b64_tr_b16 v[52:53], v7 offset:12288
    v_mfma_f32_16x16x32_bf16 v[96:99], v[40:43], v[240:243], v[96:99]
    ds_read_b64_tr_b16 v[54:55], v7 offset:12800
    v_mfma_f32_16x16x32_bf16 v[96:99], v[44:47], v[248:251], v[96:99]
    ds_read_b64_tr_b16 v[56:57], v7 offset:24576
    v_mfma_f32_16x16x32_bf16 v[100:103], v[44:47], v[252:255], v[100:103]
    ds_read_b64_tr_b16 v[58:59], v7 offset:25088
    v_mfma_f32_16x16x32_bf16 v[100:103], v[40:43], v[244:247], v[100:103]
    ds_read_b64_tr_b16 v[60:61], v7 offset:28672
    v_mfma_f32_16x16x32_bf16 v[100:103], v[36:39], v[236:239], v[100:103]
    ds_read_b64_tr_b16 v[62:63], v7 offset:29184
    v_mfma_f32_16x16x32_bf16 v[100:103], v[32:35], v[228:231], v[100:103]
    s_setprio 1
    v_mul_f32 v85, v85, v19
    v_cvt_pk_bf16_f32 v82, v84, v85
    v_mul_f32 v18, v86, v86
    v_mul_f32 v19, v87, v87
    v_fma_f32 v18, v18, s96, v16
    v_fma_f32 v19, v19, s96, v16
    v_mul_f32 v18, v18, v86
    v_mul_f32 v19, v19, v87
    v_exp_f32 v18, v18
    v_exp_f32 v19, v19
    v_mov_b64 v[192:193], 0
    v_mov_b64 v[194:195], 0
    v_mov_b64 v[196:197], 0
    v_mov_b64 v[198:199], 0
    s_waitcnt lgkmcnt(0)
    v_mfma_f32_16x16x32_bf16 v[104:107], v[48:51], v[224:227], v[104:107]
    ds_read_b64_tr_b16 v[32:33], v8 offset:0
    ds_read_b64_tr_b16 v[34:35], v8 offset:512
    v_mfma_f32_16x16x32_bf16 v[104:107], v[52:55], v[232:235], v[104:107]
    ds_read_b64_tr_b16 v[36:37], v8 offset:4096
    v_mfma_f32_16x16x32_bf16 v[104:107], v[56:59], v[240:243], v[104:107]
    ds_read_b64_tr_b16 v[38:39], v8 offset:4608
    v_mfma_f32_16x16x32_bf16 v[104:107], v[60:63], v[248:251], v[104:107]
    ds_read_b64_tr_b16 v[40:41], v8 offset:16384
    v_mfma_f32_16x16x32_bf16 v[108:111], v[60:63], v[252:255], v[108:111]
    ds_read_b64_tr_b16 v[42:43], v8 offset:16896
    v_mfma_f32_16x16x32_bf16 v[108:111], v[56:59], v[244:247], v[108:111]
    ds_read_b64_tr_b16 v[44:45], v8 offset:20480
    v_mfma_f32_16x16x32_bf16 v[108:111], v[52:55], v[236:239], v[108:111]
    ds_read_b64_tr_b16 v[46:47], v8 offset:20992
    v_mfma_f32_16x16x32_bf16 v[108:111], v[48:51], v[228:231], v[108:111]
    s_setprio 0
    s_cmp_lg_u32 s68, 0
    s_cbranch_scc1 L_nopoll0G
    v_cmp_eq_u32 vcc, 0, v28
    s_cbranch_vccnz L_s0retryG
L_s0doneG:
    s_mov_b32 s81, 196608
    v_lshlrev_b32 v21, 7, v15
    buffer_load_dword v20, v21, s[52:55], s81 offen sc1
L_nopoll0G:
    v_mul_f32 v86, v86, v94
    v_add_f32 v18, 1.0, v18
    v_add_f32 v19, 1.0, v19
    v_rcp_f32 v18, v18
    v_rcp_f32 v19, v19
    v_mul_f32 v87, v87, v95
    v_mul_f32 v86, v86, v18
    v_mul_f32 v87, v87, v19
    v_cvt_pk_bf16_f32 v83, v86, v87
    v_permlane16_swap_b32 v80, v82
    s_nop 0
    v_permlane16_swap_b32 v81, v83
    v_mov_b64 v[200:201], 0
    v_mov_b64 v[202:203], 0
    v_mov_b64 v[204:205], 0
    v_mov_b64 v[206:207], 0
    s_waitcnt lgkmcnt(0)
    v_mfma_f32_16x16x32_bf16 v[112:115], v[32:35], v[224:227], v[112:115]
    ds_read_b64_tr_b16 v[48:49], v8 offset:8192
    ds_read_b64_tr_b16 v[50:51], v8 offset:8704
    v_mfma_f32_16x16x32_bf16 v[112:115], v[36:39], v[232:235], v[112:115]
    ds_read_b64_tr_b16 v[52:53], v8 offset:12288
    v_mfma_f32_16x16x32_bf16 v[112:115], v[40:43], v[240:243], v[112:115]
    ds_read_b64_tr_b16 v[54:55], v8 offset:12800
    v_mfma_f32_16x16x32_bf16 v[112:115], v[44:47], v[248:251], v[112:115]
    ds_read_b64_tr_b16 v[56:57], v8 offset:24576
    v_mfma_f32_16x16x32_bf16 v[116:119], v[44:47], v[252:255], v[116:119]
    ds_read_b64_tr_b16 v[58:59], v8 offset:25088
    v_mfma_f32_16x16x32_bf16 v[116:119], v[40:43], v[244:247], v[116:119]
    ds_read_b64_tr_b16 v[60:61], v8 offset:28672
    v_mfma_f32_16x16x32_bf16 v[116:119], v[36:39], v[236:239], v[116:119]
    ds_read_b64_tr_b16 v[62:63], v8 offset:29184
    v_mfma_f32_16x16x32_bf16 v[116:119], v[32:35], v[228:231], v[116:119]
    s_waitcnt lgkmcnt(0)
L_join:
    s_cmp_lg_u32 s68, 0
    s_cbranch_scc1 L_s1doneJ
    s_mov_b32 s80, 0
L_s1pollJ:
    s_waitcnt vmcnt(0)
    v_cmp_ne_u32 vcc, 1, v20
    s_cbranch_vccz L_s1doneJ
    s_mov_b64 exec, vcc
    buffer_load_dword v20, v21, s[52:55], s81 offen sc1
    s_mov_b64 exec, -1
    s_add_u32 s80, s80, 1
    s_cmp_lt_u32 s80, 4194304
    s_cbranch_scc1 L_s1pollJ
    s_waitcnt vmcnt(0)
L_s1doneJ:
    s_barrier
    buffer_load_dwordx4 v[128:131], v14, s[52:55], s1 offen sc1
    s_xor_b32 s1, s1, 1024
    s_mov_b32 m0, s83
    s_nop 0
    buffer_load_dwordx4 v26, s[52:55], s85 offen sc1 lds
    buffer_load_dwordx4 v26, s[52:55], s85 offen offset:1024 sc1 lds
    buffer_load_dwordx4 v[132:135], v14, s[52:55], s1 offen sc1
    v_mfma_f32_16x16x32_bf16 v[120:123], v[48:51], v[224:227], v[120:123]
    v_mfma_f32_16x16x32_bf16 v[120:123], v[52:55], v[232:235], v[120:123]
    v_mfma_f32_16x16x32_bf16 v[120:123], v[56:59], v[240:243], v[120:123]
    v_mfma_f32_16x16x32_bf16 v[120:123], v[60:63], v[248:251], v[120:123]
    v_mfma_f32_16x16x32_bf16 v[124:127], v[60:63], v[252:255], v[124:127]
    v_mfma_f32_16x16x32_bf16 v[124:127], v[56:59], v[244:247], v[124:127]
    v_mfma_f32_16x16x32_bf16 v[124:127], v[52:55], v[236:239], v[124:127]
    v_mfma_f32_16x16x32_bf16 v[124:127], v[48:51], v[228:231], v[124:127]
    s_add_u32 s85, s85, 8192
    s_add_u32 m0, s83, 8192
    s_and_b32 s85, s85, 0xffff
    buffer_load_dwordx4 v26, s[52:55], s85 offen sc1 lds
    buffer_load_dwordx4 v26, s[52:55], s85 offen offset:1024 sc1 lds
    v_pk_mul_f32 v[18:19], v[96:97], v[96:97]
    v_pk_mul_f32 v[22:23], v[98:99], v[98:99]
    v_pk_fma_f32 v[18:19], v[18:19], s[96:97], v[16:17] op_sel_hi:[1,0,0]
    v_pk_fma_f32 v[22:23], v[22:23], s[96:97], v[16:17] op_sel_hi:[1,0,0]
    v_pk_mul_f32 v[18:19], v[18:19], v[96:97]
    v_pk_mul_f32 v[22:23], v[22:23], v[98:99]
    v_exp_f32 v18, v18
    v_exp_f32 v22, v22
    v_exp_f32 v19, v19
    v_exp_f32 v23, v23
    v_pk_mul_f32 v[96:97], v[96:97], v[104:105]
    v_pk_mul_f32 v[98:99], v[98:99], v[106:107]
    v_pk_add_f32 v[18:19], v[18:19], 1.0 op_sel_hi:[1,0]
    v_pk_add_f32 v[22:23], v[22:23], 1.0 op_sel_hi:[1,0]
    v_rcp_f32 v18, v18
    v_rcp_f32 v22, v22
    v_rcp_f32 v19, v19
    v_rcp_f32 v23, v23
    v_pk_mul_f32 v[96:97], v[96:97], v[18:19]
    v_pk_mul_f32 v[98:99], v[98:99], v[22:23]
    v_cvt_pk_bf16_f32 v96, v96, v97
    v_cvt_pk_bf16_f32 v97, v98, v99
    v_pk_mul_f32 v[18:19], v[100:101], v[100:101]
    v_pk_mul_f32 v[22:23], v[102:103], v[102:103]
    v_pk_fma_f32 v[18:19], v[18:19], s[96:97], v[16:17] op_sel_hi:[1,0,0]
    v_pk_fma_f32 v[22:23], v[22:23], s[96:97], v[16:17] op_sel_hi:[1,0,0]
    v_pk_mul_f32 v[18:19], v[18:19], v[100:101]
    v_pk_mul_f32 v[22:23], v[22:23], v[102:103]
    v_exp_f32 v18, v18
    v_exp_f32 v22, v22
    v_exp_f32 v19, v19
    v_exp_f32 v23, v23
    v_pk_mul_f32 v[100:101], v[100:101], v[108:109]
    v_pk_mul_f32 v[102:103], v[102:103], v[110:111]
    v_pk_add_f32 v[18:19], v[18:19], 1.0 op_sel_hi:[1,0]
    v_pk_add_f32 v[22:23], v[22:23], 1.0 op_sel_hi:[1,0]
    v_rcp_f32 v18, v18
    v_rcp_f32 v22, v22
    v_rcp_f32 v19, v19
    v_rcp_f32 v23, v23
    v_pk_mul_f32 v[100:101], v[100:101], v[18:19]
    v_pk_mul_f32 v[102:103], v[102:103], v[22:23]
    v_cvt_pk_bf16_f32 v98, v100, v101
    v_cvt_pk_bf16_f32 v99, v102, v103
    v_pk_mul_f32 v[18:19], v[112:113], v[112:113]
    v_pk_mul_f32 v[22:23], v[114:115], v[114:115]
    v_pk_fma_f32 v[18:19], v[18:19], s[96:97], v[16:17] op_sel_hi:[1,0,0]
    v_pk_fma_f32 v[22:23], v[22:23], s[96:97], v[16:17] op_sel_hi:[1,0,0]
    v_pk_mul_f32 v[18:19], v[18:19], v[112:113]
    v_pk_mul_f32 v[22:23], v[22:23], v[114:115]
    v_exp_f32 v18, v18
    v_exp_f32 v22, v22
    v_exp_f32 v19, v19
    v_exp_f32 v23, v23
    v_pk_mul_f32 v[112:113], v[112:113], v[120:121]
    v_pk_mul_f32 v[114:115], v[114:115], v[122:123]
    v_pk_add_f32 v[18:19], v[18:19], 1.0 op_sel_hi:[1,0]
    v_pk_add_f32 v[22:23], v[22:23], 1.0 op_sel_hi:[1,0]
    v_rcp_f32 v18, v18
    v_rcp_f32 v22, v22
    v_rcp_f32 v19, v19
    v_rcp_f32 v23, v23
    v_pk_mul_f32 v[112:113], v[112:113], v[18:19]
    v_pk_mul_f32 v[114:115], v[114:115], v[22:23]
    v_cvt_pk_bf16_f32 v112, v112, v113
    v_cvt_pk_bf16_f32 v113, v114, v115
    v_permlane16_swap_b32 v96, v98
    v_permlane16_swap_b32 v97, v99
    v_pk_mul_f32 v[18:19], v[116:117], v[116:117]
    v_pk_mul_f32 v[22:23], v[118:119], v[118:119]
    v_pk_fma_f32 v[18:19], v[18:19], s[96:97], v[16:17] op_sel_hi:[1,0,0]
    v_pk_fma_f32 v[22:23], v[22:23], s[96:97], v[16:17] op_sel_hi:[1,0,0]
    v_pk_mul_f32 v[18:19], v[18:19], v[116:117]
    v_pk_mul_f32 v[22:23], v[22:23], v[118:119]
    v_exp_f32 v18, v18
    v_exp_f32 v22, v22
    v_exp_f32 v19, v19
    v_exp_f32 v23, v23
    v_pk_mul_f32 v[116:117], v[116:117], v[124:125]
    v_pk_mul_f32 v[118:119], v[118:119], v[126:127]
    v_pk_add_f32 v[18:19], v[18:19], 1.0 op_sel_hi:[1,0]
    v_pk_add_f32 v[22:23], v[22:23], 1.0 op_sel_hi:[1,0]
    v_rcp_f32 v18, v18
    v_rcp_f32 v22, v22
    v_rcp_f32 v19, v19
    v_rcp_f32 v23, v23
    v_pk_mul_f32 v[116:117], v[116:117], v[18:19]
    v_pk_mul_f32 v[118:119], v[118:119], v[22:23]
    v_cvt_pk_bf16_f32 v114, v116, v117
    v_cvt_pk_bf16_f32 v115, v118, v119
    s_nop 0
    v_permlane16_swap_b32 v112, v114
    v_permlane16_swap_b32 v113, v115
    s_mov_b32 s88, 0x55555555
    s_mov_b32 s89, 0x55555555
    s_waitcnt vmcnt(0)
    s_barrier
    s_setprio 3
    ds_read_b128 v[136:139], v24 offset:0
    s_mov_b64 exec, s[88:89]
    ds_read_b128 v[144:147], v25 offset:1024
    s_mov_b64 exec, -1
    s_waitcnt lgkmcnt(1)
    v_mfma_f32_32x32x16_bf16 v[208:223], v[136:139], v[128:131], 4.0
    v_mfma_f32_32x32x16_bf16 v[224:239], v[136:139], v[132:135], 4.0
    s_nop 10
    v_exp_f32 v208, v208
    v_exp_f32 v209, v209
    s_cmp_eq_u32 s71, 0
    s_cbranch_scc1 L_nols1
    s_add_u32 s82, s0, 16384
    buffer_store_dwordx4 v[80:83], v4, s[52:55], s82 offen sc1
L_nols1:
    v_exp_f32 v210, v210
    v_exp_f32 v211, v211
    v_exp_f32 v212, v212
    s_waitcnt lgkmcnt(0)
    s_mov_b64 exec, s[88:89]
    ds_read_b128 v[140:143], v25 offset:1536
    ds_read_b128 v[148:151], v25 offset:3072
    s_mov_b64 exec, -1
    v_exp_f32 v213, v213
    v_exp_f32 v214, v214
    v_exp_f32 v215, v215
    v_exp_f32 v216, v216
    v_exp_f32 v217, v217
    v_exp_f32 v218, v218
    ds_read_b128 v[136:139], v24 offset:2048
    v_smfmac_f32_32x32x32_bf16 v[176:191], v[144:147], v[208:215], v154
    v_exp_f32 v219, v219
    v_exp_f32 v220, v220
    v_exp_f32 v221, v221
    v_exp_f32 v222, v222
    v_exp_f32 v223, v223
    v_exp_f32 v224, v224
    v_exp_f32 v225, v225
    s_waitcnt lgkmcnt(0)
    v_smfmac_f32_32x32x32_bf16 v[176:191], v[140:143], v[216:223], v154
    v_exp_f32 v226, v226
    v_exp_f32 v227, v227
    v_exp_f32 v228, v228
    s_add_u32 s85, s85, 8192
    s_add_u32 m0, s83, 16384
    s_and_b32 s85, s85, 0xffff
    buffer_load_dwordx4 v26, s[52:55], s85 offen sc1 lds
    v_mfma_f32_32x32x16_bf16 v[208:223], v[136:139], v[128:131], 4.0
    v_exp_f32 v229, v229
    v_exp_f32 v230, v230
    v_exp_f32 v231, v231
    buffer_load_dwordx4 v26, s[52:55], s85 offen offset:1024 sc1 lds
    v_exp_f32 v232, v232
    v_exp_f32 v233, v233
    v_exp_f32 v234, v234
    v_smfmac_f32_32x32x32_bf16 v[192:207], v[144:147], v[224:231], v154
    v_exp_f32 v235, v235
    v_exp_f32 v236, v236
    v_exp_f32 v237, v237
    v_exp_f32 v238, v238
    v_exp_f32 v239, v239
    v_exp_f32 v208, v208
    v_exp_f32 v209, v209
    v_smfmac_f32_32x32x32_bf16 v[192:207], v[140:143], v[232:239], v154
    v_exp_f32 v210, v210
    v_exp_f32 v211, v211
    v_exp_f32 v212, v212
    s_mov_b64 exec, s[88:89]
    ds_read_b128 v[140:143], v25 offset:3584
    ds_read_b128 v[144:147], v25 offset:5120
    s_mov_b64 exec, -1
    v_mfma_f32_32x32x16_bf16 v[224:239], v[136:139], v[132:135], 4.0
    v_exp_f32 v213, v213
    v_exp_f32 v214, v214
    v_exp_f32 v215, v215
    v_exp_f32 v216, v216
    v_exp_f32 v217, v217
    v_exp_f32 v218, v218
    ds_read_b128 v[136:139], v24 offset:4096
    v_smfmac_f32_32x32x32_bf16 v[176:191], v[148:151], v[208:215], v154
    v_exp_f32 v219, v219
    v_exp_f32 v220, v220
    v_exp_f32 v221, v221
    buffer_store_dwordx4 v[96:99], v4, s[52:55], s3 offen sc1
    v_exp_f32 v222, v222
    v_exp_f32 v223, v223
    v_exp_f32 v224, v224
    v_exp_f32 v225, v225
    s_waitcnt lgkmcnt(0)
    v_smfmac_f32_32x32x32_bf16 v[176:191], v[140:143], v[216:223], v154
    v_exp_f32 v226, v226
    v_exp_f32 v227, v227
    v_exp_f32 v228, v228
    v_mfma_f32_32x32x16_bf16 v[208:223], v[136:139], v[128:131], 4.0
    v_exp_f32 v229, v229
    v_exp_f32 v230, v230
    v_exp_f32 v231, v231
    v_exp_f32 v232, v232
    v_exp_f32 v233, v233
    v_exp_f32 v234, v234
    v_smfmac_f32_32x32x32_bf16 v[192:207], v[148:151], v[224:231], v154
    v_exp_f32 v235, v235
    v_exp_f32 v236, v236
    v_exp_f32 v237, v237
    s_add_u32 s85, s85, 8192
    s_add_u32 m0, s83, 24576
    s_and_b32 s85, s85, 0xffff
    buffer_load_dwordx4 v26, s[52:55], s85 offen sc1 lds
    v_exp_f32 v238, v238
    v_exp_f32 v239, v239
    v_exp_f32 v208, v208
    v_exp_f32 v209, v209
    buffer_load_dwordx4 v26, s[52:55], s85 offen offset:1024 sc1 lds
    v_smfmac_f32_32x32x32_bf16 v[192:207], v[140:143], v[232:239], v154
    v_exp_f32 v210, v210
    v_exp_f32 v211, v211
    v_exp_f32 v212, v212
    s_mov_b64 exec, s[88:89]
    ds_read_b128 v[140:143], v25 offset:5632
    ds_read_b128 v[148:151], v25 offset:7168
    s_mov_b64 exec, -1
    v_mfma_f32_32x32x16_bf16 v[224:239], v[136:139], v[132:135], 4.0
    v_exp_f32 v213, v213
    v_exp_f32 v214, v214
    v_exp_f32 v215, v215
    s_setprio 2
    v_exp_f32 v216, v216
    v_exp_f32 v217, v217
    v_exp_f32 v218, v218
    ds_read_b128 v[136:139], v24 offset:6144
    v_smfmac_f32_32x32x32_bf16 v[176:191], v[144:147], v[208:215], v154
    v_exp_f32 v219, v219
    v_exp_f32 v220, v220
    v_exp_f32 v221, v221
    v_exp_f32 v222, v222
    v_exp_f32 v223, v223
    v_exp_f32 v224, v224
    v_exp_f32 v225, v225
    s_waitcnt lgkmcnt(0)
    v_smfmac_f32_32x32x32_bf16 v[176:191], v[140:143], v[216:223], v154
    v_exp_f32 v226, v226
    v_exp_f32 v227, v227
    v_exp_f32 v228, v228
    v_mfma_f32_32x32x16_bf16 v[208:223], v[136:139], v[128:131], 4.0
    v_exp_f32 v229, v229
    v_exp_f32 v230, v230
    v_exp_f32 v231, v231
    s_add_u32 s3, s3, 16384
    buffer_store_dwordx4 v[112:115], v4, s[52:55], s3 offen sc1
    v_exp_f32 v232, v232
    v_exp_f32 v233, v233
    v_exp_f32 v234, v234
    v_smfmac_f32_32x32x32_bf16 v[192:207], v[144:147], v[224:231], v154
    v_exp_f32 v235, v235
    v_exp_f32 v236, v236
    v_exp_f32 v237, v237
    v_exp_f32 v238, v238
    v_exp_f32 v239, v239
    v_exp_f32 v208, v208
    v_exp_f32 v209, v209
    v_smfmac_f32_32x32x32_bf16 v[192:207], v[140:143], v[232:239], v154
    v_exp_f32 v210, v210
    v_exp_f32 v211, v211
    v_exp_f32 v212, v212
    s_mov_b64 exec, s[88:89]
    ds_read_b128 v[140:143], v25 offset:7680
    ds_read_b128 v[144:147], v25 offset:9216
    s_mov_b64 exec, -1
    v_mfma_f32_32x32x16_bf16 v[224:239], v[136:139], v[132:135], 4.0
    v_exp_f32 v213, v213
    v_exp_f32 v214, v214
    v_exp_f32 v215, v215
    s_add_u32 s85, s85, 8192
    s_add_u32 m0, s83, 32768
    s_and_b32 s85, s85, 0xffff
    buffer_load_dwordx4 v26, s[52:55], s85 offen sc1 lds
    v_exp_f32 v216, v216
    v_exp_f32 v217, v217
    v_exp_f32 v218, v218
    ds_read_b128 v[136:139], v24 offset:8192
    v_smfmac_f32_32x32x32_bf16 v[176:191], v[148:151], v[208:215], v154
    v_exp_f32 v219, v219
    v_exp_f32 v220, v220
    v_exp_f32 v221, v221
    buffer_load_dwordx4 v26, s[52:55], s85 offen offset:1024 sc1 lds
    v_exp_f32 v222, v222
    v_exp_f32 v223, v223
    v_exp_f32 v224, v224
    v_exp_f32 v225, v225
    s_waitcnt lgkmcnt(0)
    v_smfmac_f32_32x32x32_bf16 v[176:191], v[140:143], v[216:223], v154
    v_exp_f32 v226, v226
    v_exp_f32 v227, v227
    v_exp_f32 v228, v228
    v_mfma_f32_32x32x16_bf16 v[208:223], v[136:139], v[128:131], 4.0
    v_exp_f32 v229, v229
    v_exp_f32 v230, v230
    v_exp_f32 v231, v231
    v_exp_f32 v232, v232
    v_exp_f32 v233, v233
    v_exp_f32 v234, v234
    v_smfmac_f32_32x32x32_bf16 v[192:207], v[148:151], v[224:231], v154
    v_exp_f32 v235, v235
    v_exp_f32 v236, v236
    v_exp_f32 v237, v237
    v_exp_f32 v238, v238
    v_exp_f32 v239, v239
    v_exp_f32 v208, v208
    v_exp_f32 v209, v209
    v_smfmac_f32_32x32x32_bf16 v[192:207], v[140:143], v[232:239], v154
    v_exp_f32 v210, v210
    v_exp_f32 v211, v211
    v_exp_f32 v212, v212
    s_mov_b64 exec, s[88:89]
    ds_read_b128 v[140:143], v25 offset:9728
    ds_read_b128 v[148:151], v25 offset:11264
    s_mov_b64 exec, -1
    v_mfma_f32_32x32x16_bf16 v[224:239], v[136:139], v[132:135], 4.0
    v_exp_f32 v213, v213
    v_exp_f32 v214, v214
    v_exp_f32 v215, v215
    v_exp_f32 v216, v216
    v_exp_f32 v217, v217
    v_exp_f32 v218, v218
    ds_read_b128 v[136:139], v24 offset:10240
    v_smfmac_f32_32x32x32_bf16 v[176:191], v[144:147], v[208:215], v154
    v_exp_f32 v219, v219
    v_exp_f32 v220, v220
    v_exp_f32 v221, v221
    s_add_u32 s85, s85, 8192
    s_add_u32 m0, s83, 40960
    s_and_b32 s85, s85, 0xffff
    buffer_load_dwordx4 v26, s[52:55], s85 offen sc1 lds
    v_exp_f32 v222, v222
    v_exp_f32 v223, v223
    v_exp_f32 v224, v224
    v_exp_f32 v225, v225
    s_waitcnt lgkmcnt(0)
    v_smfmac_f32_32x32x32_bf16 v[176:191], v[140:143], v[216:223], v154
    v_exp_f32 v226, v226
    v_exp_f32 v227, v227
    v_exp_f32 v228, v228
    buffer_load_dwordx4 v26, s[52:55], s85 offen offset:1024 sc1 lds
    v_mfma_f32_32x32x16_bf16 v[208:223], v[136:139], v[128:131], 4.0
    v_exp_f32 v229, v229
    v_exp_f32 v230, v230
    v_exp_f32 v231, v231
    v_exp_f32 v232, v232
    v_exp_f32 v233, v233
    v_exp_f32 v234, v234
    v_smfmac_f32_32x32x32_bf16 v[192:207], v[144:147], v[224:231], v154
    v_exp_f32 v235, v235
    v_exp_f32 v236, v236
    v_exp_f32 v237, v237
    v_exp_f32 v238, v238
    v_exp_f32 v239, v239
    v_exp_f32 v208, v208
    v_exp_f32 v209, v209
    s_add_u32 m0, s100, 0
    s_nop 0
    buffer_load_dwordx4 v0, s[60:63], s99 offen lds
    v_smfmac_f32_32x32x32_bf16 v[192:207], v[140:143], v[232:239], v154
    v_exp_f32 v210, v210
    v_exp_f32 v211, v211
    v_exp_f32 v212, v212
    s_setprio 1
    s_mov_b64 exec, s[88:89]
    ds_read_b128 v[140:143], v25 offset:11776
    ds_read_b128 v[144:147], v25 offset:13312
    s_mov_b64 exec, -1
    v_mfma_f32_32x32x16_bf16 v[224:239], v[136:139], v[132:135], 4.0
    v_exp_f32 v213, v213
    v_exp_f32 v214, v214
    v_exp_f32 v215, v215
    buffer_load_dwordx4 v158, s[60:63], s99 offen offset:1024 lds
    v_exp_f32 v216, v216
    v_exp_f32 v217, v217
    v_exp_f32 v218, v218
    ds_read_b128 v[136:139], v24 offset:12288
    v_smfmac_f32_32x32x32_bf16 v[176:191], v[148:151], v[208:215], v154
    v_exp_f32 v219, v219
    v_exp_f32 v220, v220
    v_exp_f32 v221, v221
    v_exp_f32 v222, v222
    v_exp_f32 v223, v223
    v_exp_f32 v224, v224
    v_exp_f32 v225, v225
    s_waitcnt lgkmcnt(0)
    v_smfmac_f32_32x32x32_bf16 v[176:191], v[140:143], v[216:223], v154
    v_exp_f32 v226, v226
    v_exp_f32 v227, v227
    v_exp_f32 v228, v228
    v_mfma_f32_32x32x16_bf16 v[208:223], v[136:139], v[128:131], 4.0
    v_exp_f32 v229, v229
    v_exp_f32 v230, v230
    v_exp_f32 v231, v231
    v_exp_f32 v232, v232
    v_exp_f32 v233, v233
    v_exp_f32 v234, v234
    v_smfmac_f32_32x32x32_bf16 v[192:207], v[148:151], v[224:231], v154
    v_exp_f32 v235, v235
    v_exp_f32 v236, v236
    v_exp_f32 v237, v237
    v_exp_f32 v238, v238
    v_exp_f32 v239, v239
    v_exp_f32 v208, v208
    v_exp_f32 v209, v209
    v_smfmac_f32_32x32x32_bf16 v[192:207], v[140:143], v[232:239], v154
    v_exp_f32 v210, v210
    v_exp_f32 v211, v211
    v_exp_f32 v212, v212
    s_mov_b64 exec, s[88:89]
    ds_read_b128 v[140:143], v25 offset:13824
    ds_read_b128 v[148:151], v25 offset:15360
    s_mov_b64 exec, -1
    v_mfma_f32_32x32x16_bf16 v[224:239], v[136:139], v[132:135], 4.0
    v_exp_f32 v213, v213
    v_exp_f32 v214, v214
    v_exp_f32 v215, v215
    v_exp_f32 v216, v216
    v_exp_f32 v217, v217
    v_exp_f32 v218, v218
    ds_read_b128 v[136:139], v24 offset:14336
    v_smfmac_f32_32x32x32_bf16 v[176:191], v[144:147], v[208:215], v154
    v_exp_f32 v219, v219
    v_exp_f32 v220, v220
    v_exp_f32 v221, v221
    v_exp_f32 v222, v222
    v_exp_f32 v223, v223
    v_exp_f32 v224, v224
    v_exp_f32 v225, v225
    s_waitcnt lgkmcnt(0)
    v_smfmac_f32_32x32x32_bf16 v[176:191], v[140:143], v[216:223], v154
    v_exp_f32 v226, v226
    v_exp_f32 v227, v227
    v_exp_f32 v228, v228
    v_mfma_f32_32x32x16_bf16 v[208:223], v[136:139], v[128:131], 4.0
    v_exp_f32 v229, v229
    v_exp_f32 v230, v230
    v_exp_f32 v231, v231
    v_exp_f32 v232, v232
    v_exp_f32 v233, v233
    v_exp_f32 v234, v234
    v_smfmac_f32_32x32x32_bf16 v[192:207], v[144:147], v[224:231], v154
    v_exp_f32 v235, v235
    v_exp_f32 v236, v236
    v_exp_f32 v237, v237
    s_setprio 0
    v_exp_f32 v238, v238
    v_exp_f32 v239, v239
    v_exp_f32 v208, v208
    v_exp_f32 v209, v209
    v_smfmac_f32_32x32x32_bf16 v[192:207], v[140:143], v[232:239], v154
    v_exp_f32 v210, v210
    v_exp_f32 v211, v211
    v_exp_f32 v212, v212
    s_mov_b64 exec, s[88:89]
    ds_read_b128 v[140:143], v25 offset:15872
    s_mov_b64 exec, -1
    v_mfma_f32_32x32x16_bf16 v[224:239], v[136:139], v[132:135], 4.0
    v_exp_f32 v213, v213
    v_exp_f32 v214, v214
    v_exp_f32 v215, v215
    s_add_u32 m0, s100, 2048
    s_sub_u32 s44, s99, 16384
    s_cselect_b32 s44, 212992, s44
    buffer_load_dwordx4 v0, s[60:63], s44 offen lds
    v_exp_f32 v216, v216
    v_exp_f32 v217, v217
    v_exp_f32 v218, v218
    s_waitcnt vmcnt(3) lgkmcnt(0)
    s_barrier
    s_setprio 3
    ds_read_b128 v[136:139], v24 offset:16384
    s_mov_b64 exec, s[88:89]
    ds_read_b128 v[144:147], v25 offset:17408
    s_mov_b64 exec, -1
    v_smfmac_f32_32x32x32_bf16 v[176:191], v[148:151], v[208:215], v154
    v_exp_f32 v219, v219
    v_exp_f32 v220, v220
    v_exp_f32 v221, v221
    s_mov_b64 exec, 1
    buffer_store_dword v168, v17, s[52:55], s98 offen sc1
    s_mov_b64 exec, -1
    buffer_load_dwordx4 v158, s[60:63], s44 offen offset:1024 lds
    v_exp_f32 v222, v222
    v_exp_f32 v223, v223
    v_exp_f32 v224, v224
    v_exp_f32 v225, v225
    s_waitcnt lgkmcnt(0)
    v_smfmac_f32_32x32x32_bf16 v[176:191], v[140:143], v[216:223], v154
    v_exp_f32 v226, v226
    v_exp_f32 v227, v227
    v_exp_f32 v228, v228
    v_mfma_f32_32x32x16_bf16 v[208:223], v[136:139], v[128:131], 4.0
    v_exp_f32 v229, v229
    v_exp_f32 v230, v230
    v_exp_f32 v231, v231
    v_exp_f32 v232, v232
    v_exp_f32 v233, v233
    v_exp_f32 v234, v234
    v_smfmac_f32_32x32x32_bf16 v[192:207], v[148:151], v[224:231], v154
    v_exp_f32 v235, v235
    v_exp_f32 v236, v236
    v_exp_f32 v237, v237
    v_exp_f32 v238, v238
    v_exp_f32 v239, v239
    v_exp_f32 v208, v208
    v_exp_f32 v209, v209
    v_smfmac_f32_32x32x32_bf16 v[192:207], v[140:143], v[232:239], v154
    v_exp_f32 v210, v210
    v_exp_f32 v211, v211
    v_exp_f32 v212, v212
    s_mov_b64 exec, s[88:89]
    ds_read_b128 v[140:143], v25 offset:17920
    ds_read_b128 v[148:151], v25 offset:19456
    s_mov_b64 exec, -1
    v_mfma_f32_32x32x16_bf16 v[224:239], v[136:139], v[132:135], 4.0
    v_exp_f32 v213, v213
    v_exp_f32 v214, v214
    v_exp_f32 v215, v215
    v_exp_f32 v216, v216
    v_exp_f32 v217, v217
    v_exp_f32 v218, v218
    ds_read_b128 v[136:139], v24 offset:18432
    v_smfmac_f32_32x32x32_bf16 v[176:191], v[144:147], v[208:215], v154
    v_exp_f32 v219, v219
    v_exp_f32 v220, v220
    v_exp_f32 v221, v221
    v_exp_f32 v222, v222
    v_exp_f32 v223, v223
    v_exp_f32 v224, v224
    v_exp_f32 v225, v225
    s_waitcnt lgkmcnt(0)
    v_smfmac_f32_32x32x32_bf16 v[176:191], v[140:143], v[216:223], v154
    v_exp_f32 v226, v226
    v_exp_f32 v227, v227
    v_exp_f32 v228, v228
    v_mfma_f32_32x32x16_bf16 v[208:223], v[136:139], v[128:131], 4.0
    v_exp_f32 v229, v229
    v_exp_f32 v230, v230
    v_exp_f32 v231, v231
    v_exp_f32 v232, v232
    v_exp_f32 v233, v233
    v_exp_f32 v234, v234
    v_smfmac_f32_32x32x32_bf16 v[192:207], v[144:147], v[224:231], v154
    v_exp_f32 v235, v235
    v_exp_f32 v236, v236
    v_exp_f32 v237, v237
    v_exp_f32 v238, v238
    v_exp_f32 v239, v239
    v_exp_f32 v208, v208
    v_exp_f32 v209, v209
    v_smfmac_f32_32x32x32_bf16 v[192:207], v[140:143], v[232:239], v154
    v_exp_f32 v210, v210
    v_exp_f32 v211, v211
    v_exp_f32 v212, v212
    s_mov_b64 exec, s[88:89]
    ds_read_b128 v[140:143], v25 offset:19968
    ds_read_b128 v[144:147], v25 offset:21504
    s_mov_b64 exec, -1
    v_mfma_f32_32x32x16_bf16 v[224:239], v[136:139], v[132:135], 4.0
    v_exp_f32 v213, v213
    v_exp_f32 v214, v214
    v_exp_f32 v215, v215
    v_exp_f32 v216, v216
    v_exp_f32 v217, v217
    v_exp_f32 v218, v218
    ds_read_b128 v[136:139], v24 offset:20480
    v_smfmac_f32_32x32x32_bf16 v[176:191], v[148:151], v[208:215], v154
    v_exp_f32 v219, v219
    v_exp_f32 v220, v220
    v_exp_f32 v221, v221
    s_add_u32 m0, s100, 4096
    s_sub_u32 s45, s44, 16384
    s_cselect_b32 s45, 212992, s45
    buffer_load_dwordx4 v0, s[60:63], s45 offen lds
    v_exp_f32 v222, v222
    v_exp_f32 v223, v223
    v_exp_f32 v224, v224
    v_exp_f32 v225, v225
    s_waitcnt lgkmcnt(0)
    v_smfmac_f32_32x32x32_bf16 v[176:191], v[140:143], v[216:223], v154
    v_exp_f32 v226, v226
    v_exp_f32 v227, v227
    v_exp_f32 v228, v228
    buffer_load_dwordx4 v158, s[60:63], s45 offen offset:1024 lds
    v_mfma_f32_32x32x16_bf16 v[208:223], v[136:139], v[128:131], 4.0
    v_exp_f32 v229, v229
    v_exp_f32 v230, v230
    v_exp_f32 v231, v231
    v_exp_f32 v232, v232
    v_exp_f32 v233, v233
    v_exp_f32 v234, v234
    v_smfmac_f32_32x32x32_bf16 v[192:207], v[148:151], v[224:231], v154
    v_exp_f32 v235, v235
    v_exp_f32 v236, v236
    v_exp_f32 v237, v237
    v_exp_f32 v238, v238
    v_exp_f32 v239, v239
    v_exp_f32 v208, v208
    v_exp_f32 v209, v209
    v_smfmac_f32_32x32x32_bf16 v[192:207], v[140:143], v[232:239], v154
    v_exp_f32 v210, v210
    v_exp_f32 v211, v211
    v_exp_f32 v212, v212
    s_mov_b64 exec, s[88:89]
    ds_read_b128 v[140:143], v25 offset:22016
    ds_read_b128 v[148:151], v25 offset:23552
    s_mov_b64 exec, -1
    v_mfma_f32_32x32x16_bf16 v[224:239], v[136:139], v[132:135], 4.0
    v_exp_f32 v213, v213
    v_exp_f32 v214, v214
    v_exp_f32 v215, v215
    v_exp_f32 v216, v216
    v_exp_f32 v217, v217
    v_exp_f32 v218, v218
    ds_read_b128 v[136:139], v24 offset:22528
    v_smfmac_f32_32x32x32_bf16 v[176:191], v[144:147], v[208:215], v154
    v_exp_f32 v219, v219
    v_exp_f32 v220, v220
    v_exp_f32 v221, v221
    v_exp_f32 v222, v222
    v_exp_f32 v223, v223
    v_exp_f32 v224, v224
    v_exp_f32 v225, v225
    s_waitcnt lgkmcnt(0)
    v_smfmac_f32_32x32x32_bf16 v[176:191], v[140:143], v[216:223], v154
    v_exp_f32 v226, v226
    v_exp_f32 v227, v227
    v_exp_f32 v228, v228
    v_mfma_f32_32x32x16_bf16 v[208:223], v[136:139], v[128:131], 4.0
    v_exp_f32 v229, v229
    v_exp_f32 v230, v230
    v_exp_f32 v231, v231
    v_exp_f32 v232, v232
    v_exp_f32 v233, v233
    v_exp_f32 v234, v234
    v_smfmac_f32_32x32x32_bf16 v[192:207], v[144:147], v[224:231], v154
    v_exp_f32 v235, v235
    v_exp_f32 v236, v236
    v_exp_f32 v237, v237
    v_exp_f32 v238, v238
    v_exp_f32 v239, v239
    v_exp_f32 v208, v208
    v_exp_f32 v209, v209
    v_smfmac_f32_32x32x32_bf16 v[192:207], v[140:143], v[232:239], v154
    v_exp_f32 v210, v210
    v_exp_f32 v211, v211
    v_exp_f32 v212, v212
    s_mov_b64 exec, s[88:89]
    ds_read_b128 v[140:143], v25 offset:24064
    ds_read_b128 v[144:147], v25 offset:25600
    s_mov_b64 exec, -1
    v_mfma_f32_32x32x16_bf16 v[224:239], v[136:139], v[132:135], 4.0
    v_exp_f32 v213, v213
    v_exp_f32 v214, v214
    v_exp_f32 v215, v215
    v_exp_f32 v216, v216
    v_exp_f32 v217, v217
    v_exp_f32 v218, v218
    ds_read_b128 v[136:139], v24 offset:24576
    v_smfmac_f32_32x32x32_bf16 v[176:191], v[148:151], v[208:215], v154
    v_exp_f32 v219, v219
    v_exp_f32 v220, v220
    v_exp_f32 v221, v221
    v_exp_f32 v222, v222
    v_exp_f32 v223, v223
    v_exp_f32 v224, v224
    v_exp_f32 v225, v225
    s_waitcnt lgkmcnt(0)
    v_smfmac_f32_32x32x32_bf16 v[176:191], v[140:143], v[216:223], v154
    v_exp_f32 v226, v226
    v_exp_f32 v227, v227
    v_exp_f32 v228, v228
    s_add_u32 m0, s100, 6144
    s_sub_u32 s47, s45, 16384
    s_cselect_b32 s47, 212992, s47
    buffer_load_dwordx4 v0, s[60:63], s47 offen lds
    v_mfma_f32_32x32x16_bf16 v[208:223], v[136:139], v[128:131], 4.0
    v_exp_f32 v229, v229
    v_exp_f32 v230, v230
    v_exp_f32 v231, v231
    buffer_load_dwordx4 v158, s[60:63], s47 offen offset:1024 lds
    v_exp_f32 v232, v232
    v_exp_f32 v233, v233
    v_exp_f32 v234, v234
    v_smfmac_f32_32x32x32_bf16 v[192:207], v[148:151], v[224:231], v154
    v_exp_f32 v235, v235
    v_exp_f32 v236, v236
    v_exp_f32 v237, v237
    v_exp_f32 v238, v238
    v_exp_f32 v239, v239
    v_exp_f32 v208, v208
    v_exp_f32 v209, v209
    v_smfmac_f32_32x32x32_bf16 v[192:207], v[140:143], v[232:239], v154
    v_exp_f32 v210, v210
    v_exp_f32 v211, v211
    v_exp_f32 v212, v212
    s_mov_b64 exec, s[88:89]
    ds_read_b128 v[140:143], v25 offset:26112
    ds_read_b128 v[148:151], v25 offset:27648
    s_mov_b64 exec, -1
    v_mfma_f32_32x32x16_bf16 v[224:239], v[136:139], v[132:135], 4.0
    v_exp_f32 v213, v213
    v_exp_f32 v214, v214
    v_exp_f32 v215, v215
    s_add_u32 s85, s85, 8192
    s_add_u32 m0, s83, 0
    s_and_b32 s85, s85, 0xffff
    buffer_load_dwordx4 v26, s[52:55], s85 offen sc1 lds
    v_exp_f32 v216, v216
    v_exp_f32 v217, v217
    v_exp_f32 v218, v218
    ds_read_b128 v[136:139], v24 offset:26624
    v_smfmac_f32_32x32x32_bf16 v[176:191], v[144:147], v[208:215], v154
    v_exp_f32 v219, v219
    v_exp_f32 v220, v220
    v_exp_f32 v221, v221
    buffer_load_dwordx4 v26, s[52:55], s85 offen offset:1024 sc1 lds
    v_exp_f32 v222, v222
    v_exp_f32 v223, v223
    v_exp_f32 v224, v224
    v_exp_f32 v225, v225
    s_waitcnt lgkmcnt(0)
    v_smfmac_f32_32x32x32_bf16 v[176:191], v[140:143], v[216:223], v154
    v_exp_f32 v226, v226
    v_exp_f32 v227, v227
    v_exp_f32 v228, v228
    v_mfma_f32_32x32x16_bf16 v[208:223], v[136:139], v[128:131], 4.0
    v_exp_f32 v229, v229
    v_exp_f32 v230, v230
    v_exp_f32 v231, v231
    v_exp_f32 v232, v232
    v_exp_f32 v233, v233
    v_exp_f32 v234, v234
    s_add_u32 s85, s85, 8192
    s_add_u32 m0, s83, 8192
    s_and_b32 s85, s85, 0xffff
    buffer_load_dwordx4 v26, s[52:55], s85 offen sc1 lds
    v_smfmac_f32_32x32x32_bf16 v[192:207], v[144:147], v[224:231], v154
    v_exp_f32 v235, v235
    v_exp_f32 v236, v236
    v_exp_f32 v237, v237
    buffer_load_dwordx4 v26, s[52:55], s85 offen offset:1024 sc1 lds
    v_exp_f32 v238, v238
    v_exp_f32 v239, v239
    v_exp_f32 v208, v208
    v_exp_f32 v209, v209
    v_smfmac_f32_32x32x32_bf16 v[192:207], v[140:143], v[232:239], v154
    v_exp_f32 v210, v210
    v_exp_f32 v211, v211
    v_exp_f32 v212, v212
    s_mov_b64 exec, s[88:89]
    ds_read_b128 v[140:143], v25 offset:28160
    ds_read_b128 v[144:147], v25 offset:29696
    s_mov_b64 exec, -1
    v_mfma_f32_32x32x16_bf16 v[224:239], v[136:139], v[132:135], 4.0
    v_exp_f32 v213, v213
    v_exp_f32 v214, v214
    v_exp_f32 v215, v215
    v_exp_f32 v216, v216
    v_exp_f32 v217, v217
    v_exp_f32 v218, v218
    ds_read_b128 v[136:139], v24 offset:28672
    v_smfmac_f32_32x32x32_bf16 v[176:191], v[148:151], v[208:215], v154
    v_exp_f32 v219, v219
    v_exp_f32 v220, v220
    v_exp_f32 v221, v221
    v_exp_f32 v222, v222
    v_exp_f32 v223, v223
    v_exp_f32 v224, v224
    v_exp_f32 v225, v225
    s_waitcnt lgkmcnt(0)
    v_smfmac_f32_32x32x32_bf16 v[176:191], v[140:143], v[216:223], v154
    v_exp_f32 v226, v226
    v_exp_f32 v227, v227
    v_exp_f32 v228, v228
    v_mfma_f32_32x32x16_bf16 v[208:223], v[136:139], v[128:131], 4.0
    v_exp_f32 v229, v229
    v_exp_f32 v230, v230
    v_exp_f32 v231, v231
    s_mov_b64 exec, 15
    buffer_load_dwordx4 v[164:167], v163, s[52:55], s97 offen sc1
    s_mov_b64 exec, -1
    v_exp_f32 v232, v232
    v_exp_f32 v233, v233
    v_exp_f32 v234, v234
    v_smfmac_f32_32x32x32_bf16 v[192:207], v[148:151], v[224:231], v154
    v_exp_f32 v235, v235
    v_exp_f32 v236, v236
    v_exp_f32 v237, v237
    v_exp_f32 v238, v238
    v_exp_f32 v239, v239
    v_exp_f32 v208, v208
    v_exp_f32 v209, v209
    v_smfmac_f32_32x32x32_bf16 v[192:207], v[140:143], v[232:239], v154
    v_exp_f32 v210, v210
    v_exp_f32 v211, v211
    v_exp_f32 v212, v212
    s_mov_b64 exec, s[88:89]
    ds_read_b128 v[140:143], v25 offset:30208
    ds_read_b128 v[148:151], v25 offset:31744
    s_mov_b64 exec, -1
    v_mfma_f32_32x32x16_bf16 v[224:239], v[136:139], v[132:135], 4.0
    v_exp_f32 v213, v213
    v_exp_f32 v214, v214
    v_exp_f32 v215, v215
    v_exp_f32 v216, v216
    v_exp_f32 v217, v217
    v_exp_f32 v218, v218
    ds_read_b128 v[136:139], v24 offset:30720
    v_smfmac_f32_32x32x32_bf16 v[176:191], v[144:147], v[208:215], v154
    v_exp_f32 v219, v219
    v_exp_f32 v220, v220
    v_exp_f32 v221, v221
    v_exp_f32 v222, v222
    v_exp_f32 v223, v223
    v_exp_f32 v224, v224
    v_exp_f32 v225, v225
    s_waitcnt lgkmcnt(0)
    v_smfmac_f32_32x32x32_bf16 v[176:191], v[140:143], v[216:223], v154
    v_exp_f32 v226, v226
    v_exp_f32 v227, v227
    v_exp_f32 v228, v228
    s_setprio 2
    v_mfma_f32_32x32x16_bf16 v[208:223], v[136:139], v[128:131], 4.0
    v_exp_f32 v229, v229
    v_exp_f32 v230, v230
    v_exp_f32 v231, v231
    s_waitcnt vmcnt(0)
    s_mov_b64 exec, 15
    v_min3_u32 v164, v164, v165, v166
    v_min_u32 v164, v164, v167
    v_cmp_ne_u32 vcc, 1, v164
    s_cbranch_vccnz L_s2retry
L_s2done:
    s_mov_b64 exec, -1
    buffer_load_dword v152, v152, s[52:55], s79 offen sc1
    v_exp_f32 v232, v232
    v_exp_f32 v233, v233
    v_exp_f32 v234, v234
    buffer_load_dwordx4 v[32:35], v161, s[52:55], s99 offen sc1
    v_smfmac_f32_32x32x32_bf16 v[192:207], v[144:147], v[224:231], v154
    v_exp_f32 v235, v235
    v_exp_f32 v236, v236
    v_exp_f32 v237, v237
    buffer_load_dwordx4 v[36:39], v162, s[52:55], s99 offen sc1
    v_exp_f32 v238, v238
    v_exp_f32 v239, v239
    v_exp_f32 v208, v208
    v_exp_f32 v209, v209
    v_smfmac_f32_32x32x32_bf16 v[192:207], v[140:143], v[232:239], v154
    v_exp_f32 v210, v210
    v_exp_f32 v211, v211
    v_exp_f32 v212, v212
    s_mov_b64 exec, s[88:89]
    ds_read_b128 v[140:143], v25 offset:32256
    ds_read_b128 v[144:147], v25 offset:33792
    s_mov_b64 exec, -1
    v_mfma_f32_32x32x16_bf16 v[224:239], v[136:139], v[132:135], 4.0
    v_exp_f32 v213, v213
    v_exp_f32 v214, v214
    v_exp_f32 v215, v215
    buffer_load_dwordx4 v[40:43], v161, s[52:55], s44 offen sc1
    v_exp_f32 v216, v216
    v_exp_f32 v217, v217
    v_exp_f32 v218, v218
    buffer_load_dwordx4 v[44:47], v162, s[52:55], s44 offen sc1
    ds_read_b128 v[136:139], v24 offset:32768
    v_smfmac_f32_32x32x32_bf16 v[176:191], v[148:151], v[208:215], v154
    v_exp_f32 v219, v219
    v_exp_f32 v220, v220
    v_exp_f32 v221, v221
    v_exp_f32 v222, v222
    v_exp_f32 v223, v223
    v_exp_f32 v224, v224
    v_exp_f32 v225, v225
    s_waitcnt lgkmcnt(0)
    v_smfmac_f32_32x32x32_bf16 v[176:191], v[140:143], v[216:223], v154
    v_exp_f32 v226, v226
    v_exp_f32 v227, v227
    v_exp_f32 v228, v228
    buffer_load_dwordx4 v[48:51], v161, s[52:55], s45 offen sc1
    v_mfma_f32_32x32x16_bf16 v[208:223], v[136:139], v[128:131], 4.0
    v_exp_f32 v229, v229
    v_exp_f32 v230, v230
    v_exp_f32 v231, v231
    s_waitcnt vmcnt(3)
    ds_read_b64_tr_b16 v[240:241], v159 offset:0
    ds_read_b64_tr_b16 v[242:243], v159 offset:512
    buffer_load_dwordx4 v[52:55], v162, s[52:55], s45 offen sc1
    v_exp_f32 v232, v232
    v_exp_f32 v233, v233
    v_exp_f32 v234, v234
    ds_read_b64_tr_b16 v[244:245], v160 offset:0
    ds_read_b64_tr_b16 v[246:247], v160 offset:512
    v_smfmac_f32_32x32x32_bf16 v[192:207], v[148:151], v[224:231], v154
    v_exp_f32 v235, v235
    v_exp_f32 v236, v236
    v_exp_f32 v237, v237
    v_exp_f32 v238, v238
    v_exp_f32 v239, v239
    v_exp_f32 v208, v208
    v_exp_f32 v209, v209
    v_smfmac_f32_32x32x32_bf16 v[192:207], v[140:143], v[232:239], v154
    v_exp_f32 v210, v210
    v_exp_f32 v211, v211
    v_exp_f32 v212, v212
    s_mov_b64 exec, s[88:89]
    ds_read_b128 v[140:143], v25 offset:34304
    ds_read_b128 v[148:151], v25 offset:35840
    s_mov_b64 exec, -1
    v_mfma_f32_32x32x16_bf16 v[224:239], v[136:139], v[132:135], 4.0
    v_exp_f32 v213, v213
    v_exp_f32 v214, v214
    v_exp_f32 v215, v215
    s_waitcnt lgkmcnt(2)
    v_mfma_f32_32x32x16_bf16 v[64:79], v[240:243], v[32:35], 0
    v_exp_f32 v216, v216
    v_exp_f32 v217, v217
    v_exp_f32 v218, v218
    ds_read_b128 v[136:139], v24 offset:34816
    v_smfmac_f32_32x32x32_bf16 v[176:191], v[144:147], v[208:215], v154
    v_exp_f32 v219, v219
    v_exp_f32 v220, v220
    v_exp_f32 v221, v221
    s_add_u32 m0, s100, 0
    s_sub_u32 s99, s47, 16384
    s_cselect_b32 s99, 212992, s99
    buffer_load_dwordx4 v0, s[60:63], s99 offen lds
    v_mfma_f32_32x32x16_bf16 v[80:95], v[244:247], v[32:35], 0
    v_exp_f32 v222, v222
    v_exp_f32 v223, v223
    v_exp_f32 v224, v224
    v_exp_f32 v225, v225
    s_waitcnt lgkmcnt(0)
    v_smfmac_f32_32x32x32_bf16 v[176:191], v[140:143], v[216:223], v154
    v_exp_f32 v226, v226
    v_exp_f32 v227, v227
    v_exp_f32 v228, v228
    buffer_load_dwordx4 v158, s[60:63], s99 offen offset:1024 lds
    v_mfma_f32_32x32x16_bf16 v[208:223], v[136:139], v[128:131], 4.0
    v_exp_f32 v229, v229
    v_exp_f32 v230, v230
    v_exp_f32 v231, v231
    buffer_load_dwordx4 v[56:59], v161, s[52:55], s47 offen sc1
    v_mfma_f32_32x32x16_bf16 v[96:111], v[240:243], v[36:39], 0
    v_exp_f32 v232, v232
    v_exp_f32 v233, v233
    v_exp_f32 v234, v234
    s_waitcnt vmcnt(5)
    ds_read_b64_tr_b16 v[248:249], v159 offset:2048
    ds_read_b64_tr_b16 v[250:251], v159 offset:2560
    v_smfmac_f32_32x32x32_bf16 v[192:207], v[144:147], v[224:231], v154
    v_exp_f32 v235, v235
    v_exp_f32 v236, v236
    v_exp_f32 v237, v237
    ds_read_b64_tr_b16 v[252:253], v160 offset:2048
    ds_read_b64_tr_b16 v[254:255], v160 offset:2560
    buffer_load_dwordx4 v[60:63], v162, s[52:55], s47 offen sc1
    v_mfma_f32_32x32x16_bf16 v[112:127], v[244:247], v[36:39], 0
    v_exp_f32 v238, v238
    v_exp_f32 v239, v239
    v_exp_f32 v208, v208
    v_exp_f32 v209, v209
    v_smfmac_f32_32x32x32_bf16 v[192:207], v[140:143], v[232:239], v154
    v_exp_f32 v210, v210
    v_exp_f32 v211, v211
    v_exp_f32 v212, v212
    s_mov_b64 exec, s[88:89]
    ds_read_b128 v[140:143], v25 offset:36352
    ds_read_b128 v[144:147], v25 offset:37888
    s_mov_b64 exec, -1
    v_mfma_f32_32x32x16_bf16 v[224:239], v[136:139], v[132:135], 4.0
    v_exp_f32 v213, v213
    v_exp_f32 v214, v214
    v_exp_f32 v215, v215
    s_waitcnt lgkmcnt(2)
    v_mfma_f32_32x32x16_bf16 v[64:79], v[248:251], v[40:43], v[64:79]
    v_exp_f32 v216, v216
    v_exp_f32 v217, v217
    v_exp_f32 v218, v218
    ds_read_b128 v[136:139], v24 offset:36864
    v_smfmac_f32_32x32x32_bf16 v[176:191], v[148:151], v[208:215], v154
    v_exp_f32 v219, v219
    v_exp_f32 v220, v220
    v_exp_f32 v221, v221
    s_add_u32 m0, s100, 2048
    s_sub_u32 s44, s99, 16384
    s_cselect_b32 s44, 212992, s44
    buffer_load_dwordx4 v0, s[60:63], s44 offen lds
    v_mfma_f32_32x32x16_bf16 v[80:95], v[252:255], v[40:43], v[80:95]
    v_exp_f32 v222, v222
    v_exp_f32 v223, v223
    v_exp_f32 v224, v224
    v_exp_f32 v225, v225
    s_waitcnt lgkmcnt(0)
    v_smfmac_f32_32x32x32_bf16 v[176:191], v[140:143], v[216:223], v154
    v_exp_f32 v226, v226
    v_exp_f32 v227, v227
    v_exp_f32 v228, v228
    buffer_load_dwordx4 v158, s[60:63], s44 offen offset:1024 lds
    v_mfma_f32_32x32x16_bf16 v[208:223], v[136:139], v[128:131], 4.0
    v_exp_f32 v229, v229
    v_exp_f32 v230, v230
    v_exp_f32 v231, v231
    buffer_load_dwordx4 v[32:35], v161, s[52:55], s99 offen sc1
    v_mfma_f32_32x32x16_bf16 v[96:111], v[248:251], v[44:47], v[96:111]
    v_exp_f32 v232, v232
    v_exp_f32 v233, v233
    v_exp_f32 v234, v234
    s_waitcnt vmcnt(7)
    ds_read_b64_tr_b16 v[240:241], v159 offset:4096
    ds_read_b64_tr_b16 v[242:243], v159 offset:4608
    v_smfmac_f32_32x32x32_bf16 v[192:207], v[148:151], v[224:231], v154
    v_exp_f32 v235, v235
    v_exp_f32 v236, v236
    v_exp_f32 v237, v237
    ds_read_b64_tr_b16 v[244:245], v160 offset:4096
    ds_read_b64_tr_b16 v[246:247], v160 offset:4608
    buffer_load_dwordx4 v[36:39], v162, s[52:55], s99 offen sc1
    v_exp_f32 v238, v238
    v_exp_f32 v239, v239
    v_exp_f32 v208, v208
    v_exp_f32 v209, v209
    v_smfmac_f32_32x32x32_bf16 v[192:207], v[140:143], v[232:239], v154
    v_exp_f32 v210, v210
    v_exp_f32 v211, v211
    v_exp_f32 v212, v212
    s_mov_b64 exec, s[88:89]
    ds_read_b128 v[140:143], v25 offset:38400
    ds_read_b128 v[148:151], v25 offset:39936
    s_mov_b64 exec, -1
    v_mfma_f32_32x32x16_bf16 v[224:239], v[136:139], v[132:135], 4.0
    v_exp_f32 v213, v213
    v_exp_f32 v214, v214
    v_exp_f32 v215, v215
    v_mfma_f32_32x32x16_bf16 v[112:127], v[252:255], v[44:47], v[112:127]
    v_exp_f32 v216, v216
    v_exp_f32 v217, v217
    v_exp_f32 v218, v218
    ds_read_b128 v[136:139], v24 offset:38912
    v_smfmac_f32_32x32x32_bf16 v[176:191], v[144:147], v[208:215], v154
    v_exp_f32 v219, v219
    v_exp_f32 v220, v220
    v_exp_f32 v221, v221
    s_waitcnt lgkmcnt(3)
    v_mfma_f32_32x32x16_bf16 v[64:79], v[240:243], v[48:51], v[64:79]
    v_exp_f32 v222, v222
    v_exp_f32 v223, v223
    v_exp_f32 v224, v224
    v_exp_f32 v225, v225
    s_waitcnt lgkmcnt(0)
    v_smfmac_f32_32x32x32_bf16 v[176:191], v[140:143], v[216:223], v154
    v_exp_f32 v226, v226
    v_exp_f32 v227, v227
    v_exp_f32 v228, v228
    s_add_u32 m0, s100, 4096
    s_sub_u32 s45, s44, 16384
    s_cselect_b32 s45, 212992, s45
    buffer_load_dwordx4 v0, s[60:63], s45 offen lds
    v_mfma_f32_32x32x16_bf16 v[208:223], v[136:139], v[128:131], 4.0
    v_exp_f32 v229, v229
    v_exp_f32 v230, v230
    v_exp_f32 v231, v231
    buffer_load_dwordx4 v158, s[60:63], s45 offen offset:1024 lds
    v_mfma_f32_32x32x16_bf16 v[80:95], v[244:247], v[48:51], v[80:95]
    v_exp_f32 v232, v232
    v_exp_f32 v233, v233
    v_exp_f32 v234, v234
    buffer_load_dwordx4 v[40:43], v161, s[52:55], s44 offen sc1
    v_smfmac_f32_32x32x32_bf16 v[192:207], v[144:147], v[224:231], v154
    v_exp_f32 v235, v235
    v_exp_f32 v236, v236
    v_exp_f32 v237, v237
    buffer_load_dwordx4 v[44:47], v162, s[52:55], s44 offen sc1
    v_mfma_f32_32x32x16_bf16 v[96:111], v[240:243], v[52:55], v[96:111]
    v_exp_f32 v238, v238
    v_exp_f32 v239, v239
    v_exp_f32 v208, v208
    v_exp_f32 v209, v209
    s_waitcnt vmcnt(8)
    ds_read_b64_tr_b16 v[248:249], v159 offset:6144
    ds_read_b64_tr_b16 v[250:251], v159 offset:6656
    s_setprio 1
    v_smfmac_f32_32x32x32_bf16 v[192:207], v[140:143], v[232:239], v154
    v_exp_f32 v210, v210
    v_exp_f32 v211, v211
    v_exp_f32 v212, v212
    ds_read_b64_tr_b16 v[252:253], v160 offset:6144
    ds_read_b64_tr_b16 v[254:255], v160 offset:6656
    s_mov_b64 exec, s[88:89]
    ds_read_b128 v[140:143], v25 offset:40448
    ds_read_b128 v[144:147], v25 offset:41984
    s_mov_b64 exec, -1
    v_mfma_f32_32x32x16_bf16 v[224:239], v[136:139], v[132:135], 4.0
    v_exp_f32 v213, v213
    v_exp_f32 v214, v214
    v_exp_f32 v215, v215
    v_mfma_f32_32x32x16_bf16 v[112:127], v[244:247], v[52:55], v[112:127]
    v_exp_f32 v216, v216
    v_exp_f32 v217, v217
    v_exp_f32 v218, v218
    ds_read_b128 v[136:139], v24 offset:40960
    v_smfmac_f32_32x32x32_bf16 v[176:191], v[148:151], v[208:215], v154
    v_exp_f32 v219, v219
    v_exp_f32 v220, v220
    v_exp_f32 v221, v221
    s_waitcnt lgkmcnt(3)
    v_mfma_f32_32x32x16_bf16 v[64:79], v[248:251], v[56:59], v[64:79]
    v_exp_f32 v222, v222
    v_exp_f32 v223, v223
    v_exp_f32 v224, v224
    v_exp_f32 v225, v225
    s_waitcnt lgkmcnt(0)
    v_smfmac_f32_32x32x32_bf16 v[176:191], v[140:143], v[216:223], v154
    v_exp_f32 v226, v226
    v_exp_f32 v227, v227
    v_exp_f32 v228, v228
    s_add_u32 m0, s100, 6144
    s_sub_u32 s47, s45, 16384
    s_cselect_b32 s47, 212992, s47
    buffer_load_dwordx4 v0, s[60:63], s47 offen lds
    v_mfma_f32_32x32x16_bf16 v[208:223], v[136:139], v[128:131], 4.0
    v_exp_f32 v229, v229
    v_exp_f32 v230, v230
    v_exp_f32 v231, v231
    buffer_load_dwordx4 v158, s[60:63], s47 offen offset:1024 lds
    v_mfma_f32_32x32x16_bf16 v[80:95], v[252:255], v[56:59], v[80:95]
    v_exp_f32 v232, v232
    v_exp_f32 v233, v233
    v_exp_f32 v234, v234
    buffer_load_dwordx4 v[48:51], v161, s[52:55], s45 offen sc1
    v_smfmac_f32_32x32x32_bf16 v[192:207], v[148:151], v[224:231], v154
    v_exp_f32 v235, v235
    v_exp_f32 v236, v236
    v_exp_f32 v237, v237
    buffer_load_dwordx4 v[52:55], v162, s[52:55], s45 offen sc1
    v_exp_f32 v238, v238
    v_exp_f32 v239, v239
    v_exp_f32 v208, v208
    v_exp_f32 v209, v209
    v_smfmac_f32_32x32x32_bf16 v[192:207], v[140:143], v[232:239], v154
    v_exp_f32 v210, v210
    v_exp_f32 v211, v211
    v_exp_f32 v212, v212
    s_mov_b64 exec, s[88:89]
    ds_read_b128 v[140:143], v25 offset:42496
    ds_read_b128 v[148:151], v25 offset:44032
    s_mov_b64 exec, -1
    v_mfma_f32_32x32x16_bf16 v[224:239], v[136:139], v[132:135], 4.0
    v_exp_f32 v213, v213
    v_exp_f32 v214, v214
    v_exp_f32 v215, v215
    v_mfma_f32_32x32x16_bf16 v[96:111], v[248:251], v[60:63], v[96:111]
    v_exp_f32 v216, v216
    v_exp_f32 v217, v217
    v_exp_f32 v218, v218
    s_waitcnt vmcnt(8)
    ds_read_b64_tr_b16 v[240:241], v159 offset:0
    ds_read_b64_tr_b16 v[242:243], v159 offset:512
    ds_read_b128 v[136:139], v24 offset:43008
    v_smfmac_f32_32x32x32_bf16 v[176:191], v[144:147], v[208:215], v154
    v_exp_f32 v219, v219
    v_exp_f32 v220, v220
    v_exp_f32 v221, v221
    ds_read_b64_tr_b16 v[244:245], v160 offset:0
    ds_read_b64_tr_b16 v[246:247], v160 offset:512
    v_mfma_f32_32x32x16_bf16 v[112:127], v[252:255], v[60:63], v[112:127]
    v_exp_f32 v222, v222
    v_exp_f32 v223, v223
    v_exp_f32 v224, v224
    v_exp_f32 v225, v225
    s_waitcnt lgkmcnt(2)
    v_smfmac_f32_32x32x32_bf16 v[176:191], v[140:143], v[216:223], v154
    v_exp_f32 v226, v226
    v_exp_f32 v227, v227
    v_exp_f32 v228, v228
    v_mfma_f32_32x32x16_bf16 v[208:223], v[136:139], v[128:131], 4.0
    v_exp_f32 v229, v229
    v_exp_f32 v230, v230
    v_exp_f32 v231, v231
    s_waitcnt lgkmcnt(0)
    v_mfma_f32_32x32x16_bf16 v[64:79], v[240:243], v[32:35], v[64:79]
    v_exp_f32 v232, v232
    v_exp_f32 v233, v233
    v_exp_f32 v234, v234
    s_add_u32 m0, s100, 0
    s_sub_u32 s99, s47, 16384
    s_cselect_b32 s99, 212992, s99
    buffer_load_dwordx4 v0, s[60:63], s99 offen lds
    s_setprio 0
    v_smfmac_f32_32x32x32_bf16 v[192:207], v[144:147], v[224:231], v154
    v_exp_f32 v235, v235
    v_exp_f32 v236, v236
    v_exp_f32 v237, v237
    buffer_load_dwordx4 v158, s[60:63], s99 offen offset:1024 lds
    v_mfma_f32_32x32x16_bf16 v[80:95], v[244:247], v[32:35], v[80:95]
    v_exp_f32 v238, v238
    v_exp_f32 v239, v239
    v_exp_f32 v208, v208
    v_exp_f32 v209, v209
    buffer_load_dwordx4 v[56:59], v161, s[52:55], s47 offen sc1
    v_smfmac_f32_32x32x32_bf16 v[192:207], v[140:143], v[232:239], v154
    v_exp_f32 v210, v210
    v_exp_f32 v211, v211
    v_exp_f32 v212, v212
    s_mov_b64 exec, s[88:89]
    ds_read_b128 v[140:143], v25 offset:44544
    ds_read_b128 v[144:147], v25 offset:46080
    s_mov_b64 exec, -1
    v_mfma_f32_32x32x16_bf16 v[224:239], v[136:139], v[132:135], 4.0
    v_exp_f32 v213, v213
    v_exp_f32 v214, v214
    v_exp_f32 v215, v215
    buffer_load_dwordx4 v[60:63], v162, s[52:55], s47 offen sc1
    v_mfma_f32_32x32x16_bf16 v[96:111], v[240:243], v[36:39], v[96:111]
    v_exp_f32 v216, v216
    v_exp_f32 v217, v217
    v_exp_f32 v218, v218
    s_waitcnt vmcnt(8)
    ds_read_b64_tr_b16 v[248:249], v159 offset:2048
    ds_read_b64_tr_b16 v[250:251], v159 offset:2560
    ds_read_b128 v[136:139], v24 offset:45056
    v_smfmac_f32_32x32x32_bf16 v[176:191], v[148:151], v[208:215], v154
    v_exp_f32 v219, v219
    v_exp_f32 v220, v220
    v_exp_f32 v221, v221
    ds_read_b64_tr_b16 v[252:253], v160 offset:2048
    ds_read_b64_tr_b16 v[254:255], v160 offset:2560
    v_mfma_f32_32x32x16_bf16 v[112:127], v[244:247], v[36:39], v[112:127]
    v_exp_f32 v222, v222
    v_exp_f32 v223, v223
    v_exp_f32 v224, v224
    v_exp_f32 v225, v225
    s_waitcnt lgkmcnt(2)
    v_smfmac_f32_32x32x32_bf16 v[176:191], v[140:143], v[216:223], v154
    v_exp_f32 v226, v226
    v_exp_f32 v227, v227
    v_exp_f32 v228, v228
    v_mfma_f32_32x32x16_bf16 v[208:223], v[136:139], v[128:131], 4.0
    v_exp_f32 v229, v229
    v_exp_f32 v230, v230
    v_exp_f32 v231, v231
    s_waitcnt lgkmcnt(0)
    v_mfma_f32_32x32x16_bf16 v[64:79], v[248:251], v[40:43], v[64:79]
    v_exp_f32 v232, v232
    v_exp_f32 v233, v233
    v_exp_f32 v234, v234
    s_add_u32 m0, s100, 2048
    s_sub_u32 s44, s99, 16384
    s_cselect_b32 s44, 212992, s44
    buffer_load_dwordx4 v0, s[60:63], s44 offen lds
    v_smfmac_f32_32x32x32_bf16 v[192:207], v[148:151], v[224:231], v154
    v_exp_f32 v235, v235
    v_exp_f32 v236, v236
    v_exp_f32 v237, v237
    buffer_load_dwordx4 v158, s[60:63], s44 offen offset:1024 lds
    v_exp_f32 v238, v238
    v_exp_f32 v239, v239
    s_barrier
    s_setprio 3
    v_exp_f32 v208, v208
    v_exp_f32 v209, v209
    buffer_load_dwordx4 v[32:35], v161, s[52:55], s99 offen sc1
    v_smfmac_f32_32x32x32_bf16 v[192:207], v[140:143], v[232:239], v154
    v_exp_f32 v210, v210
    v_exp_f32 v211, v211
    v_exp_f32 v212, v212
    s_mov_b64 exec, s[88:89]
    ds_read_b128 v[140:143], v25 offset:46592
    ds_read_b128 v[148:151], v25 offset:48128
    s_mov_b64 exec, -1
    v_mfma_f32_32x32x16_bf16 v[224:239], v[136:139], v[132:135], 4.0
    v_exp_f32 v213, v213
    v_exp_f32 v214, v214
    v_exp_f32 v215, v215
    buffer_load_dwordx4 v[36:39], v162, s[52:55], s99 offen sc1
    v_mfma_f32_32x32x16_bf16 v[80:95], v[252:255], v[40:43], v[80:95]
    v_exp_f32 v216, v216
    v_exp_f32 v217, v217
    v_exp_f32 v218, v218
    ds_read_b128 v[136:139], v24 offset:47104
    v_smfmac_f32_32x32x32_bf16 v[176:191], v[144:147], v[208:215], v154
    v_exp_f32 v219, v219
    v_exp_f32 v220, v220
    v_exp_f32 v221, v221
    v_mfma_f32_32x32x16_bf16 v[96:111], v[248:251], v[44:47], v[96:111]
    v_exp_f32 v222, v222
    v_exp_f32 v223, v223
    v_exp_f32 v224, v224
    v_exp_f32 v225, v225
    s_waitcnt vmcnt(8)
    ds_read_b64_tr_b16 v[240:241], v159 offset:4096
    ds_read_b64_tr_b16 v[242:243], v159 offset:4608
    s_waitcnt lgkmcnt(2)
    v_smfmac_f32_32x32x32_bf16 v[176:191], v[140:143], v[216:223], v154
    v_exp_f32 v226, v226
    v_exp_f32 v227, v227
    v_exp_f32 v228, v228
    ds_read_b64_tr_b16 v[244:245], v160 offset:4096
    ds_read_b64_tr_b16 v[246:247], v160 offset:4608
    v_mfma_f32_32x32x16_bf16 v[208:223], v[136:139], v[128:131], 4.0
    v_exp_f32 v229, v229
    v_exp_f32 v230, v230
    v_exp_f32 v231, v231
    v_mfma_f32_32x32x16_bf16 v[112:127], v[252:255], v[44:47], v[112:127]
    v_exp_f32 v232, v232
    v_exp_f32 v233, v233
    v_exp_f32 v234, v234
    v_smfmac_f32_32x32x32_bf16 v[192:207], v[144:147], v[224:231], v154
    v_exp_f32 v235, v235
    v_exp_f32 v236, v236
    v_exp_f32 v237, v237
    s_waitcnt lgkmcnt(0)
    v_mfma_f32_32x32x16_bf16 v[64:79], v[240:243], v[48:51], v[64:79]
    v_exp_f32 v238, v238
    v_exp_f32 v239, v239
    v_exp_f32 v208, v208
    v_exp_f32 v209, v209
    s_add_u32 m0, s100, 4096
    s_sub_u32 s45, s44, 16384
    s_cselect_b32 s45, 212992, s45
    buffer_load_dwordx4 v0, s[60:63], s45 offen lds
    v_smfmac_f32_32x32x32_bf16 v[192:207], v[140:143], v[232:239], v154
    v_exp_f32 v210, v210
    v_exp_f32 v211, v211
    v_exp_f32 v212, v212
    s_mov_b64 exec, s[88:89]
    ds_read_b128 v[140:143], v25 offset:48640
    ds_read_b128 v[144:147], v25 offset:1024
    s_mov_b64 exec, -1
    v_mfma_f32_32x32x16_bf16 v[224:239], v[136:139], v[132:135], 4.0
    v_exp_f32 v213, v213
    v_exp_f32 v214, v214
    v_exp_f32 v215, v215
    buffer_load_dwordx4 v158, s[60:63], s45 offen offset:1024 lds
    v_mfma_f32_32x32x16_bf16 v[80:95], v[244:247], v[48:51], v[80:95]
    v_exp_f32 v216, v216
    v_exp_f32 v217, v217
    v_exp_f32 v218, v218
    ds_read_b128 v[136:139], v24 offset:0
    v_smfmac_f32_32x32x32_bf16 v[176:191], v[148:151], v[208:215], v154
    v_exp_f32 v219, v219
    v_exp_f32 v220, v220
    v_exp_f32 v221, v221
    buffer_load_dwordx4 v[40:43], v161, s[52:55], s44 offen sc1
    v_mfma_f32_32x32x16_bf16 v[96:111], v[240:243], v[52:55], v[96:111]
    v_exp_f32 v222, v222
    v_exp_f32 v223, v223
    v_exp_f32 v224, v224
    v_exp_f32 v225, v225
    s_waitcnt lgkmcnt(0)
    v_smfmac_f32_32x32x32_bf16 v[176:191], v[140:143], v[216:223], v154
    v_exp_f32 v226, v226
    v_exp_f32 v227, v227
    v_exp_f32 v228, v228
    s_waitcnt vmcnt(7)
    ds_read_b64_tr_b16 v[248:249], v159 offset:6144
    ds_read_b64_tr_b16 v[250:251], v159 offset:6656
    buffer_load_dwordx4 v[44:47], v162, s[52:55], s44 offen sc1
    v_mfma_f32_32x32x16_bf16 v[208:223], v[136:139], v[128:131], 4.0
    v_exp_f32 v229, v229
    v_exp_f32 v230, v230
    v_exp_f32 v231, v231
    ds_read_b64_tr_b16 v[252:253], v160 offset:6144
    ds_read_b64_tr_b16 v[254:255], v160 offset:6656
    v_mfma_f32_32x32x16_bf16 v[112:127], v[244:247], v[52:55], v[112:127]
    v_exp_f32 v232, v232
    v_exp_f32 v233, v233
    v_exp_f32 v234, v234
    v_smfmac_f32_32x32x32_bf16 v[192:207], v[148:151], v[224:231], v154
    v_exp_f32 v235, v235
    v_exp_f32 v236, v236
    v_exp_f32 v237, v237
    v_exp_f32 v238, v238
    v_exp_f32 v239, v239
    v_exp_f32 v208, v208
    v_exp_f32 v209, v209
    v_smfmac_f32_32x32x32_bf16 v[192:207], v[140:143], v[232:239], v154
    v_exp_f32 v210, v210
    v_exp_f32 v211, v211
    v_exp_f32 v212, v212
    s_mov_b64 exec, s[88:89]
    ds_read_b128 v[140:143], v25 offset:1536
    ds_read_b128 v[148:151], v25 offset:3072
    s_mov_b64 exec, -1
    v_mfma_f32_32x32x16_bf16 v[224:239], v[136:139], v[132:135], 4.0
    v_exp_f32 v213, v213
    v_exp_f32 v214, v214
    v_exp_f32 v215, v215
    s_waitcnt lgkmcnt(2)
    v_mfma_f32_32x32x16_bf16 v[64:79], v[248:251], v[56:59], v[64:79]
    v_exp_f32 v216, v216
    v_exp_f32 v217, v217
    v_exp_f32 v218, v218
    ds_read_b128 v[136:139], v24 offset:2048
    v_smfmac_f32_32x32x32_bf16 v[176:191], v[144:147], v[208:215], v154
    v_exp_f32 v219, v219
    v_exp_f32 v220, v220
    v_exp_f32 v221, v221
    s_add_u32 m0, s100, 6144
    s_sub_u32 s47, s45, 16384
    s_cselect_b32 s47, 212992, s47
    buffer_load_dwordx4 v0, s[60:63], s47 offen lds
    v_mfma_f32_32x32x16_bf16 v[80:95], v[252:255], v[56:59], v[80:95]
    v_exp_f32 v222, v222
    v_exp_f32 v223, v223
    v_exp_f32 v224, v224
    v_exp_f32 v225, v225
    s_waitcnt lgkmcnt(0)
    v_smfmac_f32_32x32x32_bf16 v[176:191], v[140:143], v[216:223], v154
    v_exp_f32 v226, v226
    v_exp_f32 v227, v227
    v_exp_f32 v228, v228
    buffer_load_dwordx4 v158, s[60:63], s47 offen offset:1024 lds
    v_mfma_f32_32x32x16_bf16 v[208:223], v[136:139], v[128:131], 4.0
    v_exp_f32 v229, v229
    v_exp_f32 v230, v230
    v_exp_f32 v231, v231
    buffer_load_dwordx4 v[48:51], v161, s[52:55], s45 offen sc1
    v_mfma_f32_32x32x16_bf16 v[96:111], v[248:251], v[60:63], v[96:111]
    v_exp_f32 v232, v232
    v_exp_f32 v233, v233
    v_exp_f32 v234, v234
    s_waitcnt vmcnt(7)
    ds_read_b64_tr_b16 v[240:241], v159 offset:0
    ds_read_b64_tr_b16 v[242:243], v159 offset:512
    v_smfmac_f32_32x32x32_bf16 v[192:207], v[144:147], v[224:231], v154
    v_exp_f32 v235, v235
    v_exp_f32 v236, v236
    v_exp_f32 v237, v237
    ds_read_b64_tr_b16 v[244:245], v160 offset:0
    ds_read_b64_tr_b16 v[246:247], v160 offset:512
    buffer_load_dwordx4 v[52:55], v162, s[52:55], s45 offen sc1
    v_mfma_f32_32x32x16_bf16 v[112:127], v[252:255], v[60:63], v[112:127]
    v_exp_f32 v238, v238
    v_exp_f32 v239, v239
    v_exp_f32 v208, v208
    v_exp_f32 v209, v209
    v_smfmac_f32_32x32x32_bf16 v[192:207], v[140:143], v[232:239], v154
    v_exp_f32 v210, v210
    v_exp_f32 v211, v211
    v_exp_f32 v212, v212
    s_mov_b64 exec, s[88:89]
    ds_read_b128 v[140:143], v25 offset:3584
    ds_read_b128 v[144:147], v25 offset:5120
    s_mov_b64 exec, -1
    v_mfma_f32_32x32x16_bf16 v[224:239], v[136:139], v[132:135], 4.0
    v_exp_f32 v213, v213
    v_exp_f32 v214, v214
    v_exp_f32 v215, v215
    s_waitcnt lgkmcnt(2)
    v_mfma_f32_32x32x16_bf16 v[64:79], v[240:243], v[32:35], v[64:79]
    v_exp_f32 v216, v216
    v_exp_f32 v217, v217
    v_exp_f32 v218, v218
    ds_read_b128 v[136:139], v24 offset:4096
    v_smfmac_f32_32x32x32_bf16 v[176:191], v[148:151], v[208:215], v154
    v_exp_f32 v219, v219
    v_exp_f32 v220, v220
    v_exp_f32 v221, v221
    s_add_u32 m0, s100, 0
    s_sub_u32 s99, s47, 16384
    s_cselect_b32 s99, 212992, s99
    buffer_load_dwordx4 v0, s[60:63], s99 offen lds
    v_mfma_f32_32x32x16_bf16 v[80:95], v[244:247], v[32:35], v[80:95]
    v_exp_f32 v222, v222
    v_exp_f32 v223, v223
    v_exp_f32 v224, v224
    v_exp_f32 v225, v225
    s_waitcnt lgkmcnt(0)
    v_smfmac_f32_32x32x32_bf16 v[176:191], v[140:143], v[216:223], v154
    v_exp_f32 v226, v226
    v_exp_f32 v227, v227
    v_exp_f32 v228, v228
    buffer_load_dwordx4 v158, s[60:63], s99 offen offset:1024 lds
    v_mfma_f32_32x32x16_bf16 v[208:223], v[136:139], v[128:131], 4.0
    v_exp_f32 v229, v229
    v_exp_f32 v230, v230
    v_exp_f32 v231, v231
    buffer_load_dwordx4 v[56:59], v161, s[52:55], s47 offen sc1
    v_mfma_f32_32x32x16_bf16 v[96:111], v[240:243], v[36:39], v[96:111]
    v_exp_f32 v232, v232
    v_exp_f32 v233, v233
    v_exp_f32 v234, v234
    s_waitcnt vmcnt(7)
    ds_read_b64_tr_b16 v[248:249], v159 offset:2048
    ds_read_b64_tr_b16 v[250:251], v159 offset:2560
    v_smfmac_f32_32x32x32_bf16 v[192:207], v[148:151], v[224:231], v154
    v_exp_f32 v235, v235
    v_exp_f32 v236, v236
    v_exp_f32 v237, v237
    ds_read_b64_tr_b16 v[252:253], v160 offset:2048
    ds_read_b64_tr_b16 v[254:255], v160 offset:2560
    buffer_load_dwordx4 v[60:63], v162, s[52:55], s47 offen sc1
    v_exp_f32 v238, v238
    v_exp_f32 v239, v239
    v_exp_f32 v208, v208
    v_exp_f32 v209, v209
    v_smfmac_f32_32x32x32_bf16 v[192:207], v[140:143], v[232:239], v154
    v_exp_f32 v210, v210
    v_exp_f32 v211, v211
    v_exp_f32 v212, v212
    s_mov_b64 exec, s[88:89]
    ds_read_b128 v[140:143], v25 offset:5632
    ds_read_b128 v[148:151], v25 offset:7168
    s_mov_b64 exec, -1
    v_mfma_f32_32x32x16_bf16 v[224:239], v[136:139], v[132:135], 4.0
    v_exp_f32 v213, v213
    v_exp_f32 v214, v214
    v_exp_f32 v215, v215
    v_mfma_f32_32x32x16_bf16 v[112:127], v[244:247], v[36:39], v[112:127]
    v_exp_f32 v216, v216
    v_exp_f32 v217, v217
    v_exp_f32 v218, v218
    ds_read_b128 v[136:139], v24 offset:6144
    v_smfmac_f32_32x32x32_bf16 v[176:191], v[144:147], v[208:215], v154
    v_exp_f32 v219, v219
    v_exp_f32 v220, v220
    v_exp_f32 v221, v221
    s_waitcnt lgkmcnt(3)
    v_mfma_f32_32x32x16_bf16 v[64:79], v[248:251], v[40:43], v[64:79]
    v_exp_f32 v222, v222
    v_exp_f32 v223, v223
    v_exp_f32 v224, v224
    v_exp_f32 v225, v225
    s_waitcnt lgkmcnt(0)
    v_smfmac_f32_32x32x32_bf16 v[176:191], v[140:143], v[216:223], v154
    v_exp_f32 v226, v226
    v_exp_f32 v227, v227
    v_exp_f32 v228, v228
    s_add_u32 m0, s100, 2048
    s_sub_u32 s44, s99, 16384
    s_cselect_b32 s44, 212992, s44
    buffer_load_dwordx4 v0, s[60:63], s44 offen lds
    v_mfma_f32_32x32x16_bf16 v[208:223], v[136:139], v[128:131], 4.0
    v_exp_f32 v229, v229
    v_exp_f32 v230, v230
    v_exp_f32 v231, v231
    buffer_load_dwordx4 v158, s[60:63], s44 offen offset:1024 lds
    v_mfma_f32_32x32x16_bf16 v[80:95], v[252:255], v[40:43], v[80:95]
    v_exp_f32 v232, v232
    v_exp_f32 v233, v233
    v_exp_f32 v234, v234
    buffer_load_dwordx4 v[32:35], v161, s[52:55], s99 offen sc1
    v_smfmac_f32_32x32x32_bf16 v[192:207], v[144:147], v[224:231], v154
    v_exp_f32 v235, v235
    v_exp_f32 v236, v236
    v_exp_f32 v237, v237
    buffer_load_dwordx4 v[36:39], v162, s[52:55], s99 offen sc1
    v_mfma_f32_32x32x16_bf16 v[96:111], v[248:251], v[44:47], v[96:111]
    v_exp_f32 v238, v238
    v_exp_f32 v239, v239
    v_exp_f32 v208, v208
    v_exp_f32 v209, v209
    s_waitcnt vmcnt(8)
    ds_read_b64_tr_b16 v[240:241], v159 offset:4096
    ds_read_b64_tr_b16 v[242:243], v159 offset:4608
    v_smfmac_f32_32x32x32_bf16 v[192:207], v[140:143], v[232:239], v154
    v_exp_f32 v210, v210
    v_exp_f32 v211, v211
    v_exp_f32 v212, v212
    ds_read_b64_tr_b16 v[244:245], v160 offset:4096
    ds_read_b64_tr_b16 v[246:247], v160 offset:4608
    s_mov_b64 exec, s[88:89]
    ds_read_b128 v[140:143], v25 offset:7680
    ds_read_b128 v[144:147], v25 offset:9216
    s_mov_b64 exec, -1
    v_mfma_f32_32x32x16_bf16 v[224:239], v[136:139], v[132:135], 4.0
    v_exp_f32 v213, v213
    v_exp_f32 v214, v214
    v_exp_f32 v215, v215
    v_mfma_f32_32x32x16_bf16 v[112:127], v[252:255], v[44:47], v[112:127]
    v_exp_f32 v216, v216
    v_exp_f32 v217, v217
    v_exp_f32 v218, v218
    ds_read_b128 v[136:139], v24 offset:8192
    v_smfmac_f32_32x32x32_bf16 v[176:191], v[148:151], v[208:215], v154
    v_exp_f32 v219, v219
    v_exp_f32 v220, v220
    v_exp_f32 v221, v221
    s_waitcnt lgkmcnt(3)
    v_mfma_f32_32x32x16_bf16 v[64:79], v[240:243], v[48:51], v[64:79]
    v_exp_f32 v222, v222
    v_exp_f32 v223, v223
    v_exp_f32 v224, v224
    v_exp_f32 v225, v225
    s_waitcnt lgkmcnt(0)
    v_smfmac_f32_32x32x32_bf16 v[176:191], v[140:143], v[216:223], v154
    v_exp_f32 v226, v226
    v_exp_f32 v227, v227
    v_exp_f32 v228, v228
    s_add_u32 m0, s100, 4096
    s_lshl_b32 s74, s71, 14
    buffer_load_dwordx4 v0, s[64:67], s74 offen lds
    v_mfma_f32_32x32x16_bf16 v[208:223], v[136:139], v[128:131], 4.0
    v_exp_f32 v229, v229
    v_exp_f32 v230, v230
    v_exp_f32 v231, v231
    buffer_load_dwordx4 v158, s[64:67], s74 offen offset:1024 lds
    v_mfma_f32_32x32x16_bf16 v[80:95], v[244:247], v[48:51], v[80:95]
    v_exp_f32 v232, v232
    v_exp_f32 v233, v233
    v_exp_f32 v234, v234
    buffer_load_dwordx4 v[40:43], v161, s[52:55], s44 offen sc1
    v_smfmac_f32_32x32x32_bf16 v[192:207], v[148:151], v[224:231], v154
    v_exp_f32 v235, v235
    v_exp_f32 v236, v236
    v_exp_f32 v237, v237
    buffer_load_dwordx4 v[44:47], v162, s[52:55], s44 offen sc1
    v_exp_f32 v238, v238
    v_exp_f32 v239, v239
    v_exp_f32 v208, v208
    v_exp_f32 v209, v209
    v_smfmac_f32_32x32x32_bf16 v[192:207], v[140:143], v[232:239], v154
    v_exp_f32 v210, v210
    v_exp_f32 v211, v211
    v_exp_f32 v212, v212
    s_mov_b64 exec, s[88:89]
    ds_read_b128 v[140:143], v25 offset:9728
    ds_read_b128 v[148:151], v25 offset:11264
    s_mov_b64 exec, -1
    v_mfma_f32_32x32x16_bf16 v[224:239], v[136:139], v[132:135], 4.0
    v_exp_f32 v213, v213
    v_exp_f32 v214, v214
    v_exp_f32 v215, v215
    v_mfma_f32_32x32x16_bf16 v[96:111], v[240:243], v[52:55], v[96:111]
    v_exp_f32 v216, v216
    v_exp_f32 v217, v217
    v_exp_f32 v218, v218
    s_waitcnt vmcnt(8)
    ds_read_b64_tr_b16 v[248:249], v159 offset:6144
    ds_read_b64_tr_b16 v[250:251], v159 offset:6656
    ds_read_b128 v[136:139], v24 offset:10240
    v_smfmac_f32_32x32x32_bf16 v[176:191], v[144:147], v[208:215], v154
    v_exp_f32 v219, v219
    v_exp_f32 v220, v220
    v_exp_f32 v221, v221
    ds_read_b64_tr_b16 v[252:253], v160 offset:6144
    ds_read_b64_tr_b16 v[254:255], v160 offset:6656
    v_mfma_f32_32x32x16_bf16 v[112:127], v[244:247], v[52:55], v[112:127]
    v_exp_f32 v222, v222
    v_exp_f32 v223, v223
    v_exp_f32 v224, v224
    v_exp_f32 v225, v225
    s_waitcnt lgkmcnt(2)
    v_smfmac_f32_32x32x32_bf16 v[176:191], v[140:143], v[216:223], v154
    v_exp_f32 v226, v226
    v_exp_f32 v227, v227
    v_exp_f32 v228, v228
    v_mfma_f32_32x32x16_bf16 v[208:223], v[136:139], v[128:131], 4.0
    v_exp_f32 v229, v229
    v_exp_f32 v230, v230
    v_exp_f32 v231, v231
    s_waitcnt lgkmcnt(0)
    v_mfma_f32_32x32x16_bf16 v[64:79], v[248:251], v[56:59], v[64:79]
    v_exp_f32 v232, v232
    v_exp_f32 v233, v233
    v_exp_f32 v234, v234
    s_add_u32 m0, s100, 6144
    s_add_u32 s74, s74, 16384
    s_and_b32 s74, s74, 0xffff
    buffer_load_dwordx4 v0, s[64:67], s74 offen lds
    v_smfmac_f32_32x32x32_bf16 v[192:207], v[144:147], v[224:231], v154
    v_exp_f32 v235, v235
    v_exp_f32 v236, v236
    v_exp_f32 v237, v237
    buffer_load_dwordx4 v158, s[64:67], s74 offen offset:1024 lds
    v_mfma_f32_32x32x16_bf16 v[80:95], v[252:255], v[56:59], v[80:95]
    v_exp_f32 v238, v238
    v_exp_f32 v239, v239
    v_exp_f32 v208, v208
    v_exp_f32 v209, v209
    s_setprio 2
    v_smfmac_f32_32x32x32_bf16 v[192:207], v[140:143], v[232:239], v154
    v_exp_f32 v210, v210
    v_exp_f32 v211, v211
    v_exp_f32 v212, v212
    s_mov_b64 exec, s[88:89]
    ds_read_b128 v[140:143], v25 offset:11776
    ds_read_b128 v[144:147], v25 offset:13312
    s_mov_b64 exec, -1
    v_mfma_f32_32x32x16_bf16 v[224:239], v[136:139], v[132:135], 4.0
    v_exp_f32 v213, v213
    v_exp_f32 v214, v214
    v_exp_f32 v215, v215
    v_mfma_f32_32x32x16_bf16 v[96:111], v[248:251], v[60:63], v[96:111]
    v_exp_f32 v216, v216
    v_exp_f32 v217, v217
    v_exp_f32 v218, v218
    s_waitcnt vmcnt(6)
    ds_read_b64_tr_b16 v[240:241], v159 offset:0
    ds_read_b64_tr_b16 v[242:243], v159 offset:512
    ds_read_b128 v[136:139], v24 offset:12288
    v_smfmac_f32_32x32x32_bf16 v[176:191], v[148:151], v[208:215], v154
    v_exp_f32 v219, v219
    v_exp_f32 v220, v220
    v_exp_f32 v221, v221
    ds_read_b64_tr_b16 v[244:245], v160 offset:0
    ds_read_b64_tr_b16 v[246:247], v160 offset:512
    v_mfma_f32_32x32x16_bf16 v[112:127], v[252:255], v[60:63], v[112:127]
    v_exp_f32 v222, v222
    v_exp_f32 v223, v223
    v_exp_f32 v224, v224
    v_exp_f32 v225, v225
    s_waitcnt lgkmcnt(2)
    v_smfmac_f32_32x32x32_bf16 v[176:191], v[140:143], v[216:223], v154
    v_exp_f32 v226, v226
    v_exp_f32 v227, v227
    v_exp_f32 v228, v228
    v_mfma_f32_32x32x16_bf16 v[208:223], v[136:139], v[128:131], 4.0
    v_exp_f32 v229, v229
    v_exp_f32 v230, v230
    v_exp_f32 v231, v231
    s_waitcnt lgkmcnt(0)
    v_mfma_f32_32x32x16_bf16 v[64:79], v[240:243], v[32:35], v[64:79]
    v_exp_f32 v232, v232
    v_exp_f32 v233, v233
    v_exp_f32 v234, v234
    s_add_u32 m0, s100, 0
    s_add_u32 s74, s74, 16384
    s_and_b32 s74, s74, 0xffff
    buffer_load_dwordx4 v0, s[64:67], s74 offen lds
    v_smfmac_f32_32x32x32_bf16 v[192:207], v[148:151], v[224:231], v154
    v_exp_f32 v235, v235
    v_exp_f32 v236, v236
    v_exp_f32 v237, v237
    buffer_load_dwordx4 v158, s[64:67], s74 offen offset:1024 lds
    v_exp_f32 v238, v238
    v_exp_f32 v239, v239
    v_exp_f32 v208, v208
    v_exp_f32 v209, v209
    v_smfmac_f32_32x32x32_bf16 v[192:207], v[140:143], v[232:239], v154
    v_exp_f32 v210, v210
    v_exp_f32 v211, v211
    v_exp_f32 v212, v212
    s_mov_b64 exec, s[88:89]
    ds_read_b128 v[140:143], v25 offset:13824
    ds_read_b128 v[148:151], v25 offset:15360
    s_mov_b64 exec, -1
    v_mfma_f32_32x32x16_bf16 v[224:239], v[136:139], v[132:135], 4.0
    v_exp_f32 v213, v213
    v_exp_f32 v214, v214
    v_exp_f32 v215, v215
    v_mfma_f32_32x32x16_bf16 v[80:95], v[244:247], v[32:35], v[80:95]
    v_exp_f32 v216, v216
    v_exp_f32 v217, v217
    v_exp_f32 v218, v218
    ds_read_b128 v[136:139], v24 offset:14336
    v_smfmac_f32_32x32x32_bf16 v[176:191], v[144:147], v[208:215], v154
    v_exp_f32 v219, v219
    v_exp_f32 v220, v220
    v_exp_f32 v221, v221
    v_mfma_f32_32x32x16_bf16 v[96:111], v[240:243], v[36:39], v[96:111]
    v_exp_f32 v222, v222
    v_exp_f32 v223, v223
    v_exp_f32 v224, v224
    v_exp_f32 v225, v225
    s_waitcnt vmcnt(4)
    ds_read_b64_tr_b16 v[248:249], v159 offset:2048
    ds_read_b64_tr_b16 v[250:251], v159 offset:2560
    s_waitcnt lgkmcnt(2)
    v_smfmac_f32_32x32x32_bf16 v[176:191], v[140:143], v[216:223], v154
    v_exp_f32 v226, v226
    v_exp_f32 v227, v227
    v_exp_f32 v228, v228
    ds_read_b64_tr_b16 v[252:253], v160 offset:2048
    ds_read_b64_tr_b16 v[254:255], v160 offset:2560
    v_mfma_f32_32x32x16_bf16 v[208:223], v[136:139], v[128:131], 4.0
    v_exp_f32 v229, v229
    v_exp_f32 v230, v230
    v_exp_f32 v231, v231
    s_setprio 1
    v_mfma_f32_32x32x16_bf16 v[112:127], v[244:247], v[36:39], v[112:127]
    v_exp_f32 v232, v232
    v_exp_f32 v233, v233
    v_exp_f32 v234, v234
    v_smfmac_f32_32x32x32_bf16 v[192:207], v[144:147], v[224:231], v154
    v_exp_f32 v235, v235
    v_exp_f32 v236, v236
    v_exp_f32 v237, v237
    s_waitcnt lgkmcnt(0)
    v_mfma_f32_32x32x16_bf16 v[64:79], v[248:251], v[40:43], v[64:79]
    v_exp_f32 v238, v238
    v_exp_f32 v239, v239
    v_exp_f32 v208, v208
    v_exp_f32 v209, v209
    s_add_u32 m0, s100, 2048
    s_add_u32 s74, s74, 16384
    s_and_b32 s74, s74, 0xffff
    buffer_load_dwordx4 v0, s[64:67], s74 offen lds
    v_smfmac_f32_32x32x32_bf16 v[192:207], v[140:143], v[232:239], v154
    v_exp_f32 v210, v210
    v_exp_f32 v211, v211
    v_exp_f32 v212, v212
    s_mov_b64 exec, s[88:89]
    ds_read_b128 v[140:143], v25 offset:15872
    s_mov_b64 exec, -1
    v_mfma_f32_32x32x16_bf16 v[224:239], v[136:139], v[132:135], 4.0
    v_exp_f32 v213, v213
    v_exp_f32 v214, v214
    v_exp_f32 v215, v215
    buffer_load_dwordx4 v158, s[64:67], s74 offen offset:1024 lds
    v_mfma_f32_32x32x16_bf16 v[80:95], v[252:255], v[40:43], v[80:95]
    v_exp_f32 v216, v216
    v_exp_f32 v217, v217
    v_exp_f32 v218, v218
    v_smfmac_f32_32x32x32_bf16 v[176:191], v[148:151], v[208:215], v154
    v_exp_f32 v219, v219
    v_exp_f32 v220, v220
    v_exp_f32 v221, v221
    v_mfma_f32_32x32x16_bf16 v[96:111], v[248:251], v[44:47], v[96:111]
    v_exp_f32 v222, v222
    v_exp_f32 v223, v223
    v_exp_f32 v224, v224
    v_exp_f32 v225, v225
    s_waitcnt lgkmcnt(0)
    v_smfmac_f32_32x32x32_bf16 v[176:191], v[140:143], v[216:223], v154
    v_exp_f32 v226, v226
    v_exp_f32 v227, v227
    v_exp_f32 v228, v228
    s_setprio 0
    v_exp_f32 v229, v229
    v_exp_f32 v230, v230
    v_exp_f32 v231, v231
    v_mfma_f32_32x32x16_bf16 v[112:127], v[252:255], v[44:47], v[112:127]
    v_exp_f32 v232, v232
    v_exp_f32 v233, v233
    v_exp_f32 v234, v234
    v_smfmac_f32_32x32x32_bf16 v[192:207], v[148:151], v[224:231], v154
    v_exp_f32 v235, v235
    v_exp_f32 v236, v236
    v_exp_f32 v237, v237
    ds_write_b32 v171, v177 offset:2048
    ds_write2st64_b32 v171, v176, v178 offset0:0 offset1:1
    ds_write2st64_b32 v171, v180, v182 offset0:2 offset1:3
    ds_write2st64_b32 v171, v184, v186 offset0:4 offset1:5
    ds_write2st64_b32 v171, v188, v190 offset0:6 offset1:7
    v_exp_f32 v238, v238
    v_exp_f32 v239, v239
    s_nop 1
    v_smfmac_f32_32x32x32_bf16 v[192:207], v[140:143], v[232:239], v154
    s_waitcnt lgkmcnt(0)
    s_barrier
    ds_read_b32 v216, v172 offset:2048
    ds_read2st64_b32 v[208:209], v172 offset0:0 offset1:1
    ds_read2st64_b32 v[210:211], v172 offset0:2 offset1:3
    ds_read2st64_b32 v[212:213], v172 offset0:4 offset1:5
    ds_read2st64_b32 v[214:215], v172 offset0:6 offset1:7
    s_add_u32 s101, s101, 3145728
    s_mov_b32 s86, 0x21800000
    s_mov_b32 s87, 0x3c000000
    s_lshl_b32 s83, s68, 13
    s_xor_b32 s82, s83, 0x8000
    v_add_u32 v24, s82, v14
    v_add_u32 v26, s83, v14
    s_waitcnt lgkmcnt(4)
    v_add_f32 v216, v193, v216
    v_rcp_f32 v20, v216
    s_waitcnt lgkmcnt(2)
    v_add_f32 v208, v192, v208
    v_add_f32 v209, v194, v209
    v_add_f32 v210, v196, v210
    v_add_f32 v211, v198, v211
    v_mul_f32 v20, v20, v152
    s_waitcnt lgkmcnt(0)
    v_add_f32 v212, v200, v212
    v_add_f32 v213, v202, v213
    v_add_f32 v214, v204, v214
    v_add_f32 v215, v206, v215
    v_pk_mul_f32 v[208:209], v[208:209], v[20:21] op_sel_hi:[1,0]
    v_pk_mul_f32 v[210:211], v[210:211], v[20:21] op_sel_hi:[1,0]
    v_pk_mul_f32 v[212:213], v[212:213], v[20:21] op_sel_hi:[1,0]
    v_pk_mul_f32 v[214:215], v[214:215], v[20:21] op_sel_hi:[1,0]
    v_pk_add_f32 v[22:23], v[208:209], v[210:211]
    v_pk_add_f32 v[20:21], v[212:213], v[214:215]
    v_cvt_pk_bf16_f32 v128, v208, v209
    v_pk_add_f32 v[22:23], v[22:23], v[20:21]
    v_cvt_pk_bf16_f32 v129, v210, v211
    v_add_f32 v22, v22, v23
    v_cvt_pk_bf16_f32 v130, v212, v213
    v_fma_f32 v22, v22, 0, v216
    v_cvt_pk_bf16_f32 v131, v214, v215
    v_subrev_u32 v22, s86, v22
    v_or_b32 v128, 1, v128
    v_cmp_lt_u32 vcc, s87, v22
    s_cbranch_vccnz L_true_max
L_norm:
    buffer_store_dwordx4 v[128:131], v14, s[52:55], s101 offen sc1
    ds_write_b128 v24, v[96:99] offset:0
    s_and_b32 s81, s68, 3
    s_lshl_b32 s82, s81, 13
    s_add_u32 s82, s82, 98304
    v_add_u32 v28, s82, v31
    v_xor_b32 v29, 64, v28
    v_sub_f32 v152, 1.0, v152
    ds_write_b128 v24, v[100:103] offset:1024
    v_add_u32 v27, 0x4000, v14
    s_lshr_b32 s89, s68, 2
    s_lshl1_add_u32 s80, s77, s89
    s_lshl3_add_u32 s80, s80, s81
    s_lshl_b32 s80, s80, 12
    s_add_u32 s80, s80, 3145728
    s_lshl4_add_u32 s88, s89, s81
    ds_write_b128 v24, v[104:107] offset:2048
    s_lshl_b32 s88, s88, 11
    s_add_u32 s81, s71, 0
    s_and_b32 s81, s81, 3
    s_lshl_b32 s81, s81, 10
    s_add_u32 s84, s80, s81
    s_add_u32 s81, s71, 1
    s_and_b32 s81, s81, 3
    ds_write_b128 v24, v[108:111] offset:3072
    s_lshl_b32 s81, s81, 10
    s_add_u32 s85, s80, s81
    s_add_u32 s81, s71, 2
    s_and_b32 s81, s81, 3
    s_lshl_b32 s81, s81, 10
    s_add_u32 s86, s80, s81
    s_add_u32 s81, s71, 3
    ds_write_b128 v24, v[112:115] offset:4096
    s_and_b32 s81, s81, 3
    s_lshl_b32 s81, s81, 10
    s_add_u32 s87, s80, s81
    v_and_b32 v20, 31, v15
    v_lshrrev_b32 v21, 5, v15
    v_and_b32 v22, 7, v15
    ds_write_b128 v24, v[116:119] offset:5120
    v_xor_b32 v21, v21, v22
    v_lshlrev_b32 v21, 4, v21
    v_lshl_add_u32 v20, v20, 8, v21
    v_add_u32 v9, s83, v20
    v_xor_b32 v10, 32, v9
    v_xor_b32 v11, 64, v9
    v_xor_b32 v12, 0x60, v9
    ds_write_b128 v24, v[120:123] offset:6144
    v_lshrrev_b32 v20, 3, v15
    v_lshlrev_b32 v21, 1, v22
    v_xor_b32 v21, v21, v20
    v_lshlrev_b32 v21, 4, v21
    v_lshl_add_u32 v21, v20, 8, v21
    v_add_u32 v1, s88, v21
    v_xor_b32 v2, 16, v1
    ds_write_b128 v24, v[124:127] offset:7168
    s_lshl3_add_u32 s83, s77, s68
    s_lshl_b32 s83, s83, 6
    s_add_u32 s83, s83, s78
    s_lshl_b32 s83, s83, 7
    v_lshlrev_b32 v22, 4, v22
    v_lshl_add_u32 v5, v20, 10, v22
    s_mov_b32 s82, 0
    s_waitcnt vmcnt(1) lgkmcnt(0)
    s_cmp_ge_u32 s68, 4
    s_barrier
    s_setprio 1
    s_cbranch_scc1 L_ol1
    s_setprio 0
    buffer_load_dwordx4 v[32:35], v14, s[52:55], s84 offen sc1
    buffer_load_dwordx4 v[36:39], v14, s[52:55], s85 offen sc1
    buffer_load_dwordx4 v[40:43], v14, s[52:55], s86 offen sc1
    buffer_load_dwordx4 v[44:47], v14, s[52:55], s87 offen sc1
    buffer_load_dwordx4 v[48:51], v27, s[52:55], s84 offen sc1
    buffer_load_dwordx4 v[52:55], v27, s[52:55], s85 offen sc1
    buffer_load_dwordx4 v[56:59], v27, s[52:55], s86 offen sc1
    buffer_load_dwordx4 v[60:63], v27, s[52:55], s87 offen sc1
L_ol1:
    ds_read_b128 v[96:99], v26 offset:0
    ds_read_b128 v[100:103], v26 offset:1024
    ds_read_b128 v[104:107], v26 offset:2048
    ds_read_b128 v[108:111], v26 offset:3072
    ds_read_b128 v[112:115], v26 offset:4096
    ds_read_b128 v[116:119], v26 offset:5120
    ds_read_b128 v[120:123], v26 offset:6144
    ds_read_b128 v[124:127], v26 offset:7168
    s_waitcnt lgkmcnt(7)
    v_pk_add_f32 v[64:65], v[64:65], v[96:97]
    v_pk_add_f32 v[66:67], v[66:67], v[98:99]
    v_pk_mul_f32 v[64:65], v[64:65], v[152:153] op_sel_hi:[1,0]
    v_pk_mul_f32 v[66:67], v[66:67], v[152:153] op_sel_hi:[1,0]
    s_waitcnt lgkmcnt(6)
    v_pk_add_f32 v[68:69], v[68:69], v[100:101]
    v_pk_add_f32 v[70:71], v[70:71], v[102:103]
    v_pk_mul_f32 v[68:69], v[68:69], v[152:153] op_sel_hi:[1,0]
    v_pk_mul_f32 v[70:71], v[70:71], v[152:153] op_sel_hi:[1,0]
    s_waitcnt lgkmcnt(5)
    v_pk_add_f32 v[72:73], v[72:73], v[104:105]
    v_pk_add_f32 v[74:75], v[74:75], v[106:107]
    v_pk_mul_f32 v[72:73], v[72:73], v[152:153] op_sel_hi:[1,0]
    v_pk_mul_f32 v[74:75], v[74:75], v[152:153] op_sel_hi:[1,0]
    s_waitcnt lgkmcnt(4)
    v_pk_add_f32 v[76:77], v[76:77], v[108:109]
    v_pk_add_f32 v[78:79], v[78:79], v[110:111]
    v_pk_mul_f32 v[76:77], v[76:77], v[152:153] op_sel_hi:[1,0]
    v_pk_mul_f32 v[78:79], v[78:79], v[152:153] op_sel_hi:[1,0]
    s_waitcnt lgkmcnt(3)
    v_pk_add_f32 v[80:81], v[80:81], v[112:113]
    v_pk_add_f32 v[82:83], v[82:83], v[114:115]
    v_pk_mul_f32 v[80:81], v[80:81], v[152:153] op_sel_hi:[1,0]
    v_pk_mul_f32 v[82:83], v[82:83], v[152:153] op_sel_hi:[1,0]
    s_waitcnt lgkmcnt(2)
    v_pk_add_f32 v[84:85], v[84:85], v[116:117]
    v_pk_add_f32 v[86:87], v[86:87], v[118:119]
    v_pk_mul_f32 v[84:85], v[84:85], v[152:153] op_sel_hi:[1,0]
    v_pk_mul_f32 v[86:87], v[86:87], v[152:153] op_sel_hi:[1,0]
    s_waitcnt lgkmcnt(1)
    v_pk_add_f32 v[88:89], v[88:89], v[120:121]
    v_pk_add_f32 v[90:91], v[90:91], v[122:123]
    v_pk_mul_f32 v[88:89], v[88:89], v[152:153] op_sel_hi:[1,0]
    v_pk_mul_f32 v[90:91], v[90:91], v[152:153] op_sel_hi:[1,0]
    s_waitcnt lgkmcnt(0)
    v_pk_add_f32 v[92:93], v[92:93], v[124:125]
    v_pk_add_f32 v[94:95], v[94:95], v[126:127]
    v_pk_mul_f32 v[92:93], v[92:93], v[152:153] op_sel_hi:[1,0]
    v_pk_mul_f32 v[94:95], v[94:95], v[152:153] op_sel_hi:[1,0]
    s_setprio 0
    s_cbranch_scc0 L_ol2
    buffer_load_dwordx4 v[32:35], v14, s[52:55], s84 offen sc1
    buffer_load_dwordx4 v[36:39], v14, s[52:55], s85 offen sc1
    buffer_load_dwordx4 v[40:43], v14, s[52:55], s86 offen sc1
    buffer_load_dwordx4 v[44:47], v14, s[52:55], s87 offen sc1
    buffer_load_dwordx4 v[48:51], v27, s[52:55], s84 offen sc1
    buffer_load_dwordx4 v[52:55], v27, s[52:55], s85 offen sc1
    buffer_load_dwordx4 v[56:59], v27, s[52:55], s86 offen sc1
    buffer_load_dwordx4 v[60:63], v27, s[52:55], s87 offen sc1
L_ol2:
    ds_read_b64_tr_b16 v[176:177], v28 offset:4096
    ds_read_b64_tr_b16 v[178:179], v28 offset:4608
    ds_read_b64_tr_b16 v[180:181], v29 offset:4096
    ds_read_b64_tr_b16 v[182:183], v29 offset:4608
    ds_read_b64_tr_b16 v[184:185], v28 offset:6144
    ds_read_b64_tr_b16 v[186:187], v28 offset:6656
    ds_read_b64_tr_b16 v[188:189], v29 offset:6144
    ds_read_b64_tr_b16 v[190:191], v29 offset:6656
    ds_read_b64_tr_b16 v[192:193], v28 offset:0
    ds_read_b64_tr_b16 v[194:195], v28 offset:512
    ds_read_b64_tr_b16 v[196:197], v29 offset:0
    ds_read_b64_tr_b16 v[198:199], v29 offset:512
    ds_read_b64_tr_b16 v[200:201], v28 offset:2048
    ds_read_b64_tr_b16 v[202:203], v28 offset:2560
    ds_read_b64_tr_b16 v[204:205], v29 offset:2048
    ds_read_b64_tr_b16 v[206:207], v29 offset:2560
    ds_read_b64_tr_b16 v[208:209], v28 offset:36864
    ds_read_b64_tr_b16 v[210:211], v28 offset:37376
    ds_read_b64_tr_b16 v[212:213], v29 offset:36864
    ds_read_b64_tr_b16 v[214:215], v29 offset:37376
    ds_read_b64_tr_b16 v[216:217], v28 offset:38912
    ds_read_b64_tr_b16 v[218:219], v28 offset:39424
    ds_read_b64_tr_b16 v[220:221], v29 offset:38912
    ds_read_b64_tr_b16 v[222:223], v29 offset:39424
    ds_read_b64_tr_b16 v[224:225], v28 offset:32768
    ds_read_b64_tr_b16 v[226:227], v28 offset:33280
    ds_read_b64_tr_b16 v[228:229], v29 offset:32768
    ds_read_b64_tr_b16 v[230:231], v29 offset:33280
    ds_read_b64_tr_b16 v[232:233], v28 offset:34816
    ds_read_b64_tr_b16 v[234:235], v28 offset:35328
    ds_read_b64_tr_b16 v[236:237], v29 offset:34816
    ds_read_b64_tr_b16 v[238:239], v29 offset:35328
    s_waitcnt lgkmcnt(0)
L_s3poll:
    s_waitcnt vmcnt(7)
    v_mfma_f32_32x32x16_bf16 v[96:111], v[176:179], v[32:35], v[64:79]
    v_and_b32 v20, 1, v32
    v_mfma_f32_32x32x16_bf16 v[112:127], v[180:183], v[32:35], v[80:95]
    s_waitcnt vmcnt(6)
    v_mfma_f32_32x32x16_bf16 v[96:111], v[184:187], v[36:39], v[96:111]
    v_and_b32 v20, v20, v36
    v_mfma_f32_32x32x16_bf16 v[112:127], v[188:191], v[36:39], v[112:127]
    s_waitcnt vmcnt(5)
    v_mfma_f32_32x32x16_bf16 v[96:111], v[192:195], v[40:43], v[96:111]
    v_and_b32 v20, v20, v40
    v_mfma_f32_32x32x16_bf16 v[112:127], v[196:199], v[40:43], v[112:127]
    s_waitcnt vmcnt(4)
    v_mfma_f32_32x32x16_bf16 v[96:111], v[200:203], v[44:47], v[96:111]
    v_and_b32 v20, v20, v44
    v_mfma_f32_32x32x16_bf16 v[112:127], v[204:207], v[44:47], v[112:127]
    s_waitcnt vmcnt(3)
    v_mfma_f32_32x32x16_bf16 v[96:111], v[208:211], v[48:51], v[96:111]
    v_and_b32 v20, v20, v48
    v_mfma_f32_32x32x16_bf16 v[112:127], v[212:215], v[48:51], v[112:127]
    s_waitcnt vmcnt(2)
    v_mfma_f32_32x32x16_bf16 v[96:111], v[216:219], v[52:55], v[96:111]
    v_and_b32 v20, v20, v52
    v_mfma_f32_32x32x16_bf16 v[112:127], v[220:223], v[52:55], v[112:127]
    s_cmp_eq_u32 s89, 0
    s_cbranch_scc1 L_nox
    s_mov_b32 s89, 0
    s_barrier
L_nox:
    s_waitcnt vmcnt(1)
    v_mfma_f32_32x32x16_bf16 v[96:111], v[224:227], v[56:59], v[96:111]
    v_and_b32 v20, v20, v56
    s_waitcnt vmcnt(0)
    v_mfma_f32_32x32x16_bf16 v[96:111], v[232:235], v[60:63], v[96:111]
    v_and_b32 v20, v20, v60
    v_mfma_f32_32x32x16_bf16 v[112:127], v[228:231], v[56:59], v[112:127]
    v_cmp_eq_u32 vcc, 0, v20
    v_mfma_f32_32x32x16_bf16 v[112:127], v[236:239], v[60:63], v[112:127]
    s_cbranch_vccnz L_s3retry
L_s3done:
    s_nop 6
    ds_write_b128 v9, v[96:99] offset:0
    ds_write_b128 v10, v[100:103] offset:0
    ds_write_b128 v11, v[104:107] offset:0
    ds_write_b128 v12, v[108:111] offset:0
    ds_write_b128 v9, v[112:115] offset:128
    ds_write_b128 v10, v[116:119] offset:128
    ds_write_b128 v11, v[120:123] offset:128
    ds_write_b128 v12, v[124:127] offset:128
    s_cmp_ge_u32 s68, 4
    s_waitcnt lgkmcnt(0)
    s_barrier
    ds_read_b128 v[176:179], v1 offset:0
    ds_read_b128 v[180:183], v2 offset:0
    ds_read_b128 v[184:187], v1 offset:8192
    ds_read_b128 v[188:191], v2 offset:8192
    ds_read_b128 v[192:195], v1 offset:16384
    ds_read_b128 v[196:199], v2 offset:16384
    ds_read_b128 v[200:203], v1 offset:24576
    ds_read_b128 v[204:207], v2 offset:24576
    s_waitcnt lgkmcnt(4)
    v_pk_add_f32 v[176:177], v[176:177], v[184:185]
    v_pk_add_f32 v[178:179], v[178:179], v[186:187]
    v_pk_add_f32 v[180:181], v[180:181], v[188:189]
    v_pk_add_f32 v[182:183], v[182:183], v[190:191]
    s_waitcnt lgkmcnt(2)
    v_pk_add_f32 v[176:177], v[176:177], v[192:193]
    v_pk_add_f32 v[178:179], v[178:179], v[194:195]
    v_pk_add_f32 v[180:181], v[180:181], v[196:197]
    v_pk_add_f32 v[182:183], v[182:183], v[198:199]
    s_waitcnt lgkmcnt(0)
    v_pk_add_f32 v[176:177], v[176:177], v[200:201]
    v_pk_add_f32 v[178:179], v[178:179], v[202:203]
    v_pk_add_f32 v[180:181], v[180:181], v[204:205]
    v_pk_add_f32 v[182:183], v[182:183], v[206:207]
    v_cvt_pk_bf16_f32 v176, v176, v177
    v_cvt_pk_bf16_f32 v177, v178, v179
    v_cvt_pk_bf16_f32 v178, v180, v181
    v_cvt_pk_bf16_f32 v179, v182, v183
    buffer_store_dwordx4 v[176:179], v5, s[92:95], s83 offen sc1
    s_cbranch_scc1 L_noy
    s_barrier
L_noy:
L_end:
    s_endpgm
L_s3retry:
    buffer_load_dwordx4 v[32:35], v14, s[52:55], s84 offen sc1
    buffer_load_dwordx4 v[36:39], v14, s[52:55], s85 offen sc1
    buffer_load_dwordx4 v[40:43], v14, s[52:55], s86 offen sc1
    buffer_load_dwordx4 v[44:47], v14, s[52:55], s87 offen sc1
    buffer_load_dwordx4 v[48:51], v27, s[52:55], s84 offen sc1
    buffer_load_dwordx4 v[52:55], v27, s[52:55], s85 offen sc1
    buffer_load_dwordx4 v[56:59], v27, s[52:55], s86 offen sc1
    buffer_load_dwordx4 v[60:63], v27, s[52:55], s87 offen sc1
    s_add_u32 s82, s82, 1
    s_cmp_lt_u32 s82, 4194304
    s_nop 7
    s_cbranch_scc1 L_s3poll
    s_waitcnt vmcnt(0)
    s_branch L_s3done
.p2align 12
.fill 96, 4, 0xbf800000
L_pathK:
    s_mov_b32 s44, s6
    s_mov_b32 s45, s7
    s_mov_b32 s46, 524288
    s_mov_b32 s47, 0x20000
    s_mov_b32 s36, s16
    s_mov_b32 s37, s17
    s_mov_b32 s38, 1835008
    s_mov_b32 s39, 0x20000
    s_mov_b32 s40, s18
    s_mov_b32 s41, s19
    s_mov_b32 s42, 1835008
    s_mov_b32 s43, 0x20000
    s_mov_b32 s48, s8
    s_mov_b32 s49, s9
    s_mov_b32 s50, 16384
    s_mov_b32 s51, 0x20000
    v_lshrrev_b32 v22, 4, v15
    v_and_b32 v20, 15, v15
    v_lshlrev_b32 v21, 3, v20
    v_lshl_add_u32 v21, v22, 8, v21
    v_and_b32 v23, 1, v22
    v_lshl_add_u32 v21, v23, 7, v21
    v_add_u32 v12, 131072, v21
    v_xor_b32 v13, 0x80, v12
    v_lshlrev_b32 v21, 7, v23
    v_xor_b32 v11, v21, v14
    s_add_u32 s91, s68, s79
    s_and_b32 s91, s91, 7
    s_lshl_b32 s91, s91, 11
    s_lshr_b32 s90, s84, 15
    v_lshrrev_b32 v22, 1, v22
    s_lshl3_add_u32 s90, s90, s85
    s_lshl_b32 s90, s90, 8
    v_lshlrev_b32 v22, 9, v22
    v_lshl_add_u32 v22, v20, 4, v22
    v_lshl_add_u32 v30, v23, 3, v22
    s_add_u32 m0, s76, 16384
    s_lshl_b32 s73, s72, 7
    buffer_load_dwordx4 v1, s[32:35], s73 offen lds
    s_add_u32 m0, s75, 131072
    s_nop 0
    buffer_load_dwordx4 v11, s[48:51], s91 offen lds
    buffer_load_dwordx4 v11, s[48:51], s91 offen offset:1024 lds
    s_add_u32 m0, s76, 81920
    s_mul_i32 s74, s72, 65536
    buffer_load_dwordx4 v3, s[44:47], s74 offen lds
    s_add_u32 m0, s76, 90112
    s_add_u32 s74, s74, 128
    s_add_u32 s72, s72, 1
    buffer_load_dwordx4 v3, s[44:47], s74 offen lds
    s_add_u32 m0, s76, 24576
    s_and_b32 s72, s72, 7
    buffer_load_dwordx4 v2, s[32:35], s73 offen lds
    s_lshr_b32 s80, s68, 2
    s_lshl_b32 s81, s80, 16
    v_add_u32 v26, s81, v14
    s_and_b32 s81, s68, 1
    s_mul_i32 s81, s81, 49152
    v_add_u32 v24, s81, v14
    v_add_u32 v25, s81, v29
    s_mul_i32 s81, s80, 49152
    s_and_b32 s86, s68, 3
    s_lshl_b32 s87, s86, 11
    s_add_u32 s83, s87, s81
    s_lshl_b32 s87, s2, 2
    s_add_u32 s86, s86, s87
    s_and_b32 s86, s86, 31
    s_lshl_b32 s85, s86, 11
    s_add_u32 s1, s101, 3145728
    s_xor_b32 s1, s1, 1024
    s_lshl1_add_u32 s79, s77, s80
    s_lshl_b32 s79, s79, 7
    s_add_u32 s79, s79, 131072
    s_lshr_b32 s86, s77, 3
    s_lshl3_add_u32 s86, s86, s68
    s_mul_i32 s86, s86, 224
    s_and_b32 s87, s77, 7
    s_lshl1_add_u32 s87, s87, s80
    s_add_u32 s86, s86, s87
    s_lshl_b32 s86, s86, 10
    s_add_u32 s89, s86, 5242880
    s_lshr_b32 s97, s77, 1
    s_lshl_b32 s97, s97, 9
    s_add_u32 s97, s97, 204800
    s_lshl_b32 s81, s68, 24
    s_add_u32 s98, s98, s81
    s_mul_i32 s86, s68, 2304
    s_add_u32 s86, s86, 65536
    s_xor_b32 s87, s68, 1
    s_mul_i32 s87, s87, 2304
    s_add_u32 s87, s87, 65536
    s_waitcnt vmcnt(6)
    s_setprio 3
    s_barrier
    s_add_u32 m0, s76, 32768
    s_lshl_b32 s73, s72, 7
    buffer_load_dwordx4 v1, s[32:35], s73 offen lds
    s_waitcnt lgkmcnt(0)
    ds_read_b128 v[128:131], v5 offset:0
    ds_read_b128 v[132:135], v6 offset:0
    ds_read_b64_tr_b16 v[32:33], v9 offset:0
    ds_read_b64_tr_b16 v[34:35], v9 offset:512
    ds_read_b64_tr_b16 v[36:37], v9 offset:8192
    ds_read_b64_tr_b16 v[38:39], v9 offset:8704
    ds_read_b64_tr_b16 v[40:41], v10 offset:0
    ds_read_b64_tr_b16 v[42:43], v10 offset:512
    ds_read_b64_tr_b16 v[44:45], v10 offset:8192
    ds_read_b64_tr_b16 v[46:47], v10 offset:8704
    s_add_u32 m0, s76, 98304
    s_mul_i32 s74, s72, 65536
    buffer_load_dwordx4 v3, s[44:47], s74 offen lds
    s_add_u32 m0, s76, 106496
    s_add_u32 s74, s74, 128
    s_add_u32 s72, s72, 1
    buffer_load_dwordx4 v3, s[44:47], s74 offen lds
    s_add_u32 m0, s76, 40960
    s_and_b32 s72, s72, 7
    buffer_load_dwordx4 v2, s[32:35], s73 offen lds
    s_waitcnt lgkmcnt(0)
    v_mfma_f32_16x16x32_bf16 v[64:67], v[32:35], v[128:131], 0
    ds_read_b128 v[136:139], v7 offset:0
    ds_read_b128 v[140:143], v8 offset:0
    v_mfma_f32_16x16x32_bf16 v[68:71], v[32:35], v[132:135], 0
    ds_read_b64_tr_b16 v[48:49], v9 offset:4096
    v_mfma_f32_16x16x32_bf16 v[72:75], v[36:39], v[128:131], 0
    ds_read_b64_tr_b16 v[50:51], v9 offset:4608
    ds_read_b64_tr_b16 v[52:53], v9 offset:12288
    v_mfma_f32_16x16x32_bf16 v[76:79], v[36:39], v[132:135], 0
    ds_read_b64_tr_b16 v[54:55], v9 offset:12800
    v_mfma_f32_16x16x32_bf16 v[80:83], v[40:43], v[128:131], 0
    ds_read_b64_tr_b16 v[56:57], v10 offset:4096
    ds_read_b64_tr_b16 v[58:59], v10 offset:4608
    v_mfma_f32_16x16x32_bf16 v[84:87], v[40:43], v[132:135], 0
    ds_read_b64_tr_b16 v[60:61], v10 offset:12288
    v_mfma_f32_16x16x32_bf16 v[88:91], v[44:47], v[128:131], 0
    ds_read_b64_tr_b16 v[62:63], v10 offset:12800
    v_mfma_f32_16x16x32_bf16 v[92:95], v[44:47], v[132:135], 0
    s_waitcnt vmcnt(4)
    s_setprio 3
    s_barrier
    s_add_u32 m0, s76, 49152
    s_lshl_b32 s73, s72, 7
    buffer_load_dwordx4 v1, s[32:35], s73 offen lds
    s_waitcnt lgkmcnt(0)
    v_mfma_f32_16x16x32_bf16 v[64:67], v[48:51], v[136:139], v[64:67]
    ds_read_b128 v[144:147], v5 offset:16384
    ds_read_b128 v[148:151], v6 offset:16384
    v_mfma_f32_16x16x32_bf16 v[68:71], v[48:51], v[140:143], v[68:71]
    ds_read_b64_tr_b16 v[32:33], v9 offset:16384
    ds_read_b64_tr_b16 v[34:35], v9 offset:16896
    v_mfma_f32_16x16x32_bf16 v[72:75], v[52:55], v[136:139], v[72:75]
    ds_read_b64_tr_b16 v[36:37], v9 offset:24576
    ds_read_b64_tr_b16 v[38:39], v9 offset:25088
    v_mfma_f32_16x16x32_bf16 v[76:79], v[52:55], v[140:143], v[76:79]
    ds_read_b64_tr_b16 v[40:41], v10 offset:16384
    ds_read_b64_tr_b16 v[42:43], v10 offset:16896
    v_mfma_f32_16x16x32_bf16 v[80:83], v[56:59], v[136:139], v[80:83]
    ds_read_b64_tr_b16 v[44:45], v10 offset:24576
    ds_read_b64_tr_b16 v[46:47], v10 offset:25088
    v_mfma_f32_16x16x32_bf16 v[84:87], v[56:59], v[140:143], v[84:87]
    ds_read_b64_tr_b16 v[100:101], v12 offset:0
    ds_read_b64_tr_b16 v[102:103], v13 offset:0
    v_mfma_f32_16x16x32_bf16 v[88:91], v[60:63], v[136:139], v[88:91]
    ds_read_b64_tr_b16 v[104:105], v12 offset:1024
    ds_read_b64_tr_b16 v[106:107], v13 offset:1024
    v_mfma_f32_16x16x32_bf16 v[92:95], v[60:63], v[140:143], v[92:95]
    s_setprio 2
    s_add_u32 m0, s76, 114688
    s_mul_i32 s74, s72, 65536
    buffer_load_dwordx4 v3, s[44:47], s74 offen lds
    s_add_u32 m0, s76, 122880
    s_add_u32 s74, s74, 128
    s_add_u32 s72, s72, 1
    buffer_load_dwordx4 v3, s[44:47], s74 offen lds
    s_add_u32 m0, s76, 57344
    s_and_b32 s72, s72, 7
    buffer_load_dwordx4 v2, s[32:35], s73 offen lds
    s_waitcnt lgkmcnt(0)
    v_mfma_f32_16x16x32_bf16 v[64:67], v[32:35], v[144:147], v[64:67]
    ds_read_b128 v[152:155], v7 offset:16384
    ds_read_b128 v[156:159], v8 offset:16384
    v_mfma_f32_16x16x32_bf16 v[96:99], v[100:103], v[128:131], 0
    ds_read_b64_tr_b16 v[48:49], v9 offset:20480
    ds_read_b64_tr_b16 v[50:51], v9 offset:20992
    v_mfma_f32_16x16x32_bf16 v[68:71], v[32:35], v[148:151], v[68:71]
    ds_read_b64_tr_b16 v[52:53], v9 offset:28672
    v_mfma_f32_16x16x32_bf16 v[72:75], v[36:39], v[144:147], v[72:75]
    ds_read_b64_tr_b16 v[54:55], v9 offset:29184
    ds_read_b64_tr_b16 v[56:57], v10 offset:20480
    v_mfma_f32_16x16x32_bf16 v[76:79], v[36:39], v[148:151], v[76:79]
    ds_read_b64_tr_b16 v[58:59], v10 offset:20992
    v_mfma_f32_16x16x32_bf16 v[80:83], v[40:43], v[144:147], v[80:83]
    ds_read_b64_tr_b16 v[60:61], v10 offset:28672
    ds_read_b64_tr_b16 v[62:63], v10 offset:29184
    v_mfma_f32_16x16x32_bf16 v[96:99], v[104:107], v[136:139], v[96:99]
    ds_read_b64_tr_b16 v[108:109], v12 offset:2048
    v_mfma_f32_16x16x32_bf16 v[84:87], v[40:43], v[148:151], v[84:87]
    ds_read_b64_tr_b16 v[110:111], v13 offset:2048
    ds_read_b64_tr_b16 v[112:113], v12 offset:3072
    v_mfma_f32_16x16x32_bf16 v[88:91], v[44:47], v[144:147], v[88:91]
    ds_read_b64_tr_b16 v[114:115], v13 offset:3072
    v_mfma_f32_16x16x32_bf16 v[92:95], v[44:47], v[148:151], v[92:95]
    s_waitcnt vmcnt(4)
    s_setprio 3
    s_barrier
    s_add_u32 m0, s76, 0
    s_lshl_b32 s73, s72, 7
    buffer_load_dwordx4 v1, s[32:35], s73 offen lds
    s_waitcnt lgkmcnt(0)
    v_mfma_f32_16x16x32_bf16 v[64:67], v[48:51], v[152:155], v[64:67]
    ds_read_b128 v[160:163], v5 offset:32768
    ds_read_b128 v[164:167], v6 offset:32768
    v_mfma_f32_16x16x32_bf16 v[96:99], v[108:111], v[144:147], v[96:99]
    ds_read_b64_tr_b16 v[32:33], v9 offset:32768
    v_mfma_f32_16x16x32_bf16 v[68:71], v[48:51], v[156:159], v[68:71]
    ds_read_b64_tr_b16 v[34:35], v9 offset:33280
    v_mfma_f32_16x16x32_bf16 v[72:75], v[52:55], v[152:155], v[72:75]
    ds_read_b64_tr_b16 v[36:37], v9 offset:40960
    ds_read_b64_tr_b16 v[38:39], v9 offset:41472
    v_mfma_f32_16x16x32_bf16 v[76:79], v[52:55], v[156:159], v[76:79]
    ds_read_b64_tr_b16 v[40:41], v10 offset:32768
    v_mfma_f32_16x16x32_bf16 v[80:83], v[56:59], v[152:155], v[80:83]
    ds_read_b64_tr_b16 v[42:43], v10 offset:33280
    v_mfma_f32_16x16x32_bf16 v[96:99], v[112:115], v[152:155], v[96:99]
    ds_read_b64_tr_b16 v[44:45], v10 offset:40960
    ds_read_b64_tr_b16 v[46:47], v10 offset:41472
    v_mfma_f32_16x16x32_bf16 v[84:87], v[56:59], v[156:159], v[84:87]
    ds_read_b64_tr_b16 v[100:101], v12 offset:4096
    v_mfma_f32_16x16x32_bf16 v[88:91], v[60:63], v[152:155], v[88:91]
    ds_read_b64_tr_b16 v[102:103], v13 offset:4096
    v_mfma_f32_16x16x32_bf16 v[92:95], v[60:63], v[156:159], v[92:95]
    s_setprio 2
    s_add_u32 m0, s76, 65536
    s_mul_i32 s74, s72, 65536
    buffer_load_dwordx4 v3, s[44:47], s74 offen lds
    s_add_u32 m0, s76, 73728
    s_add_u32 s74, s74, 128
    s_add_u32 s72, s72, 1
    buffer_load_dwordx4 v3, s[44:47], s74 offen lds
    s_add_u32 m0, s76, 8192
    s_and_b32 s72, s72, 7
    buffer_load_dwordx4 v2, s[32:35], s73 offen lds
    s_waitcnt lgkmcnt(0)
    v_mfma_f32_16x16x32_bf16 v[64:67], v[32:35], v[160:163], v[64:67]
    ds_read_b128 v[168:171], v7 offset:32768
    ds_read_b128 v[172:175], v8 offset:32768
    v_mfma_f32_16x16x32_bf16 v[96:99], v[100:103], v[160:163], v[96:99]
    ds_read_b64_tr_b16 v[48:49], v9 offset:36864
    v_mfma_f32_16x16x32_bf16 v[68:71], v[32:35], v[164:167], v[68:71]
    ds_read_b64_tr_b16 v[50:51], v9 offset:37376
    ds_read_b64_tr_b16 v[52:53], v9 offset:45056
    v_mfma_f32_16x16x32_bf16 v[72:75], v[36:39], v[160:163], v[72:75]
    ds_read_b64_tr_b16 v[54:55], v9 offset:45568
    v_mfma_f32_16x16x32_bf16 v[76:79], v[36:39], v[164:167], v[76:79]
    ds_read_b64_tr_b16 v[56:57], v10 offset:36864
    ds_read_b64_tr_b16 v[58:59], v10 offset:37376
    v_mfma_f32_16x16x32_bf16 v[80:83], v[40:43], v[160:163], v[80:83]
    ds_read_b64_tr_b16 v[60:61], v10 offset:45056
    v_mfma_f32_16x16x32_bf16 v[84:87], v[40:43], v[164:167], v[84:87]
    ds_read_b64_tr_b16 v[62:63], v10 offset:45568
    ds_read_b64_tr_b16 v[108:109], v12 offset:5120
    v_mfma_f32_16x16x32_bf16 v[88:91], v[44:47], v[160:163], v[88:91]
    ds_read_b64_tr_b16 v[110:111], v13 offset:5120
    v_mfma_f32_16x16x32_bf16 v[92:95], v[44:47], v[164:167], v[92:95]
    s_waitcnt vmcnt(4)
    s_setprio 3
    s_barrier
    s_add_u32 m0, s76, 16384
    s_lshl_b32 s73, s72, 7
    buffer_load_dwordx4 v1, s[32:35], s73 offen lds
    s_waitcnt lgkmcnt(0)
    v_mfma_f32_16x16x32_bf16 v[64:67], v[48:51], v[168:171], v[64:67]
    ds_read_b128 v[176:179], v5 offset:49152
    ds_read_b128 v[180:183], v6 offset:49152
    v_mfma_f32_16x16x32_bf16 v[96:99], v[108:111], v[168:171], v[96:99]
    ds_read_b64_tr_b16 v[32:33], v9 offset:49152
    v_mfma_f32_16x16x32_bf16 v[68:71], v[48:51], v[172:175], v[68:71]
    ds_read_b64_tr_b16 v[34:35], v9 offset:49664
    ds_read_b64_tr_b16 v[36:37], v9 offset:57344
    v_mfma_f32_16x16x32_bf16 v[72:75], v[52:55], v[168:171], v[72:75]
    ds_read_b64_tr_b16 v[38:39], v9 offset:57856
    v_mfma_f32_16x16x32_bf16 v[76:79], v[52:55], v[172:175], v[76:79]
    ds_read_b64_tr_b16 v[40:41], v10 offset:49152
    ds_read_b64_tr_b16 v[42:43], v10 offset:49664
    v_mfma_f32_16x16x32_bf16 v[80:83], v[56:59], v[168:171], v[80:83]
    ds_read_b64_tr_b16 v[44:45], v10 offset:57344
    v_mfma_f32_16x16x32_bf16 v[84:87], v[56:59], v[172:175], v[84:87]
    ds_read_b64_tr_b16 v[46:47], v10 offset:57856
    ds_read_b64_tr_b16 v[100:101], v12 offset:6144
    v_mfma_f32_16x16x32_bf16 v[88:91], v[60:63], v[168:171], v[88:91]
    ds_read_b64_tr_b16 v[102:103], v13 offset:6144
    v_mfma_f32_16x16x32_bf16 v[92:95], v[60:63], v[172:175], v[92:95]
    s_setprio 2
    s_add_u32 m0, s76, 81920
    s_mul_i32 s74, s72, 65536
    buffer_load_dwordx4 v3, s[44:47], s74 offen lds
    s_add_u32 m0, s76, 90112
    s_add_u32 s74, s74, 128
    s_add_u32 s72, s72, 1
    buffer_load_dwordx4 v3, s[44:47], s74 offen lds
    s_add_u32 m0, s76, 24576
    s_and_b32 s72, s72, 7
    buffer_load_dwordx4 v2, s[32:35], s73 offen lds
    s_waitcnt lgkmcnt(0)
    v_mfma_f32_16x16x32_bf16 v[64:67], v[32:35], v[176:179], v[64:67]
    ds_read_b128 v[184:187], v7 offset:49152
    ds_read_b128 v[188:191], v8 offset:49152
    v_mfma_f32_16x16x32_bf16 v[96:99], v[100:103], v[176:179], v[96:99]
    ds_read_b64_tr_b16 v[48:49], v9 offset:53248
    v_mfma_f32_16x16x32_bf16 v[68:71], v[32:35], v[180:183], v[68:71]
    ds_read_b64_tr_b16 v[50:51], v9 offset:53760
    ds_read_b64_tr_b16 v[52:53], v9 offset:61440
    v_mfma_f32_16x16x32_bf16 v[72:75], v[36:39], v[176:179], v[72:75]
    ds_read_b64_tr_b16 v[54:55], v9 offset:61952
    v_mfma_f32_16x16x32_bf16 v[76:79], v[36:39], v[180:183], v[76:79]
    ds_read_b64_tr_b16 v[56:57], v10 offset:53248
    ds_read_b64_tr_b16 v[58:59], v10 offset:53760
    v_mfma_f32_16x16x32_bf16 v[80:83], v[40:43], v[176:179], v[80:83]
    ds_read_b64_tr_b16 v[60:61], v10 offset:61440
    v_mfma_f32_16x16x32_bf16 v[84:87], v[40:43], v[180:183], v[84:87]
    ds_read_b64_tr_b16 v[62:63], v10 offset:61952
    ds_read_b64_tr_b16 v[108:109], v12 offset:7168
    v_mfma_f32_16x16x32_bf16 v[88:91], v[44:47], v[176:179], v[88:91]
    ds_read_b64_tr_b16 v[110:111], v13 offset:7168
    v_mfma_f32_16x16x32_bf16 v[92:95], v[44:47], v[180:183], v[92:95]
    s_waitcnt vmcnt(4)
    s_setprio 3
    s_barrier
    s_add_u32 m0, s76, 32768
    s_lshl_b32 s73, s72, 7
    buffer_load_dwordx4 v1, s[32:35], s73 offen lds
    s_waitcnt lgkmcnt(0)
    v_mfma_f32_16x16x32_bf16 v[64:67], v[48:51], v[184:187], v[64:67]
    ds_read_b128 v[192:195], v5 offset:0
    ds_read_b128 v[196:199], v6 offset:0
    v_mfma_f32_16x16x32_bf16 v[96:99], v[108:111], v[184:187], v[96:99]
    ds_read_b64_tr_b16 v[32:33], v9 offset:0
    v_mfma_f32_16x16x32_bf16 v[68:71], v[48:51], v[188:191], v[68:71]
    ds_read_b64_tr_b16 v[34:35], v9 offset:512
    ds_read_b64_tr_b16 v[36:37], v9 offset:8192
    v_mfma_f32_16x16x32_bf16 v[72:75], v[52:55], v[184:187], v[72:75]
    ds_read_b64_tr_b16 v[38:39], v9 offset:8704
    v_mfma_f32_16x16x32_bf16 v[76:79], v[52:55], v[188:191], v[76:79]
    ds_read_b64_tr_b16 v[40:41], v10 offset:0
    ds_read_b64_tr_b16 v[42:43], v10 offset:512
    v_mfma_f32_16x16x32_bf16 v[80:83], v[56:59], v[184:187], v[80:83]
    ds_read_b64_tr_b16 v[44:45], v10 offset:8192
    v_mfma_f32_16x16x32_bf16 v[84:87], v[56:59], v[188:191], v[84:87]
    ds_read_b64_tr_b16 v[46:47], v10 offset:8704
    ds_read_b64_tr_b16 v[100:101], v12 offset:8192
    v_mfma_f32_16x16x32_bf16 v[88:91], v[60:63], v[184:187], v[88:91]
    ds_read_b64_tr_b16 v[102:103], v13 offset:8192
    v_mfma_f32_16x16x32_bf16 v[92:95], v[60:63], v[188:191], v[92:95]
    s_setprio 2
    s_add_u32 m0, s76, 98304
    s_mul_i32 s74, s72, 65536
    buffer_load_dwordx4 v3, s[44:47], s74 offen lds
    s_add_u32 m0, s76, 106496
    s_add_u32 s74, s74, 128
    s_add_u32 s72, s72, 1
    buffer_load_dwordx4 v3, s[44:47], s74 offen lds
    s_add_u32 m0, s76, 40960
    s_and_b32 s72, s72, 7
    buffer_load_dwordx4 v2, s[32:35], s73 offen lds
    s_waitcnt lgkmcnt(0)
    v_mfma_f32_16x16x32_bf16 v[64:67], v[32:35], v[192:195], v[64:67]
    ds_read_b128 v[200:203], v7 offset:0
    ds_read_b128 v[204:207], v8 offset:0
    v_mfma_f32_16x16x32_bf16 v[96:99], v[100:103], v[192:195], v[96:99]
    ds_read_b64_tr_b16 v[48:49], v9 offset:4096
    v_mfma_f32_16x16x32_bf16 v[68:71], v[32:35], v[196:199], v[68:71]
    ds_read_b64_tr_b16 v[50:51], v9 offset:4608
    ds_read_b64_tr_b16 v[52:53], v9 offset:12288
    v_mfma_f32_16x16x32_bf16 v[72:75], v[36:39], v[192:195], v[72:75]
    ds_read_b64_tr_b16 v[54:55], v9 offset:12800
    v_mfma_f32_16x16x32_bf16 v[76:79], v[36:39], v[196:199], v[76:79]
    ds_read_b64_tr_b16 v[56:57], v10 offset:4096
    ds_read_b64_tr_b16 v[58:59], v10 offset:4608
    v_mfma_f32_16x16x32_bf16 v[80:83], v[40:43], v[192:195], v[80:83]
    ds_read_b64_tr_b16 v[60:61], v10 offset:12288
    v_mfma_f32_16x16x32_bf16 v[84:87], v[40:43], v[196:199], v[84:87]
    ds_read_b64_tr_b16 v[62:63], v10 offset:12800
    ds_read_b64_tr_b16 v[108:109], v12 offset:9216
    v_mfma_f32_16x16x32_bf16 v[88:91], v[44:47], v[192:195], v[88:91]
    ds_read_b64_tr_b16 v[110:111], v13 offset:9216
    v_mfma_f32_16x16x32_bf16 v[92:95], v[44:47], v[196:199], v[92:95]
    s_waitcnt vmcnt(4)
    s_setprio 3
    s_barrier
    s_add_u32 m0, s76, 49152
    s_lshl_b32 s73, s72, 7
    buffer_load_dwordx4 v1, s[32:35], s73 offen lds
    s_waitcnt lgkmcnt(0)
    v_mfma_f32_16x16x32_bf16 v[64:67], v[48:51], v[200:203], v[64:67]
    ds_read_b128 v[208:211], v5 offset:16384
    ds_read_b128 v[212:215], v6 offset:16384
    v_mfma_f32_16x16x32_bf16 v[96:99], v[108:111], v[200:203], v[96:99]
    ds_read_b64_tr_b16 v[32:33], v9 offset:16384
    v_mfma_f32_16x16x32_bf16 v[68:71], v[48:51], v[204:207], v[68:71]
    ds_read_b64_tr_b16 v[34:35], v9 offset:16896
    ds_read_b64_tr_b16 v[36:37], v9 offset:24576
    v_mfma_f32_16x16x32_bf16 v[72:75], v[52:55], v[200:203], v[72:75]
    ds_read_b64_tr_b16 v[38:39], v9 offset:25088
    v_mfma_f32_16x16x32_bf16 v[76:79], v[52:55], v[204:207], v[76:79]
    ds_read_b64_tr_b16 v[40:41], v10 offset:16384
    ds_read_b64_tr_b16 v[42:43], v10 offset:16896
    v_mfma_f32_16x16x32_bf16 v[80:83], v[56:59], v[200:203], v[80:83]
    ds_read_b64_tr_b16 v[44:45], v10 offset:24576
    v_mfma_f32_16x16x32_bf16 v[84:87], v[56:59], v[204:207], v[84:87]
    ds_read_b64_tr_b16 v[46:47], v10 offset:25088
    ds_read_b64_tr_b16 v[100:101], v12 offset:10240
    v_mfma_f32_16x16x32_bf16 v[88:91], v[60:63], v[200:203], v[88:91]
    ds_read_b64_tr_b16 v[102:103], v13 offset:10240
    v_mfma_f32_16x16x32_bf16 v[92:95], v[60:63], v[204:207], v[92:95]
    s_setprio 2
    s_add_u32 m0, s76, 114688
    s_mul_i32 s74, s72, 65536
    buffer_load_dwordx4 v3, s[44:47], s74 offen lds
    s_add_u32 m0, s76, 122880
    s_add_u32 s74, s74, 128
    s_add_u32 s72, s72, 1
    buffer_load_dwordx4 v3, s[44:47], s74 offen lds
    s_add_u32 m0, s76, 57344
    s_and_b32 s72, s72, 7
    buffer_load_dwordx4 v2, s[32:35], s73 offen lds
    s_waitcnt lgkmcnt(0)
    v_mfma_f32_16x16x32_bf16 v[64:67], v[32:35], v[208:211], v[64:67]
    ds_read_b128 v[216:219], v7 offset:16384
    ds_read_b128 v[220:223], v8 offset:16384
    v_mfma_f32_16x16x32_bf16 v[96:99], v[100:103], v[208:211], v[96:99]
    ds_read_b64_tr_b16 v[48:49], v9 offset:20480
    v_mfma_f32_16x16x32_bf16 v[68:71], v[32:35], v[212:215], v[68:71]
    ds_read_b64_tr_b16 v[50:51], v9 offset:20992
    ds_read_b64_tr_b16 v[52:53], v9 offset:28672
    v_mfma_f32_16x16x32_bf16 v[72:75], v[36:39], v[208:211], v[72:75]
    ds_read_b64_tr_b16 v[54:55], v9 offset:29184
    v_mfma_f32_16x16x32_bf16 v[76:79], v[36:39], v[212:215], v[76:79]
    ds_read_b64_tr_b16 v[56:57], v10 offset:20480
    ds_read_b64_tr_b16 v[58:59], v10 offset:20992
    v_mfma_f32_16x16x32_bf16 v[80:83], v[40:43], v[208:211], v[80:83]
    ds_read_b64_tr_b16 v[60:61], v10 offset:28672
    v_mfma_f32_16x16x32_bf16 v[84:87], v[40:43], v[212:215], v[84:87]
    ds_read_b64_tr_b16 v[62:63], v10 offset:29184
    ds_read_b64_tr_b16 v[108:109], v12 offset:11264
    v_mfma_f32_16x16x32_bf16 v[88:91], v[44:47], v[208:211], v[88:91]
    ds_read_b64_tr_b16 v[110:111], v13 offset:11264
    v_mfma_f32_16x16x32_bf16 v[92:95], v[44:47], v[212:215], v[92:95]
    s_waitcnt vmcnt(4)
    s_setprio 3
    s_barrier
    s_add_u32 m0, s76, 65536
    s_mul_i32 s74, s72, 229376
    buffer_load_dwordx4 v27, s[36:39], s74 offen lds
    s_waitcnt lgkmcnt(0)
    v_mfma_f32_16x16x32_bf16 v[64:67], v[48:51], v[216:219], v[64:67]
    ds_read_b128 v[224:227], v5 offset:32768
    ds_read_b128 v[228:231], v6 offset:32768
    v_mfma_f32_16x16x32_bf16 v[96:99], v[108:111], v[216:219], v[96:99]
    ds_read_b64_tr_b16 v[32:33], v9 offset:32768
    v_mfma_f32_16x16x32_bf16 v[68:71], v[48:51], v[220:223], v[68:71]
    ds_read_b64_tr_b16 v[34:35], v9 offset:33280
    ds_read_b64_tr_b16 v[36:37], v9 offset:40960
    v_mfma_f32_16x16x32_bf16 v[72:75], v[52:55], v[216:219], v[72:75]
    ds_read_b64_tr_b16 v[38:39], v9 offset:41472
    v_mfma_f32_16x16x32_bf16 v[76:79], v[52:55], v[220:223], v[76:79]
    ds_read_b64_tr_b16 v[40:41], v10 offset:32768
    ds_read_b64_tr_b16 v[42:43], v10 offset:33280
    v_mfma_f32_16x16x32_bf16 v[80:83], v[56:59], v[216:219], v[80:83]
    ds_read_b64_tr_b16 v[44:45], v10 offset:40960
    v_mfma_f32_16x16x32_bf16 v[84:87], v[56:59], v[220:223], v[84:87]
    ds_read_b64_tr_b16 v[46:47], v10 offset:41472
    ds_read_b64_tr_b16 v[100:101], v12 offset:12288
    v_mfma_f32_16x16x32_bf16 v[88:91], v[60:63], v[216:219], v[88:91]
    ds_read_b64_tr_b16 v[102:103], v13 offset:12288
    v_mfma_f32_16x16x32_bf16 v[92:95], v[60:63], v[220:223], v[92:95]
    s_setprio 2
    s_add_u32 m0, s76, 73728
    s_add_u32 s72, s72, 1
    s_and_b32 s72, s72, 7
    buffer_load_dwordx4 v27, s[40:43], s74 offen lds
    s_add_u32 m0, s76, 0
    s_mul_i32 s74, s72, 229376
    buffer_load_dwordx4 v27, s[36:39], s74 offen lds
    s_add_u32 m0, s76, 8192
    s_add_u32 s72, s72, 1
    s_and_b32 s72, s72, 7
    buffer_load_dwordx4 v27, s[40:43], s74 offen lds
    s_waitcnt lgkmcnt(0)
    v_mfma_f32_16x16x32_bf16 v[64:67], v[32:35], v[224:227], v[64:67]
    ds_read_b128 v[232:235], v7 offset:32768
    ds_read_b128 v[236:239], v8 offset:32768
    v_mfma_f32_16x16x32_bf16 v[96:99], v[100:103], v[224:227], v[96:99]
    ds_read_b64_tr_b16 v[48:49], v9 offset:36864
    v_mfma_f32_16x16x32_bf16 v[68:71], v[32:35], v[228:231], v[68:71]
    ds_read_b64_tr_b16 v[50:51], v9 offset:37376
    ds_read_b64_tr_b16 v[52:53], v9 offset:45056
    v_mfma_f32_16x16x32_bf16 v[72:75], v[36:39], v[224:227], v[72:75]
    ds_read_b64_tr_b16 v[54:55], v9 offset:45568
    v_mfma_f32_16x16x32_bf16 v[76:79], v[36:39], v[228:231], v[76:79]
    ds_read_b64_tr_b16 v[56:57], v10 offset:36864
    ds_read_b64_tr_b16 v[58:59], v10 offset:37376
    v_mfma_f32_16x16x32_bf16 v[80:83], v[40:43], v[224:227], v[80:83]
    ds_read_b64_tr_b16 v[60:61], v10 offset:45056
    v_mfma_f32_16x16x32_bf16 v[84:87], v[40:43], v[228:231], v[84:87]
    ds_read_b64_tr_b16 v[62:63], v10 offset:45568
    ds_read_b64_tr_b16 v[108:109], v12 offset:13312
    v_mfma_f32_16x16x32_bf16 v[88:91], v[44:47], v[224:227], v[88:91]
    ds_read_b64_tr_b16 v[110:111], v13 offset:13312
    v_mfma_f32_16x16x32_bf16 v[92:95], v[44:47], v[228:231], v[92:95]
    s_waitcnt vmcnt(4)
    s_setprio 3
    s_barrier
    s_add_u32 m0, s76, 81920
    s_mul_i32 s74, s72, 229376
    buffer_load_dwordx4 v27, s[36:39], s74 offen lds
    s_waitcnt lgkmcnt(0)
    v_mfma_f32_16x16x32_bf16 v[64:67], v[48:51], v[232:235], v[64:67]
    ds_read_b128 v[240:243], v5 offset:49152
    ds_read_b128 v[244:247], v6 offset:49152
    v_mfma_f32_16x16x32_bf16 v[96:99], v[108:111], v[232:235], v[96:99]
    ds_read_b64_tr_b16 v[32:33], v9 offset:49152
    v_mfma_f32_16x16x32_bf16 v[68:71], v[48:51], v[236:239], v[68:71]
    ds_read_b64_tr_b16 v[34:35], v9 offset:49664
    ds_read_b64_tr_b16 v[36:37], v9 offset:57344
    v_mfma_f32_16x16x32_bf16 v[72:75], v[52:55], v[232:235], v[72:75]
    ds_read_b64_tr_b16 v[38:39], v9 offset:57856
    v_mfma_f32_16x16x32_bf16 v[76:79], v[52:55], v[236:239], v[76:79]
    ds_read_b64_tr_b16 v[40:41], v10 offset:49152
    ds_read_b64_tr_b16 v[42:43], v10 offset:49664
    v_mfma_f32_16x16x32_bf16 v[80:83], v[56:59], v[232:235], v[80:83]
    ds_read_b64_tr_b16 v[44:45], v10 offset:57344
    v_mfma_f32_16x16x32_bf16 v[84:87], v[56:59], v[236:239], v[84:87]
    ds_read_b64_tr_b16 v[46:47], v10 offset:57856
    ds_read_b64_tr_b16 v[100:101], v12 offset:14336
    v_mfma_f32_16x16x32_bf16 v[88:91], v[60:63], v[232:235], v[88:91]
    ds_read_b64_tr_b16 v[102:103], v13 offset:14336
    v_mfma_f32_16x16x32_bf16 v[92:95], v[60:63], v[236:239], v[92:95]
    s_setprio 2
    s_add_u32 m0, s76, 90112
    s_add_u32 s72, s72, 1
    s_and_b32 s72, s72, 7
    buffer_load_dwordx4 v27, s[40:43], s74 offen lds
    s_add_u32 m0, s76, 16384
    s_mul_i32 s74, s72, 229376
    buffer_load_dwordx4 v27, s[36:39], s74 offen lds
    buffer_load_dword v28, v17, s[56:59], 0 offen sc1
    s_add_u32 m0, s76, 24576
    s_add_u32 s72, s72, 1
    s_and_b32 s72, s72, 7
    buffer_load_dwordx4 v27, s[40:43], s74 offen lds
    s_waitcnt lgkmcnt(0)
    v_mfma_f32_16x16x32_bf16 v[64:67], v[32:35], v[240:243], v[64:67]
    ds_read_b128 v[248:251], v7 offset:49152
    ds_read_b128 v[252:255], v8 offset:49152
    v_mfma_f32_16x16x32_bf16 v[96:99], v[100:103], v[240:243], v[96:99]
    ds_read_b64_tr_b16 v[48:49], v9 offset:53248
    v_mfma_f32_16x16x32_bf16 v[68:71], v[32:35], v[244:247], v[68:71]
    ds_read_b64_tr_b16 v[50:51], v9 offset:53760
    ds_read_b64_tr_b16 v[52:53], v9 offset:61440
    v_mfma_f32_16x16x32_bf16 v[72:75], v[36:39], v[240:243], v[72:75]
    ds_read_b64_tr_b16 v[54:55], v9 offset:61952
    v_mfma_f32_16x16x32_bf16 v[76:79], v[36:39], v[244:247], v[76:79]
    ds_read_b64_tr_b16 v[56:57], v10 offset:53248
    ds_read_b64_tr_b16 v[58:59], v10 offset:53760
    v_mfma_f32_16x16x32_bf16 v[80:83], v[40:43], v[240:243], v[80:83]
    ds_read_b64_tr_b16 v[60:61], v10 offset:61440
    v_mfma_f32_16x16x32_bf16 v[84:87], v[40:43], v[244:247], v[84:87]
    ds_read_b64_tr_b16 v[62:63], v10 offset:61952
    ds_read_b64_tr_b16 v[108:109], v12 offset:15360
    v_mfma_f32_16x16x32_bf16 v[88:91], v[44:47], v[240:243], v[88:91]
    ds_read_b64_tr_b16 v[110:111], v13 offset:15360
    v_mfma_f32_16x16x32_bf16 v[92:95], v[44:47], v[244:247], v[92:95]
    v_subrev_u32 v5, 65536, v9
    v_subrev_u32 v6, 65536, v10
    v_add_u32 v7, 65536, v9
    v_add_u32 v8, 65536, v10
    s_waitcnt vmcnt(5)
    s_setprio 3
    s_barrier
    s_waitcnt lgkmcnt(0)
    v_mfma_f32_16x16x32_bf16 v[64:67], v[48:51], v[248:251], v[64:67]
    ds_read_b64_tr_b16 v[32:33], v9 offset:0
    v_mfma_f32_16x16x32_bf16 v[96:99], v[108:111], v[248:251], v[96:99]
    ds_read_b64_tr_b16 v[34:35], v9 offset:512
    v_mfma_f32_16x16x32_bf16 v[68:71], v[48:51], v[252:255], v[68:71]
    ds_read_b64_tr_b16 v[36:37], v9 offset:4096
    v_mfma_f32_16x16x32_bf16 v[72:75], v[52:55], v[248:251], v[72:75]
    ds_read_b64_tr_b16 v[38:39], v9 offset:4608
    v_mfma_f32_16x16x32_bf16 v[76:79], v[52:55], v[252:255], v[76:79]
    ds_read_b64_tr_b16 v[40:41], v5 offset:0
    v_mfma_f32_16x16x32_bf16 v[80:83], v[56:59], v[248:251], v[80:83]
    ds_read_b64_tr_b16 v[42:43], v5 offset:512
    v_mfma_f32_16x16x32_bf16 v[84:87], v[56:59], v[252:255], v[84:87]
    ds_read_b64_tr_b16 v[44:45], v5 offset:4096
    v_mfma_f32_16x16x32_bf16 v[88:91], v[60:63], v[248:251], v[88:91]
    ds_read_b64_tr_b16 v[46:47], v5 offset:4608
    v_mfma_f32_16x16x32_bf16 v[92:95], v[60:63], v[252:255], v[92:95]
    s_setprio 2
    s_add_u32 s88, s84, 3149824
    s_add_u32 s84, s84, 3145728
    v_mul_f32 v96, 0x3eb8aa3b, v96
    v_mul_f32 v97, 0x3eb8aa3b, v97
    v_mul_f32 v98, 0x3eb8aa3b, v98
    v_mul_f32 v99, 0x3eb8aa3b, v99
    v_cvt_pk_bf16_f32 v18, v96, v97
    v_cvt_pk_bf16_f32 v19, v98, v99
    buffer_store_dwordx2 v[18:19], v30, s[52:55], s90 offen sc1
    v_cvt_pk_bf16_f32 v64, v64, v65
    v_cvt_pk_bf16_f32 v65, v66, v67
    v_cvt_pk_bf16_f32 v66, v68, v69
    v_cvt_pk_bf16_f32 v67, v70, v71
    v_cvt_pk_bf16_f32 v72, v72, v73
    v_cvt_pk_bf16_f32 v73, v74, v75
    v_cvt_pk_bf16_f32 v74, v76, v77
    v_cvt_pk_bf16_f32 v75, v78, v79
    v_permlane16_swap_b32 v64, v66
    v_permlane16_swap_b32 v65, v67
    v_and_b32 v64, -2, v64
    buffer_store_dwordx4 v[64:67], v4, s[52:55], s84 offen offset:0 sc1
    v_permlane16_swap_b32 v72, v74
    v_permlane16_swap_b32 v73, v75
    v_and_b32 v72, -2, v72
    buffer_store_dwordx4 v[72:75], v4, s[52:55], s88 offen offset:0 sc1
    s_waitcnt lgkmcnt(0)
    v_mfma_f32_16x16x32_bf16 v[96:99], v[32:35], v[128:131], 0
    ds_read_b64_tr_b16 v[48:49], v9 offset:8192
    ds_read_b64_tr_b16 v[50:51], v9 offset:8704
    v_mfma_f32_16x16x32_bf16 v[96:99], v[36:39], v[136:139], v[96:99]
    ds_read_b64_tr_b16 v[52:53], v9 offset:12288
    v_mfma_f32_16x16x32_bf16 v[96:99], v[40:43], v[144:147], v[96:99]
    ds_read_b64_tr_b16 v[54:55], v9 offset:12800
    v_mfma_f32_16x16x32_bf16 v[96:99], v[44:47], v[152:155], v[96:99]
    ds_read_b64_tr_b16 v[56:57], v5 offset:8192
    v_mfma_f32_16x16x32_bf16 v[100:103], v[32:35], v[132:135], 0
    ds_read_b64_tr_b16 v[58:59], v5 offset:8704
    v_mfma_f32_16x16x32_bf16 v[100:103], v[36:39], v[140:143], v[100:103]
    ds_read_b64_tr_b16 v[60:61], v5 offset:12288
    v_mfma_f32_16x16x32_bf16 v[100:103], v[40:43], v[148:151], v[100:103]
    ds_read_b64_tr_b16 v[62:63], v5 offset:12800
    v_mfma_f32_16x16x32_bf16 v[100:103], v[44:47], v[156:159], v[100:103]
    s_setprio 1
    v_cvt_pk_bf16_f32 v80, v80, v81
    v_cvt_pk_bf16_f32 v81, v82, v83
    v_cvt_pk_bf16_f32 v82, v84, v85
    v_cvt_pk_bf16_f32 v83, v86, v87
    v_cvt_pk_bf16_f32 v88, v88, v89
    v_cvt_pk_bf16_f32 v89, v90, v91
    v_cvt_pk_bf16_f32 v90, v92, v93
    v_cvt_pk_bf16_f32 v91, v94, v95
    v_permlane16_swap_b32 v80, v82
    v_permlane16_swap_b32 v81, v83
    v_and_b32 v80, -2, v80
    buffer_store_dwordx4 v[80:83], v4, s[52:55], s84 offen offset:1024 sc1
    v_permlane16_swap_b32 v88, v90
    v_permlane16_swap_b32 v89, v91
    v_and_b32 v88, -2, v88
    buffer_store_dwordx4 v[88:91], v4, s[52:55], s88 offen offset:1024 sc1
    s_waitcnt lgkmcnt(0)
    v_mfma_f32_16x16x32_bf16 v[104:107], v[48:51], v[128:131], 0
    ds_read_b64_tr_b16 v[32:33], v10 offset:0
    ds_read_b64_tr_b16 v[34:35], v10 offset:512
    v_mfma_f32_16x16x32_bf16 v[104:107], v[52:55], v[136:139], v[104:107]
    ds_read_b64_tr_b16 v[36:37], v10 offset:4096
    v_mfma_f32_16x16x32_bf16 v[104:107], v[56:59], v[144:147], v[104:107]
    ds_read_b64_tr_b16 v[38:39], v10 offset:4608
    v_mfma_f32_16x16x32_bf16 v[104:107], v[60:63], v[152:155], v[104:107]
    ds_read_b64_tr_b16 v[40:41], v6 offset:0
    v_mfma_f32_16x16x32_bf16 v[108:111], v[48:51], v[132:135], 0
    ds_read_b64_tr_b16 v[42:43], v6 offset:512
    v_mfma_f32_16x16x32_bf16 v[108:111], v[52:55], v[140:143], v[108:111]
    ds_read_b64_tr_b16 v[44:45], v6 offset:4096
    v_mfma_f32_16x16x32_bf16 v[108:111], v[56:59], v[148:151], v[108:111]
    ds_read_b64_tr_b16 v[46:47], v6 offset:4608
    v_mfma_f32_16x16x32_bf16 v[108:111], v[60:63], v[156:159], v[108:111]
    s_setprio 0
    s_waitcnt lgkmcnt(0)
    v_mfma_f32_16x16x32_bf16 v[112:115], v[32:35], v[128:131], 0
    ds_read_b64_tr_b16 v[48:49], v10 offset:8192
    ds_read_b64_tr_b16 v[50:51], v10 offset:8704
    v_mfma_f32_16x16x32_bf16 v[112:115], v[36:39], v[136:139], v[112:115]
    ds_read_b64_tr_b16 v[52:53], v10 offset:12288
    v_mfma_f32_16x16x32_bf16 v[112:115], v[40:43], v[144:147], v[112:115]
    ds_read_b64_tr_b16 v[54:55], v10 offset:12800
    v_mfma_f32_16x16x32_bf16 v[112:115], v[44:47], v[152:155], v[112:115]
    ds_read_b64_tr_b16 v[56:57], v6 offset:8192
    v_mfma_f32_16x16x32_bf16 v[116:119], v[32:35], v[132:135], 0
    ds_read_b64_tr_b16 v[58:59], v6 offset:8704
    v_mfma_f32_16x16x32_bf16 v[116:119], v[36:39], v[140:143], v[116:119]
    ds_read_b64_tr_b16 v[60:61], v6 offset:12288
    v_mfma_f32_16x16x32_bf16 v[116:119], v[40:43], v[148:151], v[116:119]
    ds_read_b64_tr_b16 v[62:63], v6 offset:12800
    v_mfma_f32_16x16x32_bf16 v[116:119], v[44:47], v[156:159], v[116:119]
    s_waitcnt vmcnt(5)
    s_setprio 3
    s_barrier
    s_add_u32 m0, s76, 98304
    s_mul_i32 s74, s72, 229376
    buffer_load_dwordx4 v27, s[36:39], s74 offen lds
    s_waitcnt lgkmcnt(0)
    v_mfma_f32_16x16x32_bf16 v[120:123], v[48:51], v[128:131], 0
    ds_read_b64_tr_b16 v[32:33], v9 offset:16384
    ds_read_b64_tr_b16 v[34:35], v9 offset:16896
    v_mfma_f32_16x16x32_bf16 v[120:123], v[52:55], v[136:139], v[120:123]
    ds_read_b64_tr_b16 v[36:37], v9 offset:20480
    v_mfma_f32_16x16x32_bf16 v[120:123], v[56:59], v[144:147], v[120:123]
    ds_read_b64_tr_b16 v[38:39], v9 offset:20992
    v_mfma_f32_16x16x32_bf16 v[120:123], v[60:63], v[152:155], v[120:123]
    ds_read_b64_tr_b16 v[40:41], v5 offset:16384
    v_mfma_f32_16x16x32_bf16 v[124:127], v[48:51], v[132:135], 0
    ds_read_b64_tr_b16 v[42:43], v5 offset:16896
    v_mfma_f32_16x16x32_bf16 v[124:127], v[52:55], v[140:143], v[124:127]
    ds_read_b64_tr_b16 v[44:45], v5 offset:20480
    v_mfma_f32_16x16x32_bf16 v[124:127], v[56:59], v[148:151], v[124:127]
    ds_read_b64_tr_b16 v[46:47], v5 offset:20992
    v_mfma_f32_16x16x32_bf16 v[124:127], v[60:63], v[156:159], v[124:127]
    s_setprio 2
    s_add_u32 m0, s76, 106496
    s_add_u32 s72, s72, 1
    s_and_b32 s72, s72, 7
    buffer_load_dwordx4 v27, s[40:43], s74 offen lds
    s_add_u32 m0, s76, 32768
    s_mul_i32 s74, s72, 229376
    buffer_load_dwordx4 v27, s[36:39], s74 offen lds
    s_add_u32 m0, s76, 40960
    s_add_u32 s72, s72, 1
    s_and_b32 s72, s72, 7
    buffer_load_dwordx4 v27, s[40:43], s74 offen lds
    s_waitcnt lgkmcnt(0)
    v_mfma_f32_16x16x32_bf16 v[96:99], v[32:35], v[160:163], v[96:99]
    ds_read_b64_tr_b16 v[48:49], v9 offset:24576
    ds_read_b64_tr_b16 v[50:51], v9 offset:25088
    v_mfma_f32_16x16x32_bf16 v[96:99], v[36:39], v[168:171], v[96:99]
    ds_read_b64_tr_b16 v[52:53], v9 offset:28672
    v_mfma_f32_16x16x32_bf16 v[96:99], v[40:43], v[176:179], v[96:99]
    ds_read_b64_tr_b16 v[54:55], v9 offset:29184
    v_mfma_f32_16x16x32_bf16 v[96:99], v[44:47], v[184:187], v[96:99]
    ds_read_b64_tr_b16 v[56:57], v5 offset:24576
    v_mfma_f32_16x16x32_bf16 v[100:103], v[44:47], v[188:191], v[100:103]
    ds_read_b64_tr_b16 v[58:59], v5 offset:25088
    v_mfma_f32_16x16x32_bf16 v[100:103], v[40:43], v[180:183], v[100:103]
    ds_read_b64_tr_b16 v[60:61], v5 offset:28672
    v_mfma_f32_16x16x32_bf16 v[100:103], v[36:39], v[172:175], v[100:103]
    ds_read_b64_tr_b16 v[62:63], v5 offset:29184
    v_mfma_f32_16x16x32_bf16 v[100:103], v[32:35], v[164:167], v[100:103]
    s_waitcnt vmcnt(4)
    s_setprio 3
    s_barrier
    v_cmp_eq_u32 vcc, 0, v28
    s_cbranch_vccnz L_s0retryK
L_s0doneK:
    s_lshl4_add_u32 s80, s70, s69
    s_lshl_b32 s80, s80, 7
    s_add_u32 s80, s80, 196608
    s_lshl_b32 s81, s68, 24
    s_add_u32 s80, s80, s81
    v_mov_b32 v21, 1
    s_mov_b64 exec, 1
    buffer_store_dword v21, v17, s[52:55], s80 offen sc1
    s_mov_b64 exec, -1
    s_waitcnt lgkmcnt(0)
    v_mfma_f32_16x16x32_bf16 v[104:107], v[48:51], v[160:163], v[104:107]
    ds_read_b64_tr_b16 v[32:33], v10 offset:16384
    ds_read_b64_tr_b16 v[34:35], v10 offset:16896
    v_mfma_f32_16x16x32_bf16 v[104:107], v[52:55], v[168:171], v[104:107]
    ds_read_b64_tr_b16 v[36:37], v10 offset:20480
    v_mfma_f32_16x16x32_bf16 v[104:107], v[56:59], v[176:179], v[104:107]
    ds_read_b64_tr_b16 v[38:39], v10 offset:20992
    v_mfma_f32_16x16x32_bf16 v[104:107], v[60:63], v[184:187], v[104:107]
    ds_read_b64_tr_b16 v[40:41], v6 offset:16384
    v_mfma_f32_16x16x32_bf16 v[108:111], v[60:63], v[188:191], v[108:111]
    ds_read_b64_tr_b16 v[42:43], v6 offset:16896
    v_mfma_f32_16x16x32_bf16 v[108:111], v[56:59], v[180:183], v[108:111]
    ds_read_b64_tr_b16 v[44:45], v6 offset:20480
    v_mfma_f32_16x16x32_bf16 v[108:111], v[52:55], v[172:175], v[108:111]
    ds_read_b64_tr_b16 v[46:47], v6 offset:20992
    v_mfma_f32_16x16x32_bf16 v[108:111], v[48:51], v[164:167], v[108:111]
    s_setprio 2
    v_and_b32 v152, 31, v15
    v_lshlrev_b32 v152, 2, v152
    v_mov_b32 v154, 0xdddddddd
    v_mov_b32 v141, 0x3f803f80
    s_mov_b32 vcc_lo, 0x22
    s_mov_b32 vcc_hi, 0x22
    v_cndmask_b32 v140, 0, v141, vcc
    v_mov_b32 v141, v140
    s_waitcnt lgkmcnt(0)
    v_mfma_f32_16x16x32_bf16 v[112:115], v[32:35], v[160:163], v[112:115]
    ds_read_b64_tr_b16 v[48:49], v10 offset:24576
    ds_read_b64_tr_b16 v[50:51], v10 offset:25088
    v_mfma_f32_16x16x32_bf16 v[112:115], v[36:39], v[168:171], v[112:115]
    ds_read_b64_tr_b16 v[52:53], v10 offset:28672
    v_mfma_f32_16x16x32_bf16 v[112:115], v[40:43], v[176:179], v[112:115]
    ds_read_b64_tr_b16 v[54:55], v10 offset:29184
    v_mfma_f32_16x16x32_bf16 v[112:115], v[44:47], v[184:187], v[112:115]
    ds_read_b64_tr_b16 v[56:57], v6 offset:24576
    v_mfma_f32_16x16x32_bf16 v[116:119], v[44:47], v[188:191], v[116:119]
    ds_read_b64_tr_b16 v[58:59], v6 offset:25088
    v_mfma_f32_16x16x32_bf16 v[116:119], v[40:43], v[180:183], v[116:119]
    ds_read_b64_tr_b16 v[60:61], v6 offset:28672
    v_mfma_f32_16x16x32_bf16 v[116:119], v[36:39], v[172:175], v[116:119]
    ds_read_b64_tr_b16 v[62:63], v6 offset:29184
    v_mfma_f32_16x16x32_bf16 v[116:119], v[32:35], v[164:167], v[116:119]
    s_waitcnt vmcnt(1)
    s_setprio 3
    s_barrier
    s_waitcnt lgkmcnt(0)
    v_mfma_f32_16x16x32_bf16 v[120:123], v[48:51], v[160:163], v[120:123]
    ds_read_b64_tr_b16 v[32:33], v9 offset:32768
    ds_read_b64_tr_b16 v[34:35], v9 offset:33280
    v_mfma_f32_16x16x32_bf16 v[120:123], v[52:55], v[168:171], v[120:123]
    ds_read_b64_tr_b16 v[36:37], v9 offset:36864
    v_mfma_f32_16x16x32_bf16 v[120:123], v[56:59], v[176:179], v[120:123]
    ds_read_b64_tr_b16 v[38:39], v9 offset:37376
    v_mfma_f32_16x16x32_bf16 v[120:123], v[60:63], v[184:187], v[120:123]
    ds_read_b64_tr_b16 v[40:41], v5 offset:32768
    v_mfma_f32_16x16x32_bf16 v[124:127], v[60:63], v[188:191], v[124:127]
    ds_read_b64_tr_b16 v[42:43], v5 offset:33280
    v_mfma_f32_16x16x32_bf16 v[124:127], v[56:59], v[180:183], v[124:127]
    ds_read_b64_tr_b16 v[44:45], v5 offset:36864
    v_mfma_f32_16x16x32_bf16 v[124:127], v[52:55], v[172:175], v[124:127]
    ds_read_b64_tr_b16 v[46:47], v5 offset:37376
    v_mfma_f32_16x16x32_bf16 v[124:127], v[48:51], v[164:167], v[124:127]
    s_setprio 2
    s_add_u32 m0, s76, 131072
    s_mul_i32 s74, s72, 229376
    buffer_load_dwordx4 v27, s[36:39], s74 offen lds
    s_add_u32 m0, s76, 139264
    s_add_u32 s72, s72, 1
    s_and_b32 s72, s72, 7
    buffer_load_dwordx4 v27, s[40:43], s74 offen lds
    v_mov_b64 v[142:143], v[140:141]
    v_mov_b64 v[144:145], v[140:141]
    v_mov_b64 v[146:147], v[140:141]
    v_mov_b64 v[148:149], v[140:141]
    v_mov_b64 v[150:151], v[140:141]
    s_waitcnt lgkmcnt(0)
    v_mfma_f32_16x16x32_bf16 v[96:99], v[32:35], v[192:195], v[96:99]
    ds_read_b64_tr_b16 v[48:49], v9 offset:40960
    ds_read_b64_tr_b16 v[50:51], v9 offset:41472
    v_mfma_f32_16x16x32_bf16 v[96:99], v[36:39], v[200:203], v[96:99]
    ds_read_b64_tr_b16 v[52:53], v9 offset:45056
    v_mfma_f32_16x16x32_bf16 v[96:99], v[40:43], v[208:211], v[96:99]
    ds_read_b64_tr_b16 v[54:55], v9 offset:45568
    v_mfma_f32_16x16x32_bf16 v[96:99], v[44:47], v[216:219], v[96:99]
    ds_read_b64_tr_b16 v[56:57], v5 offset:40960
    v_mfma_f32_16x16x32_bf16 v[100:103], v[44:47], v[220:223], v[100:103]
    ds_read_b64_tr_b16 v[58:59], v5 offset:41472
    v_mfma_f32_16x16x32_bf16 v[100:103], v[40:43], v[212:215], v[100:103]
    ds_read_b64_tr_b16 v[60:61], v5 offset:45056
    v_mfma_f32_16x16x32_bf16 v[100:103], v[36:39], v[204:207], v[100:103]
    ds_read_b64_tr_b16 v[62:63], v5 offset:45568
    v_mfma_f32_16x16x32_bf16 v[100:103], v[32:35], v[196:199], v[100:103]
    s_setprio 1
    s_add_u32 m0, s76, 147456
    s_mul_i32 s74, s72, 229376
    buffer_load_dwordx4 v27, s[36:39], s74 offen lds
    s_add_u32 m0, s76, 155648
    s_add_u32 s72, s72, 1
    s_and_b32 s72, s72, 7
    buffer_load_dwordx4 v27, s[40:43], s74 offen lds
    v_add_u32 v159, s100, v31
    v_xor_b32 v160, 64, v159
    v_add_u32 v158, 7168, v0
    v_add_u32 v161, s89, v14
    v_xor_b32 v162, 0x400, v161
    s_waitcnt lgkmcnt(0)
    v_mfma_f32_16x16x32_bf16 v[104:107], v[48:51], v[192:195], v[104:107]
    ds_read_b64_tr_b16 v[32:33], v10 offset:32768
    ds_read_b64_tr_b16 v[34:35], v10 offset:33280
    v_mfma_f32_16x16x32_bf16 v[104:107], v[52:55], v[200:203], v[104:107]
    ds_read_b64_tr_b16 v[36:37], v10 offset:36864
    v_mfma_f32_16x16x32_bf16 v[104:107], v[56:59], v[208:211], v[104:107]
    ds_read_b64_tr_b16 v[38:39], v10 offset:37376
    v_mfma_f32_16x16x32_bf16 v[104:107], v[60:63], v[216:219], v[104:107]
    ds_read_b64_tr_b16 v[40:41], v6 offset:32768
    v_mfma_f32_16x16x32_bf16 v[108:111], v[60:63], v[220:223], v[108:111]
    ds_read_b64_tr_b16 v[42:43], v6 offset:33280
    v_mfma_f32_16x16x32_bf16 v[108:111], v[56:59], v[212:215], v[108:111]
    ds_read_b64_tr_b16 v[44:45], v6 offset:36864
    v_mfma_f32_16x16x32_bf16 v[108:111], v[52:55], v[204:207], v[108:111]
    ds_read_b64_tr_b16 v[46:47], v6 offset:37376
    v_mfma_f32_16x16x32_bf16 v[108:111], v[48:51], v[196:199], v[108:111]
    s_setprio 0
    v_lshlrev_b32 v163, 7, v15
    v_mov_b32 v168, 1
    v_lshl_add_u32 v171, v15, 2, s86
    v_lshl_add_u32 v172, v15, 2, s87
    v_mov_b64 v[176:177], 0
    s_waitcnt lgkmcnt(0)
    v_mfma_f32_16x16x32_bf16 v[112:115], v[32:35], v[192:195], v[112:115]
    ds_read_b64_tr_b16 v[48:49], v10 offset:40960
    ds_read_b64_tr_b16 v[50:51], v10 offset:41472
    v_mfma_f32_16x16x32_bf16 v[112:115], v[36:39], v[200:203], v[112:115]
    ds_read_b64_tr_b16 v[52:53], v10 offset:45056
    v_mfma_f32_16x16x32_bf16 v[112:115], v[40:43], v[208:211], v[112:115]
    ds_read_b64_tr_b16 v[54:55], v10 offset:45568
    v_mfma_f32_16x16x32_bf16 v[112:115], v[44:47], v[216:219], v[112:115]
    ds_read_b64_tr_b16 v[56:57], v6 offset:40960
    v_mfma_f32_16x16x32_bf16 v[116:119], v[44:47], v[220:223], v[116:119]
    ds_read_b64_tr_b16 v[58:59], v6 offset:41472
    v_mfma_f32_16x16x32_bf16 v[116:119], v[40:43], v[212:215], v[116:119]
    ds_read_b64_tr_b16 v[60:61], v6 offset:45056
    v_mfma_f32_16x16x32_bf16 v[116:119], v[36:39], v[204:207], v[116:119]
    ds_read_b64_tr_b16 v[62:63], v6 offset:45568
    v_mfma_f32_16x16x32_bf16 v[116:119], v[32:35], v[196:199], v[116:119]
    s_waitcnt vmcnt(0)
    s_setprio 3
    s_barrier
    s_waitcnt lgkmcnt(0)
    v_mfma_f32_16x16x32_bf16 v[120:123], v[48:51], v[192:195], v[120:123]
    ds_read_b64_tr_b16 v[32:33], v7 offset:0
    ds_read_b64_tr_b16 v[34:35], v7 offset:512
    v_mfma_f32_16x16x32_bf16 v[120:123], v[52:55], v[200:203], v[120:123]
    ds_read_b64_tr_b16 v[36:37], v7 offset:4096
    v_mfma_f32_16x16x32_bf16 v[120:123], v[56:59], v[208:211], v[120:123]
    ds_read_b64_tr_b16 v[38:39], v7 offset:4608
    v_mfma_f32_16x16x32_bf16 v[120:123], v[60:63], v[216:219], v[120:123]
    ds_read_b64_tr_b16 v[40:41], v7 offset:16384
    v_mfma_f32_16x16x32_bf16 v[124:127], v[60:63], v[220:223], v[124:127]
    ds_read_b64_tr_b16 v[42:43], v7 offset:16896
    v_mfma_f32_16x16x32_bf16 v[124:127], v[56:59], v[212:215], v[124:127]
    ds_read_b64_tr_b16 v[44:45], v7 offset:20480
    v_mfma_f32_16x16x32_bf16 v[124:127], v[52:55], v[204:207], v[124:127]
    ds_read_b64_tr_b16 v[46:47], v7 offset:20992
    v_mfma_f32_16x16x32_bf16 v[124:127], v[48:51], v[196:199], v[124:127]
    s_setprio 2
    v_mov_b64 v[178:179], 0
    v_mov_b64 v[180:181], 0
    v_mov_b64 v[182:183], 0
    v_mov_b64 v[184:185], 0
    v_mov_b64 v[186:187], 0
    s_waitcnt lgkmcnt(0)
    v_mfma_f32_16x16x32_bf16 v[96:99], v[32:35], v[224:227], v[96:99]
    ds_read_b64_tr_b16 v[48:49], v7 offset:8192
    ds_read_b64_tr_b16 v[50:51], v7 offset:8704
    v_mfma_f32_16x16x32_bf16 v[96:99], v[36:39], v[232:235], v[96:99]
    ds_read_b64_tr_b16 v[52:53], v7 offset:12288
    v_mfma_f32_16x16x32_bf16 v[96:99], v[40:43], v[240:243], v[96:99]
    ds_read_b64_tr_b16 v[54:55], v7 offset:12800
    v_mfma_f32_16x16x32_bf16 v[96:99], v[44:47], v[248:251], v[96:99]
    ds_read_b64_tr_b16 v[56:57], v7 offset:24576
    v_mfma_f32_16x16x32_bf16 v[100:103], v[44:47], v[252:255], v[100:103]
    ds_read_b64_tr_b16 v[58:59], v7 offset:25088
    v_mfma_f32_16x16x32_bf16 v[100:103], v[40:43], v[244:247], v[100:103]
    ds_read_b64_tr_b16 v[60:61], v7 offset:28672
    v_mfma_f32_16x16x32_bf16 v[100:103], v[36:39], v[236:239], v[100:103]
    ds_read_b64_tr_b16 v[62:63], v7 offset:29184
    v_mfma_f32_16x16x32_bf16 v[100:103], v[32:35], v[228:231], v[100:103]
    s_setprio 1
    v_mov_b64 v[188:189], 0
    v_mov_b64 v[190:191], 0
    v_mov_b64 v[192:193], 0
    v_mov_b64 v[194:195], 0
    v_mov_b64 v[196:197], 0
    s_waitcnt lgkmcnt(0)
    v_mfma_f32_16x16x32_bf16 v[104:107], v[48:51], v[224:227], v[104:107]
    ds_read_b64_tr_b16 v[32:33], v8 offset:0
    ds_read_b64_tr_b16 v[34:35], v8 offset:512
    v_mfma_f32_16x16x32_bf16 v[104:107], v[52:55], v[232:235], v[104:107]
    ds_read_b64_tr_b16 v[36:37], v8 offset:4096
    v_mfma_f32_16x16x32_bf16 v[104:107], v[56:59], v[240:243], v[104:107]
    ds_read_b64_tr_b16 v[38:39], v8 offset:4608
    v_mfma_f32_16x16x32_bf16 v[104:107], v[60:63], v[248:251], v[104:107]
    ds_read_b64_tr_b16 v[40:41], v8 offset:16384
    v_mfma_f32_16x16x32_bf16 v[108:111], v[60:63], v[252:255], v[108:111]
    ds_read_b64_tr_b16 v[42:43], v8 offset:16896
    v_mfma_f32_16x16x32_bf16 v[108:111], v[56:59], v[244:247], v[108:111]
    ds_read_b64_tr_b16 v[44:45], v8 offset:20480
    v_mfma_f32_16x16x32_bf16 v[108:111], v[52:55], v[236:239], v[108:111]
    ds_read_b64_tr_b16 v[46:47], v8 offset:20992
    v_mfma_f32_16x16x32_bf16 v[108:111], v[48:51], v[228:231], v[108:111]
    s_setprio 0
    s_cmp_lg_u32 s68, 0
    s_cbranch_scc1 L_nopoll0K
    s_mov_b32 s81, 196608
    v_lshlrev_b32 v21, 7, v15
    buffer_load_dword v20, v21, s[52:55], s81 offen sc1
L_nopoll0K:
    v_mov_b64 v[198:199], 0
    v_mov_b64 v[200:201], 0
    v_mov_b64 v[202:203], 0
    v_mov_b64 v[204:205], 0
    v_mov_b64 v[206:207], 0
    s_waitcnt lgkmcnt(0)
    v_mfma_f32_16x16x32_bf16 v[112:115], v[32:35], v[224:227], v[112:115]
    ds_read_b64_tr_b16 v[48:49], v8 offset:8192
    ds_read_b64_tr_b16 v[50:51], v8 offset:8704
    v_mfma_f32_16x16x32_bf16 v[112:115], v[36:39], v[232:235], v[112:115]
    ds_read_b64_tr_b16 v[52:53], v8 offset:12288
    v_mfma_f32_16x16x32_bf16 v[112:115], v[40:43], v[240:243], v[112:115]
    ds_read_b64_tr_b16 v[54:55], v8 offset:12800
    v_mfma_f32_16x16x32_bf16 v[112:115], v[44:47], v[248:251], v[112:115]
    ds_read_b64_tr_b16 v[56:57], v8 offset:24576
    v_mfma_f32_16x16x32_bf16 v[116:119], v[44:47], v[252:255], v[116:119]
    ds_read_b64_tr_b16 v[58:59], v8 offset:25088
    v_mfma_f32_16x16x32_bf16 v[116:119], v[40:43], v[244:247], v[116:119]
    ds_read_b64_tr_b16 v[60:61], v8 offset:28672
    v_mfma_f32_16x16x32_bf16 v[116:119], v[36:39], v[236:239], v[116:119]
    ds_read_b64_tr_b16 v[62:63], v8 offset:29184
    v_mfma_f32_16x16x32_bf16 v[116:119], v[32:35], v[228:231], v[116:119]
    s_waitcnt lgkmcnt(0)
    s_branch L_join
.p2align 12
.fill 96, 4, 0xbf800000
L_pathV:
    s_mov_b32 s44, s6
    s_mov_b32 s45, s7
    s_mov_b32 s46, 524288
    s_mov_b32 s47, 0x20000
    s_mov_b32 s36, s16
    s_mov_b32 s37, s17
    s_mov_b32 s38, 1835008
    s_mov_b32 s39, 0x20000
    s_mov_b32 s40, s18
    s_mov_b32 s41, s19
    s_mov_b32 s42, 1835008
    s_mov_b32 s43, 0x20000
    s_mov_b32 s48, s10
    s_mov_b32 s49, s11
    s_mov_b32 s50, 16384
    s_mov_b32 s51, 0x20000
    v_lshrrev_b32 v22, 4, v15
    v_and_b32 v20, 15, v15
    v_lshlrev_b32 v21, 3, v20
    v_lshl_add_u32 v21, v22, 8, v21
    v_and_b32 v23, 1, v22
    v_lshl_add_u32 v21, v23, 7, v21
    v_add_u32 v12, 131072, v21
    v_xor_b32 v13, 0x80, v12
    v_lshlrev_b32 v21, 7, v23
    v_xor_b32 v11, v21, v14
    s_add_u32 s91, s68, s79
    s_and_b32 s91, s91, 7
    s_lshl_b32 s91, s91, 11
    s_lshr_b32 s90, s84, 15
    v_lshrrev_b32 v22, 1, v22
    s_lshl2_add_u32 s90, s90, s85
    s_lshl_b32 s90, s90, 9
    s_add_u32 s90, s90, 1024
    v_lshlrev_b32 v22, 8, v22
    v_and_b32 v20, 1, v15
    v_bfe_u32 v21, v15, 1, 2
    v_lshl_add_u32 v20, v21, 2, v20
    v_bfe_u32 v21, v15, 3, 1
    v_lshl_add_u32 v20, v21, 1, v20
    v_lshl_add_u32 v22, v20, 4, v22
    v_lshl_add_u32 v30, v23, 3, v22
    s_add_u32 m0, s76, 16384
    s_lshl_b32 s73, s72, 7
    buffer_load_dwordx4 v1, s[32:35], s73 offen lds
    s_add_u32 m0, s75, 131072
    s_nop 0
    buffer_load_dwordx4 v11, s[48:51], s91 offen lds
    buffer_load_dwordx4 v11, s[48:51], s91 offen offset:1024 lds
    s_add_u32 m0, s76, 81920
    s_mul_i32 s74, s72, 65536
    buffer_load_dwordx4 v3, s[44:47], s74 offen lds
    s_add_u32 m0, s76, 90112
    s_add_u32 s74, s74, 128
    s_add_u32 s72, s72, 1
    buffer_load_dwordx4 v3, s[44:47], s74 offen lds
    s_add_u32 m0, s76, 24576
    s_and_b32 s72, s72, 7
    buffer_load_dwordx4 v2, s[32:35], s73 offen lds
    s_lshr_b32 s80, s68, 2
    s_lshl_b32 s81, s80, 16
    v_add_u32 v26, s81, v14
    s_and_b32 s81, s68, 1
    s_mul_i32 s81, s81, 49152
    v_add_u32 v24, s81, v14
    v_add_u32 v25, s81, v29
    s_mul_i32 s81, s80, 49152
    s_and_b32 s86, s68, 3
    s_lshl_b32 s87, s86, 11
    s_add_u32 s83, s87, s81
    s_lshl_b32 s87, s2, 2
    s_add_u32 s86, s86, s87
    s_and_b32 s86, s86, 31
    s_lshl_b32 s85, s86, 11
    s_add_u32 s1, s101, 3145728
    s_xor_b32 s1, s1, 1024
    s_lshl1_add_u32 s79, s77, s80
    s_lshl_b32 s79, s79, 7
    s_add_u32 s79, s79, 131072
    s_lshr_b32 s86, s77, 3
    s_lshl3_add_u32 s86, s86, s68
    s_mul_i32 s86, s86, 224
    s_and_b32 s87, s77, 7
    s_lshl1_add_u32 s87, s87, s80
    s_add_u32 s86, s86, s87
    s_lshl_b32 s86, s86, 10
    s_add_u32 s89, s86, 5242880
    s_lshr_b32 s97, s77, 1
    s_lshl_b32 s97, s97, 9
    s_add_u32 s97, s97, 204800
    s_lshl_b32 s81, s68, 24
    s_add_u32 s98, s98, s81
    s_mul_i32 s86, s68, 2304
    s_add_u32 s86, s86, 65536
    s_xor_b32 s87, s68, 1
    s_mul_i32 s87, s87, 2304
    s_add_u32 s87, s87, 65536
    s_waitcnt vmcnt(6)
    s_setprio 3
    s_barrier
    s_add_u32 m0, s76, 32768
    s_lshl_b32 s73, s72, 7
    buffer_load_dwordx4 v1, s[32:35], s73 offen lds
    s_waitcnt lgkmcnt(0)
    ds_read_b128 v[128:131], v5 offset:0
    ds_read_b128 v[132:135], v6 offset:0
    ds_read_b64_tr_b16 v[32:33], v9 offset:0
    ds_read_b64_tr_b16 v[34:35], v9 offset:512
    ds_read_b64_tr_b16 v[36:37], v9 offset:8192
    ds_read_b64_tr_b16 v[38:39], v9 offset:8704
    ds_read_b64_tr_b16 v[40:41], v10 offset:0
    ds_read_b64_tr_b16 v[42:43], v10 offset:512
    ds_read_b64_tr_b16 v[44:45], v10 offset:8192
    ds_read_b64_tr_b16 v[46:47], v10 offset:8704
    s_add_u32 m0, s76, 98304
    s_mul_i32 s74, s72, 65536
    buffer_load_dwordx4 v3, s[44:47], s74 offen lds
    s_add_u32 m0, s76, 106496
    s_add_u32 s74, s74, 128
    s_add_u32 s72, s72, 1
    buffer_load_dwordx4 v3, s[44:47], s74 offen lds
    s_add_u32 m0, s76, 40960
    s_and_b32 s72, s72, 7
    buffer_load_dwordx4 v2, s[32:35], s73 offen lds
    s_waitcnt lgkmcnt(0)
    v_mfma_f32_16x16x32_bf16 v[64:67], v[32:35], v[128:131], 0
    ds_read_b128 v[136:139], v7 offset:0
    ds_read_b128 v[140:143], v8 offset:0
    v_mfma_f32_16x16x32_bf16 v[68:71], v[32:35], v[132:135], 0
    ds_read_b64_tr_b16 v[48:49], v9 offset:4096
    v_mfma_f32_16x16x32_bf16 v[72:75], v[36:39], v[128:131], 0
    ds_read_b64_tr_b16 v[50:51], v9 offset:4608
    ds_read_b64_tr_b16 v[52:53], v9 offset:12288
    v_mfma_f32_16x16x32_bf16 v[76:79], v[36:39], v[132:135], 0
    ds_read_b64_tr_b16 v[54:55], v9 offset:12800
    v_mfma_f32_16x16x32_bf16 v[80:83], v[40:43], v[128:131], 0
    ds_read_b64_tr_b16 v[56:57], v10 offset:4096
    ds_read_b64_tr_b16 v[58:59], v10 offset:4608
    v_mfma_f32_16x16x32_bf16 v[84:87], v[40:43], v[132:135], 0
    ds_read_b64_tr_b16 v[60:61], v10 offset:12288
    v_mfma_f32_16x16x32_bf16 v[88:91], v[44:47], v[128:131], 0
    ds_read_b64_tr_b16 v[62:63], v10 offset:12800
    v_mfma_f32_16x16x32_bf16 v[92:95], v[44:47], v[132:135], 0
    s_waitcnt vmcnt(4)
    s_setprio 3
    s_barrier
    s_add_u32 m0, s76, 49152
    s_lshl_b32 s73, s72, 7
    buffer_load_dwordx4 v1, s[32:35], s73 offen lds
    s_waitcnt lgkmcnt(0)
    v_mfma_f32_16x16x32_bf16 v[64:67], v[48:51], v[136:139], v[64:67]
    ds_read_b128 v[144:147], v5 offset:16384
    ds_read_b128 v[148:151], v6 offset:16384
    v_mfma_f32_16x16x32_bf16 v[68:71], v[48:51], v[140:143], v[68:71]
    ds_read_b64_tr_b16 v[32:33], v9 offset:16384
    ds_read_b64_tr_b16 v[34:35], v9 offset:16896
    v_mfma_f32_16x16x32_bf16 v[72:75], v[52:55], v[136:139], v[72:75]
    ds_read_b64_tr_b16 v[36:37], v9 offset:24576
    ds_read_b64_tr_b16 v[38:39], v9 offset:25088
    v_mfma_f32_16x16x32_bf16 v[76:79], v[52:55], v[140:143], v[76:79]
    ds_read_b64_tr_b16 v[40:41], v10 offset:16384
    ds_read_b64_tr_b16 v[42:43], v10 offset:16896
    v_mfma_f32_16x16x32_bf16 v[80:83], v[56:59], v[136:139], v[80:83]
    ds_read_b64_tr_b16 v[44:45], v10 offset:24576
    ds_read_b64_tr_b16 v[46:47], v10 offset:25088
    v_mfma_f32_16x16x32_bf16 v[84:87], v[56:59], v[140:143], v[84:87]
    ds_read_b64_tr_b16 v[100:101], v12 offset:0
    ds_read_b64_tr_b16 v[102:103], v13 offset:0
    v_mfma_f32_16x16x32_bf16 v[88:91], v[60:63], v[136:139], v[88:91]
    ds_read_b64_tr_b16 v[104:105], v12 offset:1024
    ds_read_b64_tr_b16 v[106:107], v13 offset:1024
    v_mfma_f32_16x16x32_bf16 v[92:95], v[60:63], v[140:143], v[92:95]
    s_setprio 2
    s_add_u32 m0, s76, 114688
    s_mul_i32 s74, s72, 65536
    buffer_load_dwordx4 v3, s[44:47], s74 offen lds
    s_add_u32 m0, s76, 122880
    s_add_u32 s74, s74, 128
    s_add_u32 s72, s72, 1
    buffer_load_dwordx4 v3, s[44:47], s74 offen lds
    s_add_u32 m0, s76, 57344
    s_and_b32 s72, s72, 7
    buffer_load_dwordx4 v2, s[32:35], s73 offen lds
    s_waitcnt lgkmcnt(0)
    v_mfma_f32_16x16x32_bf16 v[64:67], v[32:35], v[144:147], v[64:67]
    ds_read_b128 v[152:155], v7 offset:16384
    ds_read_b128 v[156:159], v8 offset:16384
    v_mfma_f32_16x16x32_bf16 v[96:99], v[128:131], v[100:103], 0
    ds_read_b64_tr_b16 v[48:49], v9 offset:20480
    ds_read_b64_tr_b16 v[50:51], v9 offset:20992
    v_mfma_f32_16x16x32_bf16 v[68:71], v[32:35], v[148:151], v[68:71]
    ds_read_b64_tr_b16 v[52:53], v9 offset:28672
    v_mfma_f32_16x16x32_bf16 v[72:75], v[36:39], v[144:147], v[72:75]
    ds_read_b64_tr_b16 v[54:55], v9 offset:29184
    ds_read_b64_tr_b16 v[56:57], v10 offset:20480
    v_mfma_f32_16x16x32_bf16 v[76:79], v[36:39], v[148:151], v[76:79]
    ds_read_b64_tr_b16 v[58:59], v10 offset:20992
    v_mfma_f32_16x16x32_bf16 v[80:83], v[40:43], v[144:147], v[80:83]
    ds_read_b64_tr_b16 v[60:61], v10 offset:28672
    ds_read_b64_tr_b16 v[62:63], v10 offset:29184
    v_mfma_f32_16x16x32_bf16 v[96:99], v[136:139], v[104:107], v[96:99]
    ds_read_b64_tr_b16 v[108:109], v12 offset:2048
    v_mfma_f32_16x16x32_bf16 v[84:87], v[40:43], v[148:151], v[84:87]
    ds_read_b64_tr_b16 v[110:111], v13 offset:2048
    ds_read_b64_tr_b16 v[112:113], v12 offset:3072
    v_mfma_f32_16x16x32_bf16 v[88:91], v[44:47], v[144:147], v[88:91]
    ds_read_b64_tr_b16 v[114:115], v13 offset:3072
    v_mfma_f32_16x16x32_bf16 v[92:95], v[44:47], v[148:151], v[92:95]
    s_waitcnt vmcnt(4)
    s_setprio 3
    s_barrier
    s_add_u32 m0, s76, 0
    s_lshl_b32 s73, s72, 7
    buffer_load_dwordx4 v1, s[32:35], s73 offen lds
    s_waitcnt lgkmcnt(0)
    v_mfma_f32_16x16x32_bf16 v[64:67], v[48:51], v[152:155], v[64:67]
    ds_read_b128 v[160:163], v5 offset:32768
    ds_read_b128 v[164:167], v6 offset:32768
    v_mfma_f32_16x16x32_bf16 v[96:99], v[144:147], v[108:111], v[96:99]
    ds_read_b64_tr_b16 v[32:33], v9 offset:32768
    v_mfma_f32_16x16x32_bf16 v[68:71], v[48:51], v[156:159], v[68:71]
    ds_read_b64_tr_b16 v[34:35], v9 offset:33280
    v_mfma_f32_16x16x32_bf16 v[72:75], v[52:55], v[152:155], v[72:75]
    ds_read_b64_tr_b16 v[36:37], v9 offset:40960
    ds_read_b64_tr_b16 v[38:39], v9 offset:41472
    v_mfma_f32_16x16x32_bf16 v[76:79], v[52:55], v[156:159], v[76:79]
    ds_read_b64_tr_b16 v[40:41], v10 offset:32768
    v_mfma_f32_16x16x32_bf16 v[80:83], v[56:59], v[152:155], v[80:83]
    ds_read_b64_tr_b16 v[42:43], v10 offset:33280
    v_mfma_f32_16x16x32_bf16 v[96:99], v[152:155], v[112:115], v[96:99]
    ds_read_b64_tr_b16 v[44:45], v10 offset:40960
    ds_read_b64_tr_b16 v[46:47], v10 offset:41472
    v_mfma_f32_16x16x32_bf16 v[84:87], v[56:59], v[156:159], v[84:87]
    ds_read_b64_tr_b16 v[100:101], v12 offset:4096
    v_mfma_f32_16x16x32_bf16 v[88:91], v[60:63], v[152:155], v[88:91]
    ds_read_b64_tr_b16 v[102:103], v13 offset:4096
    v_mfma_f32_16x16x32_bf16 v[92:95], v[60:63], v[156:159], v[92:95]
    s_setprio 2
    s_add_u32 m0, s76, 65536
    s_mul_i32 s74, s72, 65536
    buffer_load_dwordx4 v3, s[44:47], s74 offen lds
    s_add_u32 m0, s76, 73728
    s_add_u32 s74, s74, 128
    s_add_u32 s72, s72, 1
    buffer_load_dwordx4 v3, s[44:47], s74 offen lds
    s_add_u32 m0, s76, 8192
    s_and_b32 s72, s72, 7
    buffer_load_dwordx4 v2, s[32:35], s73 offen lds
    s_waitcnt lgkmcnt(0)
    v_mfma_f32_16x16x32_bf16 v[64:67], v[32:35], v[160:163], v[64:67]
    ds_read_b128 v[168:171], v7 offset:32768
    ds_read_b128 v[172:175], v8 offset:32768
    v_mfma_f32_16x16x32_bf16 v[96:99], v[160:163], v[100:103], v[96:99]
    ds_read_b64_tr_b16 v[48:49], v9 offset:36864
    v_mfma_f32_16x16x32_bf16 v[68:71], v[32:35], v[164:167], v[68:71]
    ds_read_b64_tr_b16 v[50:51], v9 offset:37376
    ds_read_b64_tr_b16 v[52:53], v9 offset:45056
    v_mfma_f32_16x16x32_bf16 v[72:75], v[36:39], v[160:163], v[72:75]
    ds_read_b64_tr_b16 v[54:55], v9 offset:45568
    v_mfma_f32_16x16x32_bf16 v[76:79], v[36:39], v[164:167], v[76:79]
    ds_read_b64_tr_b16 v[56:57], v10 offset:36864
    ds_read_b64_tr_b16 v[58:59], v10 offset:37376
    v_mfma_f32_16x16x32_bf16 v[80:83], v[40:43], v[160:163], v[80:83]
    ds_read_b64_tr_b16 v[60:61], v10 offset:45056
    v_mfma_f32_16x16x32_bf16 v[84:87], v[40:43], v[164:167], v[84:87]
    ds_read_b64_tr_b16 v[62:63], v10 offset:45568
    ds_read_b64_tr_b16 v[108:109], v12 offset:5120
    v_mfma_f32_16x16x32_bf16 v[88:91], v[44:47], v[160:163], v[88:91]
    ds_read_b64_tr_b16 v[110:111], v13 offset:5120
    v_mfma_f32_16x16x32_bf16 v[92:95], v[44:47], v[164:167], v[92:95]
    s_waitcnt vmcnt(4)
    s_setprio 3
    s_barrier
    s_add_u32 m0, s76, 16384
    s_lshl_b32 s73, s72, 7
    buffer_load_dwordx4 v1, s[32:35], s73 offen lds
    s_waitcnt lgkmcnt(0)
    v_mfma_f32_16x16x32_bf16 v[64:67], v[48:51], v[168:171], v[64:67]
    ds_read_b128 v[176:179], v5 offset:49152
    ds_read_b128 v[180:183], v6 offset:49152
    v_mfma_f32_16x16x32_bf16 v[96:99], v[168:171], v[108:111], v[96:99]
    ds_read_b64_tr_b16 v[32:33], v9 offset:49152
    v_mfma_f32_16x16x32_bf16 v[68:71], v[48:51], v[172:175], v[68:71]
    ds_read_b64_tr_b16 v[34:35], v9 offset:49664
    ds_read_b64_tr_b16 v[36:37], v9 offset:57344
    v_mfma_f32_16x16x32_bf16 v[72:75], v[52:55], v[168:171], v[72:75]
    ds_read_b64_tr_b16 v[38:39], v9 offset:57856
    v_mfma_f32_16x16x32_bf16 v[76:79], v[52:55], v[172:175], v[76:79]
    ds_read_b64_tr_b16 v[40:41], v10 offset:49152
    ds_read_b64_tr_b16 v[42:43], v10 offset:49664
    v_mfma_f32_16x16x32_bf16 v[80:83], v[56:59], v[168:171], v[80:83]
    ds_read_b64_tr_b16 v[44:45], v10 offset:57344
    v_mfma_f32_16x16x32_bf16 v[84:87], v[56:59], v[172:175], v[84:87]
    ds_read_b64_tr_b16 v[46:47], v10 offset:57856
    ds_read_b64_tr_b16 v[100:101], v12 offset:6144
    v_mfma_f32_16x16x32_bf16 v[88:91], v[60:63], v[168:171], v[88:91]
    ds_read_b64_tr_b16 v[102:103], v13 offset:6144
    v_mfma_f32_16x16x32_bf16 v[92:95], v[60:63], v[172:175], v[92:95]
    s_setprio 2
    s_add_u32 m0, s76, 81920
    s_mul_i32 s74, s72, 65536
    buffer_load_dwordx4 v3, s[44:47], s74 offen lds
    s_add_u32 m0, s76, 90112
    s_add_u32 s74, s74, 128
    s_add_u32 s72, s72, 1
    buffer_load_dwordx4 v3, s[44:47], s74 offen lds
    s_add_u32 m0, s76, 24576
    s_and_b32 s72, s72, 7
    buffer_load_dwordx4 v2, s[32:35], s73 offen lds
    s_waitcnt lgkmcnt(0)
    v_mfma_f32_16x16x32_bf16 v[64:67], v[32:35], v[176:179], v[64:67]
    ds_read_b128 v[184:187], v7 offset:49152
    ds_read_b128 v[188:191], v8 offset:49152
    v_mfma_f32_16x16x32_bf16 v[96:99], v[176:179], v[100:103], v[96:99]
    ds_read_b64_tr_b16 v[48:49], v9 offset:53248
    v_mfma_f32_16x16x32_bf16 v[68:71], v[32:35], v[180:183], v[68:71]
    ds_read_b64_tr_b16 v[50:51], v9 offset:53760
    ds_read_b64_tr_b16 v[52:53], v9 offset:61440
    v_mfma_f32_16x16x32_bf16 v[72:75], v[36:39], v[176:179], v[72:75]
    ds_read_b64_tr_b16 v[54:55], v9 offset:61952
    v_mfma_f32_16x16x32_bf16 v[76:79], v[36:39], v[180:183], v[76:79]
    ds_read_b64_tr_b16 v[56:57], v10 offset:53248
    ds_read_b64_tr_b16 v[58:59], v10 offset:53760
    v_mfma_f32_16x16x32_bf16 v[80:83], v[40:43], v[176:179], v[80:83]
    ds_read_b64_tr_b16 v[60:61], v10 offset:61440
    v_mfma_f32_16x16x32_bf16 v[84:87], v[40:43], v[180:183], v[84:87]
    ds_read_b64_tr_b16 v[62:63], v10 offset:61952
    ds_read_b64_tr_b16 v[108:109], v12 offset:7168
    v_mfma_f32_16x16x32_bf16 v[88:91], v[44:47], v[176:179], v[88:91]
    ds_read_b64_tr_b16 v[110:111], v13 offset:7168
    v_mfma_f32_16x16x32_bf16 v[92:95], v[44:47], v[180:183], v[92:95]
    s_waitcnt vmcnt(4)
    s_setprio 3
    s_barrier
    s_add_u32 m0, s76, 32768
    s_lshl_b32 s73, s72, 7
    buffer_load_dwordx4 v1, s[32:35], s73 offen lds
    s_waitcnt lgkmcnt(0)
    v_mfma_f32_16x16x32_bf16 v[64:67], v[48:51], v[184:187], v[64:67]
    ds_read_b128 v[192:195], v5 offset:0
    ds_read_b128 v[196:199], v6 offset:0
    v_mfma_f32_16x16x32_bf16 v[96:99], v[184:187], v[108:111], v[96:99]
    ds_read_b64_tr_b16 v[32:33], v9 offset:0
    v_mfma_f32_16x16x32_bf16 v[68:71], v[48:51], v[188:191], v[68:71]
    ds_read_b64_tr_b16 v[34:35], v9 offset:512
    ds_read_b64_tr_b16 v[36:37], v9 offset:8192
    v_mfma_f32_16x16x32_bf16 v[72:75], v[52:55], v[184:187], v[72:75]
    ds_read_b64_tr_b16 v[38:39], v9 offset:8704
    v_mfma_f32_16x16x32_bf16 v[76:79], v[52:55], v[188:191], v[76:79]
    ds_read_b64_tr_b16 v[40:41], v10 offset:0
    ds_read_b64_tr_b16 v[42:43], v10 offset:512
    v_mfma_f32_16x16x32_bf16 v[80:83], v[56:59], v[184:187], v[80:83]
    ds_read_b64_tr_b16 v[44:45], v10 offset:8192
    v_mfma_f32_16x16x32_bf16 v[84:87], v[56:59], v[188:191], v[84:87]
    ds_read_b64_tr_b16 v[46:47], v10 offset:8704
    ds_read_b64_tr_b16 v[100:101], v12 offset:8192
    v_mfma_f32_16x16x32_bf16 v[88:91], v[60:63], v[184:187], v[88:91]
    ds_read_b64_tr_b16 v[102:103], v13 offset:8192
    v_mfma_f32_16x16x32_bf16 v[92:95], v[60:63], v[188:191], v[92:95]
    s_setprio 2
    s_add_u32 m0, s76, 98304
    s_mul_i32 s74, s72, 65536
    buffer_load_dwordx4 v3, s[44:47], s74 offen lds
    s_add_u32 m0, s76, 106496
    s_add_u32 s74, s74, 128
    s_add_u32 s72, s72, 1
    buffer_load_dwordx4 v3, s[44:47], s74 offen lds
    s_add_u32 m0, s76, 40960
    s_and_b32 s72, s72, 7
    buffer_load_dwordx4 v2, s[32:35], s73 offen lds
    s_waitcnt lgkmcnt(0)
    v_mfma_f32_16x16x32_bf16 v[64:67], v[32:35], v[192:195], v[64:67]
    ds_read_b128 v[200:203], v7 offset:0
    ds_read_b128 v[204:207], v8 offset:0
    v_mfma_f32_16x16x32_bf16 v[96:99], v[192:195], v[100:103], v[96:99]
    ds_read_b64_tr_b16 v[48:49], v9 offset:4096
    v_mfma_f32_16x16x32_bf16 v[68:71], v[32:35], v[196:199], v[68:71]
    ds_read_b64_tr_b16 v[50:51], v9 offset:4608
    ds_read_b64_tr_b16 v[52:53], v9 offset:12288
    v_mfma_f32_16x16x32_bf16 v[72:75], v[36:39], v[192:195], v[72:75]
    ds_read_b64_tr_b16 v[54:55], v9 offset:12800
    v_mfma_f32_16x16x32_bf16 v[76:79], v[36:39], v[196:199], v[76:79]
    ds_read_b64_tr_b16 v[56:57], v10 offset:4096
    ds_read_b64_tr_b16 v[58:59], v10 offset:4608
    v_mfma_f32_16x16x32_bf16 v[80:83], v[40:43], v[192:195], v[80:83]
    ds_read_b64_tr_b16 v[60:61], v10 offset:12288
    v_mfma_f32_16x16x32_bf16 v[84:87], v[40:43], v[196:199], v[84:87]
    ds_read_b64_tr_b16 v[62:63], v10 offset:12800
    ds_read_b64_tr_b16 v[108:109], v12 offset:9216
    v_mfma_f32_16x16x32_bf16 v[88:91], v[44:47], v[192:195], v[88:91]
    ds_read_b64_tr_b16 v[110:111], v13 offset:9216
    v_mfma_f32_16x16x32_bf16 v[92:95], v[44:47], v[196:199], v[92:95]
    s_waitcnt vmcnt(4)
    s_setprio 3
    s_barrier
    s_add_u32 m0, s76, 49152
    s_lshl_b32 s73, s72, 7
    buffer_load_dwordx4 v1, s[32:35], s73 offen lds
    s_waitcnt lgkmcnt(0)
    v_mfma_f32_16x16x32_bf16 v[64:67], v[48:51], v[200:203], v[64:67]
    ds_read_b128 v[208:211], v5 offset:16384
    ds_read_b128 v[212:215], v6 offset:16384
    v_mfma_f32_16x16x32_bf16 v[96:99], v[200:203], v[108:111], v[96:99]
    ds_read_b64_tr_b16 v[32:33], v9 offset:16384
    v_mfma_f32_16x16x32_bf16 v[68:71], v[48:51], v[204:207], v[68:71]
    ds_read_b64_tr_b16 v[34:35], v9 offset:16896
    ds_read_b64_tr_b16 v[36:37], v9 offset:24576
    v_mfma_f32_16x16x32_bf16 v[72:75], v[52:55], v[200:203], v[72:75]
    ds_read_b64_tr_b16 v[38:39], v9 offset:25088
    v_mfma_f32_16x16x32_bf16 v[76:79], v[52:55], v[204:207], v[76:79]
    ds_read_b64_tr_b16 v[40:41], v10 offset:16384
    ds_read_b64_tr_b16 v[42:43], v10 offset:16896
    v_mfma_f32_16x16x32_bf16 v[80:83], v[56:59], v[200:203], v[80:83]
    ds_read_b64_tr_b16 v[44:45], v10 offset:24576
    v_mfma_f32_16x16x32_bf16 v[84:87], v[56:59], v[204:207], v[84:87]
    ds_read_b64_tr_b16 v[46:47], v10 offset:25088
    ds_read_b64_tr_b16 v[100:101], v12 offset:10240
    v_mfma_f32_16x16x32_bf16 v[88:91], v[60:63], v[200:203], v[88:91]
    ds_read_b64_tr_b16 v[102:103], v13 offset:10240
    v_mfma_f32_16x16x32_bf16 v[92:95], v[60:63], v[204:207], v[92:95]
    s_setprio 2
    s_add_u32 m0, s76, 114688
    s_mul_i32 s74, s72, 65536
    buffer_load_dwordx4 v3, s[44:47], s74 offen lds
    s_add_u32 m0, s76, 122880
    s_add_u32 s74, s74, 128
    s_add_u32 s72, s72, 1
    buffer_load_dwordx4 v3, s[44:47], s74 offen lds
    s_add_u32 m0, s76, 57344
    s_and_b32 s72, s72, 7
    buffer_load_dwordx4 v2, s[32:35], s73 offen lds
    s_waitcnt lgkmcnt(0)
    v_mfma_f32_16x16x32_bf16 v[64:67], v[32:35], v[208:211], v[64:67]
    ds_read_b128 v[216:219], v7 offset:16384
    ds_read_b128 v[220:223], v8 offset:16384
    v_mfma_f32_16x16x32_bf16 v[96:99], v[208:211], v[100:103], v[96:99]
    ds_read_b64_tr_b16 v[48:49], v9 offset:20480
    v_mfma_f32_16x16x32_bf16 v[68:71], v[32:35], v[212:215], v[68:71]
    ds_read_b64_tr_b16 v[50:51], v9 offset:20992
    ds_read_b64_tr_b16 v[52:53], v9 offset:28672
    v_mfma_f32_16x16x32_bf16 v[72:75], v[36:39], v[208:211], v[72:75]
    ds_read_b64_tr_b16 v[54:55], v9 offset:29184
    v_mfma_f32_16x16x32_bf16 v[76:79], v[36:39], v[212:215], v[76:79]
    ds_read_b64_tr_b16 v[56:57], v10 offset:20480
    ds_read_b64_tr_b16 v[58:59], v10 offset:20992
    v_mfma_f32_16x16x32_bf16 v[80:83], v[40:43], v[208:211], v[80:83]
    ds_read_b64_tr_b16 v[60:61], v10 offset:28672
    v_mfma_f32_16x16x32_bf16 v[84:87], v[40:43], v[212:215], v[84:87]
    ds_read_b64_tr_b16 v[62:63], v10 offset:29184
    ds_read_b64_tr_b16 v[108:109], v12 offset:11264
    v_mfma_f32_16x16x32_bf16 v[88:91], v[44:47], v[208:211], v[88:91]
    ds_read_b64_tr_b16 v[110:111], v13 offset:11264
    v_mfma_f32_16x16x32_bf16 v[92:95], v[44:47], v[212:215], v[92:95]
    s_waitcnt vmcnt(4)
    s_setprio 3
    s_barrier
    s_add_u32 m0, s76, 65536
    s_mul_i32 s74, s72, 229376
    buffer_load_dwordx4 v27, s[36:39], s74 offen lds
    s_waitcnt lgkmcnt(0)
    v_mfma_f32_16x16x32_bf16 v[64:67], v[48:51], v[216:219], v[64:67]
    ds_read_b128 v[224:227], v5 offset:32768
    ds_read_b128 v[228:231], v6 offset:32768
    v_mfma_f32_16x16x32_bf16 v[96:99], v[216:219], v[108:111], v[96:99]
    ds_read_b64_tr_b16 v[32:33], v9 offset:32768
    v_mfma_f32_16x16x32_bf16 v[68:71], v[48:51], v[220:223], v[68:71]
    ds_read_b64_tr_b16 v[34:35], v9 offset:33280
    ds_read_b64_tr_b16 v[36:37], v9 offset:40960
    v_mfma_f32_16x16x32_bf16 v[72:75], v[52:55], v[216:219], v[72:75]
    ds_read_b64_tr_b16 v[38:39], v9 offset:41472
    v_mfma_f32_16x16x32_bf16 v[76:79], v[52:55], v[220:223], v[76:79]
    ds_read_b64_tr_b16 v[40:41], v10 offset:32768
    ds_read_b64_tr_b16 v[42:43], v10 offset:33280
    v_mfma_f32_16x16x32_bf16 v[80:83], v[56:59], v[216:219], v[80:83]
    ds_read_b64_tr_b16 v[44:45], v10 offset:40960
    v_mfma_f32_16x16x32_bf16 v[84:87], v[56:59], v[220:223], v[84:87]
    ds_read_b64_tr_b16 v[46:47], v10 offset:41472
    ds_read_b64_tr_b16 v[100:101], v12 offset:12288
    v_mfma_f32_16x16x32_bf16 v[88:91], v[60:63], v[216:219], v[88:91]
    ds_read_b64_tr_b16 v[102:103], v13 offset:12288
    v_mfma_f32_16x16x32_bf16 v[92:95], v[60:63], v[220:223], v[92:95]
    s_setprio 2
    s_add_u32 m0, s76, 73728
    s_add_u32 s72, s72, 1
    s_and_b32 s72, s72, 7
    buffer_load_dwordx4 v27, s[40:43], s74 offen lds
    s_add_u32 m0, s76, 0
    s_mul_i32 s74, s72, 229376
    buffer_load_dwordx4 v27, s[36:39], s74 offen lds
    s_add_u32 m0, s76, 8192
    s_add_u32 s72, s72, 1
    s_and_b32 s72, s72, 7
    buffer_load_dwordx4 v27, s[40:43], s74 offen lds
    s_waitcnt lgkmcnt(0)
    v_mfma_f32_16x16x32_bf16 v[64:67], v[32:35], v[224:227], v[64:67]
    ds_read_b128 v[232:235], v7 offset:32768
    ds_read_b128 v[236:239], v8 offset:32768
    v_mfma_f32_16x16x32_bf16 v[96:99], v[224:227], v[100:103], v[96:99]
    ds_read_b64_tr_b16 v[48:49], v9 offset:36864
    v_mfma_f32_16x16x32_bf16 v[68:71], v[32:35], v[228:231], v[68:71]
    ds_read_b64_tr_b16 v[50:51], v9 offset:37376
    ds_read_b64_tr_b16 v[52:53], v9 offset:45056
    v_mfma_f32_16x16x32_bf16 v[72:75], v[36:39], v[224:227], v[72:75]
    ds_read_b64_tr_b16 v[54:55], v9 offset:45568
    v_mfma_f32_16x16x32_bf16 v[76:79], v[36:39], v[228:231], v[76:79]
    ds_read_b64_tr_b16 v[56:57], v10 offset:36864
    ds_read_b64_tr_b16 v[58:59], v10 offset:37376
    v_mfma_f32_16x16x32_bf16 v[80:83], v[40:43], v[224:227], v[80:83]
    ds_read_b64_tr_b16 v[60:61], v10 offset:45056
    v_mfma_f32_16x16x32_bf16 v[84:87], v[40:43], v[228:231], v[84:87]
    ds_read_b64_tr_b16 v[62:63], v10 offset:45568
    ds_read_b64_tr_b16 v[108:109], v12 offset:13312
    v_mfma_f32_16x16x32_bf16 v[88:91], v[44:47], v[224:227], v[88:91]
    ds_read_b64_tr_b16 v[110:111], v13 offset:13312
    v_mfma_f32_16x16x32_bf16 v[92:95], v[44:47], v[228:231], v[92:95]
    s_waitcnt vmcnt(4)
    s_setprio 3
    s_barrier
    s_add_u32 m0, s76, 81920
    s_mul_i32 s74, s72, 229376
    buffer_load_dwordx4 v27, s[36:39], s74 offen lds
    s_waitcnt lgkmcnt(0)
    v_mfma_f32_16x16x32_bf16 v[64:67], v[48:51], v[232:235], v[64:67]
    ds_read_b128 v[240:243], v5 offset:49152
    ds_read_b128 v[244:247], v6 offset:49152
    v_mfma_f32_16x16x32_bf16 v[96:99], v[232:235], v[108:111], v[96:99]
    ds_read_b64_tr_b16 v[32:33], v9 offset:49152
    v_mfma_f32_16x16x32_bf16 v[68:71], v[48:51], v[236:239], v[68:71]
    ds_read_b64_tr_b16 v[34:35], v9 offset:49664
    ds_read_b64_tr_b16 v[36:37], v9 offset:57344
    v_mfma_f32_16x16x32_bf16 v[72:75], v[52:55], v[232:235], v[72:75]
    ds_read_b64_tr_b16 v[38:39], v9 offset:57856
    v_mfma_f32_16x16x32_bf16 v[76:79], v[52:55], v[236:239], v[76:79]
    ds_read_b64_tr_b16 v[40:41], v10 offset:49152
    ds_read_b64_tr_b16 v[42:43], v10 offset:49664
    v_mfma_f32_16x16x32_bf16 v[80:83], v[56:59], v[232:235], v[80:83]
    ds_read_b64_tr_b16 v[44:45], v10 offset:57344
    v_mfma_f32_16x16x32_bf16 v[84:87], v[56:59], v[236:239], v[84:87]
    ds_read_b64_tr_b16 v[46:47], v10 offset:57856
    ds_read_b64_tr_b16 v[100:101], v12 offset:14336
    v_mfma_f32_16x16x32_bf16 v[88:91], v[60:63], v[232:235], v[88:91]
    ds_read_b64_tr_b16 v[102:103], v13 offset:14336
    v_mfma_f32_16x16x32_bf16 v[92:95], v[60:63], v[236:239], v[92:95]
    s_setprio 2
    s_add_u32 m0, s76, 90112
    s_add_u32 s72, s72, 1
    s_and_b32 s72, s72, 7
    buffer_load_dwordx4 v27, s[40:43], s74 offen lds
    s_add_u32 m0, s76, 16384
    s_mul_i32 s74, s72, 229376
    buffer_load_dwordx4 v27, s[36:39], s74 offen lds
    buffer_load_dword v28, v17, s[56:59], 0 offen sc1
    s_add_u32 m0, s76, 24576
    s_add_u32 s72, s72, 1
    s_and_b32 s72, s72, 7
    buffer_load_dwordx4 v27, s[40:43], s74 offen lds
    s_waitcnt lgkmcnt(0)
    v_mfma_f32_16x16x32_bf16 v[64:67], v[32:35], v[240:243], v[64:67]
    ds_read_b128 v[248:251], v7 offset:49152
    ds_read_b128 v[252:255], v8 offset:49152
    v_mfma_f32_16x16x32_bf16 v[96:99], v[240:243], v[100:103], v[96:99]
    ds_read_b64_tr_b16 v[48:49], v9 offset:53248
    v_mfma_f32_16x16x32_bf16 v[68:71], v[32:35], v[244:247], v[68:71]
    ds_read_b64_tr_b16 v[50:51], v9 offset:53760
    ds_read_b64_tr_b16 v[52:53], v9 offset:61440
    v_mfma_f32_16x16x32_bf16 v[72:75], v[36:39], v[240:243], v[72:75]
    ds_read_b64_tr_b16 v[54:55], v9 offset:61952
    v_mfma_f32_16x16x32_bf16 v[76:79], v[36:39], v[244:247], v[76:79]
    ds_read_b64_tr_b16 v[56:57], v10 offset:53248
    ds_read_b64_tr_b16 v[58:59], v10 offset:53760
    v_mfma_f32_16x16x32_bf16 v[80:83], v[40:43], v[240:243], v[80:83]
    ds_read_b64_tr_b16 v[60:61], v10 offset:61440
    v_mfma_f32_16x16x32_bf16 v[84:87], v[40:43], v[244:247], v[84:87]
    ds_read_b64_tr_b16 v[62:63], v10 offset:61952
    ds_read_b64_tr_b16 v[108:109], v12 offset:15360
    v_mfma_f32_16x16x32_bf16 v[88:91], v[44:47], v[240:243], v[88:91]
    ds_read_b64_tr_b16 v[110:111], v13 offset:15360
    v_mfma_f32_16x16x32_bf16 v[92:95], v[44:47], v[244:247], v[92:95]
    v_subrev_u32 v5, 65536, v9
    v_subrev_u32 v6, 65536, v10
    v_add_u32 v7, 65536, v9
    v_add_u32 v8, 65536, v10
    s_waitcnt vmcnt(5)
    s_setprio 3
    s_barrier
    s_waitcnt lgkmcnt(0)
    v_mfma_f32_16x16x32_bf16 v[64:67], v[48:51], v[248:251], v[64:67]
    ds_read_b64_tr_b16 v[32:33], v9 offset:0
    v_mfma_f32_16x16x32_bf16 v[96:99], v[248:251], v[108:111], v[96:99]
    ds_read_b64_tr_b16 v[34:35], v9 offset:512
    v_mfma_f32_16x16x32_bf16 v[68:71], v[48:51], v[252:255], v[68:71]
    ds_read_b64_tr_b16 v[36:37], v9 offset:4096
    v_mfma_f32_16x16x32_bf16 v[72:75], v[52:55], v[248:251], v[72:75]
    ds_read_b64_tr_b16 v[38:39], v9 offset:4608
    v_mfma_f32_16x16x32_bf16 v[76:79], v[52:55], v[252:255], v[76:79]
    ds_read_b64_tr_b16 v[40:41], v5 offset:0
    v_mfma_f32_16x16x32_bf16 v[80:83], v[56:59], v[248:251], v[80:83]
    ds_read_b64_tr_b16 v[42:43], v5 offset:512
    v_mfma_f32_16x16x32_bf16 v[84:87], v[56:59], v[252:255], v[84:87]
    ds_read_b64_tr_b16 v[44:45], v5 offset:4096
    v_mfma_f32_16x16x32_bf16 v[88:91], v[60:63], v[248:251], v[88:91]
    ds_read_b64_tr_b16 v[46:47], v5 offset:4608
    v_mfma_f32_16x16x32_bf16 v[92:95], v[60:63], v[252:255], v[92:95]
    s_setprio 2
    s_add_u32 s88, s84, 3149824
    s_add_u32 s84, s84, 3145728
    v_cvt_pk_bf16_f32 v18, v96, v97
    v_cvt_pk_bf16_f32 v19, v98, v99
    buffer_store_dwordx2 v[18:19], v30, s[52:55], s90 offen sc1
    v_cvt_pk_bf16_f32 v64, v64, v65
    v_cvt_pk_bf16_f32 v65, v66, v67
    v_cvt_pk_bf16_f32 v66, v68, v69
    v_cvt_pk_bf16_f32 v67, v70, v71
    v_cvt_pk_bf16_f32 v72, v72, v73
    v_cvt_pk_bf16_f32 v73, v74, v75
    v_cvt_pk_bf16_f32 v74, v76, v77
    v_cvt_pk_bf16_f32 v75, v78, v79
    v_permlane16_swap_b32 v64, v66
    v_permlane16_swap_b32 v65, v67
    v_and_b32 v64, -2, v64
    buffer_store_dwordx4 v[64:67], v4, s[52:55], s84 offen offset:0 sc1
    v_permlane16_swap_b32 v72, v74
    v_permlane16_swap_b32 v73, v75
    v_and_b32 v72, -2, v72
    buffer_store_dwordx4 v[72:75], v4, s[52:55], s88 offen offset:0 sc1
    s_waitcnt lgkmcnt(0)
    v_mfma_f32_16x16x32_bf16 v[96:99], v[32:35], v[128:131], 0
    ds_read_b64_tr_b16 v[48:49], v9 offset:8192
    ds_read_b64_tr_b16 v[50:51], v9 offset:8704
    v_mfma_f32_16x16x32_bf16 v[96:99], v[36:39], v[136:139], v[96:99]
    ds_read_b64_tr_b16 v[52:53], v9 offset:12288
    v_mfma_f32_16x16x32_bf16 v[96:99], v[40:43], v[144:147], v[96:99]
    ds_read_b64_tr_b16 v[54:55], v9 offset:12800
    v_mfma_f32_16x16x32_bf16 v[96:99], v[44:47], v[152:155], v[96:99]
    ds_read_b64_tr_b16 v[56:57], v5 offset:8192
    v_mfma_f32_16x16x32_bf16 v[100:103], v[32:35], v[132:135], 0
    ds_read_b64_tr_b16 v[58:59], v5 offset:8704
    v_mfma_f32_16x16x32_bf16 v[100:103], v[36:39], v[140:143], v[100:103]
    ds_read_b64_tr_b16 v[60:61], v5 offset:12288
    v_mfma_f32_16x16x32_bf16 v[100:103], v[40:43], v[148:151], v[100:103]
    ds_read_b64_tr_b16 v[62:63], v5 offset:12800
    v_mfma_f32_16x16x32_bf16 v[100:103], v[44:47], v[156:159], v[100:103]
    s_setprio 1
    v_cvt_pk_bf16_f32 v80, v80, v81
    v_cvt_pk_bf16_f32 v81, v82, v83
    v_cvt_pk_bf16_f32 v82, v84, v85
    v_cvt_pk_bf16_f32 v83, v86, v87
    v_cvt_pk_bf16_f32 v88, v88, v89
    v_cvt_pk_bf16_f32 v89, v90, v91
    v_cvt_pk_bf16_f32 v90, v92, v93
    v_cvt_pk_bf16_f32 v91, v94, v95
    v_permlane16_swap_b32 v80, v82
    v_permlane16_swap_b32 v81, v83
    v_and_b32 v80, -2, v80
    buffer_store_dwordx4 v[80:83], v4, s[52:55], s84 offen offset:1024 sc1
    v_permlane16_swap_b32 v88, v90
    v_permlane16_swap_b32 v89, v91
    v_and_b32 v88, -2, v88
    buffer_store_dwordx4 v[88:91], v4, s[52:55], s88 offen offset:1024 sc1
    s_waitcnt lgkmcnt(0)
    v_mfma_f32_16x16x32_bf16 v[104:107], v[48:51], v[128:131], 0
    ds_read_b64_tr_b16 v[32:33], v10 offset:0
    ds_read_b64_tr_b16 v[34:35], v10 offset:512
    v_mfma_f32_16x16x32_bf16 v[104:107], v[52:55], v[136:139], v[104:107]
    ds_read_b64_tr_b16 v[36:37], v10 offset:4096
    v_mfma_f32_16x16x32_bf16 v[104:107], v[56:59], v[144:147], v[104:107]
    ds_read_b64_tr_b16 v[38:39], v10 offset:4608
    v_mfma_f32_16x16x32_bf16 v[104:107], v[60:63], v[152:155], v[104:107]
    ds_read_b64_tr_b16 v[40:41], v6 offset:0
    v_mfma_f32_16x16x32_bf16 v[108:111], v[48:51], v[132:135], 0
    ds_read_b64_tr_b16 v[42:43], v6 offset:512
    v_mfma_f32_16x16x32_bf16 v[108:111], v[52:55], v[140:143], v[108:111]
    ds_read_b64_tr_b16 v[44:45], v6 offset:4096
    v_mfma_f32_16x16x32_bf16 v[108:111], v[56:59], v[148:151], v[108:111]
    ds_read_b64_tr_b16 v[46:47], v6 offset:4608
    v_mfma_f32_16x16x32_bf16 v[108:111], v[60:63], v[156:159], v[108:111]
    s_setprio 0
    s_waitcnt lgkmcnt(0)
    v_mfma_f32_16x16x32_bf16 v[112:115], v[32:35], v[128:131], 0
    ds_read_b64_tr_b16 v[48:49], v10 offset:8192
    ds_read_b64_tr_b16 v[50:51], v10 offset:8704
    v_mfma_f32_16x16x32_bf16 v[112:115], v[36:39], v[136:139], v[112:115]
    ds_read_b64_tr_b16 v[52:53], v10 offset:12288
    v_mfma_f32_16x16x32_bf16 v[112:115], v[40:43], v[144:147], v[112:115]
    ds_read_b64_tr_b16 v[54:55], v10 offset:12800
    v_mfma_f32_16x16x32_bf16 v[112:115], v[44:47], v[152:155], v[112:115]
    ds_read_b64_tr_b16 v[56:57], v6 offset:8192
    v_mfma_f32_16x16x32_bf16 v[116:119], v[32:35], v[132:135], 0
    ds_read_b64_tr_b16 v[58:59], v6 offset:8704
    v_mfma_f32_16x16x32_bf16 v[116:119], v[36:39], v[140:143], v[116:119]
    ds_read_b64_tr_b16 v[60:61], v6 offset:12288
    v_mfma_f32_16x16x32_bf16 v[116:119], v[40:43], v[148:151], v[116:119]
    ds_read_b64_tr_b16 v[62:63], v6 offset:12800
    v_mfma_f32_16x16x32_bf16 v[116:119], v[44:47], v[156:159], v[116:119]
    s_waitcnt vmcnt(5)
    s_setprio 3
    s_barrier
    s_add_u32 m0, s76, 98304
    s_mul_i32 s74, s72, 229376
    buffer_load_dwordx4 v27, s[36:39], s74 offen lds
    s_waitcnt lgkmcnt(0)
    v_mfma_f32_16x16x32_bf16 v[120:123], v[48:51], v[128:131], 0
    ds_read_b64_tr_b16 v[32:33], v9 offset:16384
    ds_read_b64_tr_b16 v[34:35], v9 offset:16896
    v_mfma_f32_16x16x32_bf16 v[120:123], v[52:55], v[136:139], v[120:123]
    ds_read_b64_tr_b16 v[36:37], v9 offset:20480
    v_mfma_f32_16x16x32_bf16 v[120:123], v[56:59], v[144:147], v[120:123]
    ds_read_b64_tr_b16 v[38:39], v9 offset:20992
    v_mfma_f32_16x16x32_bf16 v[120:123], v[60:63], v[152:155], v[120:123]
    ds_read_b64_tr_b16 v[40:41], v5 offset:16384
    v_mfma_f32_16x16x32_bf16 v[124:127], v[48:51], v[132:135], 0
    ds_read_b64_tr_b16 v[42:43], v5 offset:16896
    v_mfma_f32_16x16x32_bf16 v[124:127], v[52:55], v[140:143], v[124:127]
    ds_read_b64_tr_b16 v[44:45], v5 offset:20480
    v_mfma_f32_16x16x32_bf16 v[124:127], v[56:59], v[148:151], v[124:127]
    ds_read_b64_tr_b16 v[46:47], v5 offset:20992
    v_mfma_f32_16x16x32_bf16 v[124:127], v[60:63], v[156:159], v[124:127]
    s_setprio 2
    s_add_u32 m0, s76, 106496
    s_add_u32 s72, s72, 1
    s_and_b32 s72, s72, 7
    buffer_load_dwordx4 v27, s[40:43], s74 offen lds
    s_add_u32 m0, s76, 32768
    s_mul_i32 s74, s72, 229376
    buffer_load_dwordx4 v27, s[36:39], s74 offen lds
    s_add_u32 m0, s76, 40960
    s_add_u32 s72, s72, 1
    s_and_b32 s72, s72, 7
    buffer_load_dwordx4 v27, s[40:43], s74 offen lds
    s_waitcnt lgkmcnt(0)
    v_mfma_f32_16x16x32_bf16 v[96:99], v[32:35], v[160:163], v[96:99]
    ds_read_b64_tr_b16 v[48:49], v9 offset:24576
    ds_read_b64_tr_b16 v[50:51], v9 offset:25088
    v_mfma_f32_16x16x32_bf16 v[96:99], v[36:39], v[168:171], v[96:99]
    ds_read_b64_tr_b16 v[52:53], v9 offset:28672
    v_mfma_f32_16x16x32_bf16 v[96:99], v[40:43], v[176:179], v[96:99]
    ds_read_b64_tr_b16 v[54:55], v9 offset:29184
    v_mfma_f32_16x16x32_bf16 v[96:99], v[44:47], v[184:187], v[96:99]
    ds_read_b64_tr_b16 v[56:57], v5 offset:24576
    v_mfma_f32_16x16x32_bf16 v[100:103], v[44:47], v[188:191], v[100:103]
    ds_read_b64_tr_b16 v[58:59], v5 offset:25088
    v_mfma_f32_16x16x32_bf16 v[100:103], v[40:43], v[180:183], v[100:103]
    ds_read_b64_tr_b16 v[60:61], v5 offset:28672
    v_mfma_f32_16x16x32_bf16 v[100:103], v[36:39], v[172:175], v[100:103]
    ds_read_b64_tr_b16 v[62:63], v5 offset:29184
    v_mfma_f32_16x16x32_bf16 v[100:103], v[32:35], v[164:167], v[100:103]
    s_waitcnt vmcnt(4)
    s_setprio 3
    s_barrier
    v_cmp_eq_u32 vcc, 0, v28
    s_cbranch_vccnz L_s0retryV
L_s0doneV:
    s_lshl4_add_u32 s80, s70, s69
    s_lshl_b32 s80, s80, 7
    s_add_u32 s80, s80, 196608
    s_lshl_b32 s81, s68, 24
    s_add_u32 s80, s80, s81
    v_mov_b32 v21, 1
    s_mov_b64 exec, 1
    buffer_store_dword v21, v17, s[52:55], s80 offen sc1
    s_mov_b64 exec, -1
    s_waitcnt lgkmcnt(0)
    v_mfma_f32_16x16x32_bf16 v[104:107], v[48:51], v[160:163], v[104:107]
    ds_read_b64_tr_b16 v[32:33], v10 offset:16384
    ds_read_b64_tr_b16 v[34:35], v10 offset:16896
    v_mfma_f32_16x16x32_bf16 v[104:107], v[52:55], v[168:171], v[104:107]
    ds_read_b64_tr_b16 v[36:37], v10 offset:20480
    v_mfma_f32_16x16x32_bf16 v[104:107], v[56:59], v[176:179], v[104:107]
    ds_read_b64_tr_b16 v[38:39], v10 offset:20992
    v_mfma_f32_16x16x32_bf16 v[104:107], v[60:63], v[184:187], v[104:107]
    ds_read_b64_tr_b16 v[40:41], v6 offset:16384
    v_mfma_f32_16x16x32_bf16 v[108:111], v[60:63], v[188:191], v[108:111]
    ds_read_b64_tr_b16 v[42:43], v6 offset:16896
    v_mfma_f32_16x16x32_bf16 v[108:111], v[56:59], v[180:183], v[108:111]
    ds_read_b64_tr_b16 v[44:45], v6 offset:20480
    v_mfma_f32_16x16x32_bf16 v[108:111], v[52:55], v[172:175], v[108:111]
    ds_read_b64_tr_b16 v[46:47], v6 offset:20992
    v_mfma_f32_16x16x32_bf16 v[108:111], v[48:51], v[164:167], v[108:111]
    s_setprio 2
    v_and_b32 v152, 31, v15
    v_lshlrev_b32 v152, 2, v152
    v_mov_b32 v154, 0xdddddddd
    v_mov_b32 v141, 0x3f803f80
    s_mov_b32 vcc_lo, 0x22
    s_mov_b32 vcc_hi, 0x22
    v_cndmask_b32 v140, 0, v141, vcc
    v_mov_b32 v141, v140
    s_waitcnt lgkmcnt(0)
    v_mfma_f32_16x16x32_bf16 v[112:115], v[32:35], v[160:163], v[112:115]
    ds_read_b64_tr_b16 v[48:49], v10 offset:24576
    ds_read_b64_tr_b16 v[50:51], v10 offset:25088
    v_mfma_f32_16x16x32_bf16 v[112:115], v[36:39], v[168:171], v[112:115]
    ds_read_b64_tr_b16 v[52:53], v10 offset:28672
    v_mfma_f32_16x16x32_bf16 v[112:115], v[40:43], v[176:179], v[112:115]
    ds_read_b64_tr_b16 v[54:55], v10 offset:29184
    v_mfma_f32_16x16x32_bf16 v[112:115], v[44:47], v[184:187], v[112:115]
    ds_read_b64_tr_b16 v[56:57], v6 offset:24576
    v_mfma_f32_16x16x32_bf16 v[116:119], v[44:47], v[188:191], v[116:119]
    ds_read_b64_tr_b16 v[58:59], v6 offset:25088
    v_mfma_f32_16x16x32_bf16 v[116:119], v[40:43], v[180:183], v[116:119]
    ds_read_b64_tr_b16 v[60:61], v6 offset:28672
    v_mfma_f32_16x16x32_bf16 v[116:119], v[36:39], v[172:175], v[116:119]
    ds_read_b64_tr_b16 v[62:63], v6 offset:29184
    v_mfma_f32_16x16x32_bf16 v[116:119], v[32:35], v[164:167], v[116:119]
    s_waitcnt vmcnt(1)
    s_setprio 3
    s_barrier
    s_waitcnt lgkmcnt(0)
    v_mfma_f32_16x16x32_bf16 v[120:123], v[48:51], v[160:163], v[120:123]
    ds_read_b64_tr_b16 v[32:33], v9 offset:32768
    ds_read_b64_tr_b16 v[34:35], v9 offset:33280
    v_mfma_f32_16x16x32_bf16 v[120:123], v[52:55], v[168:171], v[120:123]
    ds_read_b64_tr_b16 v[36:37], v9 offset:36864
    v_mfma_f32_16x16x32_bf16 v[120:123], v[56:59], v[176:179], v[120:123]
    ds_read_b64_tr_b16 v[38:39], v9 offset:37376
    v_mfma_f32_16x16x32_bf16 v[120:123], v[60:63], v[184:187], v[120:123]
    ds_read_b64_tr_b16 v[40:41], v5 offset:32768
    v_mfma_f32_16x16x32_bf16 v[124:127], v[60:63], v[188:191], v[124:127]
    ds_read_b64_tr_b16 v[42:43], v5 offset:33280
    v_mfma_f32_16x16x32_bf16 v[124:127], v[56:59], v[180:183], v[124:127]
    ds_read_b64_tr_b16 v[44:45], v5 offset:36864
    v_mfma_f32_16x16x32_bf16 v[124:127], v[52:55], v[172:175], v[124:127]
    ds_read_b64_tr_b16 v[46:47], v5 offset:37376
    v_mfma_f32_16x16x32_bf16 v[124:127], v[48:51], v[164:167], v[124:127]
    s_setprio 2
    s_add_u32 m0, s76, 131072
    s_mul_i32 s74, s72, 229376
    buffer_load_dwordx4 v27, s[36:39], s74 offen lds
    s_add_u32 m0, s76, 139264
    s_add_u32 s72, s72, 1
    s_and_b32 s72, s72, 7
    buffer_load_dwordx4 v27, s[40:43], s74 offen lds
    v_mov_b64 v[142:143], v[140:141]
    v_mov_b64 v[144:145], v[140:141]
    v_mov_b64 v[146:147], v[140:141]
    v_mov_b64 v[148:149], v[140:141]
    v_mov_b64 v[150:151], v[140:141]
    s_waitcnt lgkmcnt(0)
    v_mfma_f32_16x16x32_bf16 v[96:99], v[32:35], v[192:195], v[96:99]
    ds_read_b64_tr_b16 v[48:49], v9 offset:40960
    ds_read_b64_tr_b16 v[50:51], v9 offset:41472
    v_mfma_f32_16x16x32_bf16 v[96:99], v[36:39], v[200:203], v[96:99]
    ds_read_b64_tr_b16 v[52:53], v9 offset:45056
    v_mfma_f32_16x16x32_bf16 v[96:99], v[40:43], v[208:211], v[96:99]
    ds_read_b64_tr_b16 v[54:55], v9 offset:45568
    v_mfma_f32_16x16x32_bf16 v[96:99], v[44:47], v[216:219], v[96:99]
    ds_read_b64_tr_b16 v[56:57], v5 offset:40960
    v_mfma_f32_16x16x32_bf16 v[100:103], v[44:47], v[220:223], v[100:103]
    ds_read_b64_tr_b16 v[58:59], v5 offset:41472
    v_mfma_f32_16x16x32_bf16 v[100:103], v[40:43], v[212:215], v[100:103]
    ds_read_b64_tr_b16 v[60:61], v5 offset:45056
    v_mfma_f32_16x16x32_bf16 v[100:103], v[36:39], v[204:207], v[100:103]
    ds_read_b64_tr_b16 v[62:63], v5 offset:45568
    v_mfma_f32_16x16x32_bf16 v[100:103], v[32:35], v[196:199], v[100:103]
    s_setprio 1
    s_add_u32 m0, s76, 147456
    s_mul_i32 s74, s72, 229376
    buffer_load_dwordx4 v27, s[36:39], s74 offen lds
    s_add_u32 m0, s76, 155648
    s_add_u32 s72, s72, 1
    s_and_b32 s72, s72, 7
    buffer_load_dwordx4 v27, s[40:43], s74 offen lds
    v_add_u32 v159, s100, v31
    v_xor_b32 v160, 64, v159
    v_add_u32 v158, 7168, v0
    v_add_u32 v161, s89, v14
    v_xor_b32 v162, 0x400, v161
    s_waitcnt lgkmcnt(0)
    v_mfma_f32_16x16x32_bf16 v[104:107], v[48:51], v[192:195], v[104:107]
    ds_read_b64_tr_b16 v[32:33], v10 offset:32768
    ds_read_b64_tr_b16 v[34:35], v10 offset:33280
    v_mfma_f32_16x16x32_bf16 v[104:107], v[52:55], v[200:203], v[104:107]
    ds_read_b64_tr_b16 v[36:37], v10 offset:36864
    v_mfma_f32_16x16x32_bf16 v[104:107], v[56:59], v[208:211], v[104:107]
    ds_read_b64_tr_b16 v[38:39], v10 offset:37376
    v_mfma_f32_16x16x32_bf16 v[104:107], v[60:63], v[216:219], v[104:107]
    ds_read_b64_tr_b16 v[40:41], v6 offset:32768
    v_mfma_f32_16x16x32_bf16 v[108:111], v[60:63], v[220:223], v[108:111]
    ds_read_b64_tr_b16 v[42:43], v6 offset:33280
    v_mfma_f32_16x16x32_bf16 v[108:111], v[56:59], v[212:215], v[108:111]
    ds_read_b64_tr_b16 v[44:45], v6 offset:36864
    v_mfma_f32_16x16x32_bf16 v[108:111], v[52:55], v[204:207], v[108:111]
    ds_read_b64_tr_b16 v[46:47], v6 offset:37376
    v_mfma_f32_16x16x32_bf16 v[108:111], v[48:51], v[196:199], v[108:111]
    s_setprio 0
    v_lshlrev_b32 v163, 7, v15
    v_mov_b32 v168, 1
    v_lshl_add_u32 v171, v15, 2, s86
    v_lshl_add_u32 v172, v15, 2, s87
    v_mov_b64 v[176:177], 0
    s_waitcnt lgkmcnt(0)
    v_mfma_f32_16x16x32_bf16 v[112:115], v[32:35], v[192:195], v[112:115]
    ds_read_b64_tr_b16 v[48:49], v10 offset:40960
    ds_read_b64_tr_b16 v[50:51], v10 offset:41472
    v_mfma_f32_16x16x32_bf16 v[112:115], v[36:39], v[200:203], v[112:115]
    ds_read_b64_tr_b16 v[52:53], v10 offset:45056
    v_mfma_f32_16x16x32_bf16 v[112:115], v[40:43], v[208:211], v[112:115]
    ds_read_b64_tr_b16 v[54:55], v10 offset:45568
    v_mfma_f32_16x16x32_bf16 v[112:115], v[44:47], v[216:219], v[112:115]
    ds_read_b64_tr_b16 v[56:57], v6 offset:40960
    v_mfma_f32_16x16x32_bf16 v[116:119], v[44:47], v[220:223], v[116:119]
    ds_read_b64_tr_b16 v[58:59], v6 offset:41472
    v_mfma_f32_16x16x32_bf16 v[116:119], v[40:43], v[212:215], v[116:119]
    ds_read_b64_tr_b16 v[60:61], v6 offset:45056
    v_mfma_f32_16x16x32_bf16 v[116:119], v[36:39], v[204:207], v[116:119]
    ds_read_b64_tr_b16 v[62:63], v6 offset:45568
    v_mfma_f32_16x16x32_bf16 v[116:119], v[32:35], v[196:199], v[116:119]
    s_waitcnt vmcnt(0)
    s_setprio 3
    s_barrier
    s_waitcnt lgkmcnt(0)
    v_mfma_f32_16x16x32_bf16 v[120:123], v[48:51], v[192:195], v[120:123]
    ds_read_b64_tr_b16 v[32:33], v7 offset:0
    ds_read_b64_tr_b16 v[34:35], v7 offset:512
    v_mfma_f32_16x16x32_bf16 v[120:123], v[52:55], v[200:203], v[120:123]
    ds_read_b64_tr_b16 v[36:37], v7 offset:4096
    v_mfma_f32_16x16x32_bf16 v[120:123], v[56:59], v[208:211], v[120:123]
    ds_read_b64_tr_b16 v[38:39], v7 offset:4608
    v_mfma_f32_16x16x32_bf16 v[120:123], v[60:63], v[216:219], v[120:123]
    ds_read_b64_tr_b16 v[40:41], v7 offset:16384
    v_mfma_f32_16x16x32_bf16 v[124:127], v[60:63], v[220:223], v[124:127]
    ds_read_b64_tr_b16 v[42:43], v7 offset:16896
    v_mfma_f32_16x16x32_bf16 v[124:127], v[56:59], v[212:215], v[124:127]
    ds_read_b64_tr_b16 v[44:45], v7 offset:20480
    v_mfma_f32_16x16x32_bf16 v[124:127], v[52:55], v[204:207], v[124:127]
    ds_read_b64_tr_b16 v[46:47], v7 offset:20992
    v_mfma_f32_16x16x32_bf16 v[124:127], v[48:51], v[196:199], v[124:127]
    s_setprio 2
    v_mov_b64 v[178:179], 0
    v_mov_b64 v[180:181], 0
    v_mov_b64 v[182:183], 0
    v_mov_b64 v[184:185], 0
    v_mov_b64 v[186:187], 0
    s_waitcnt lgkmcnt(0)
    v_mfma_f32_16x16x32_bf16 v[96:99], v[32:35], v[224:227], v[96:99]
    ds_read_b64_tr_b16 v[48:49], v7 offset:8192
    ds_read_b64_tr_b16 v[50:51], v7 offset:8704
    v_mfma_f32_16x16x32_bf16 v[96:99], v[36:39], v[232:235], v[96:99]
    ds_read_b64_tr_b16 v[52:53], v7 offset:12288
    v_mfma_f32_16x16x32_bf16 v[96:99], v[40:43], v[240:243], v[96:99]
    ds_read_b64_tr_b16 v[54:55], v7 offset:12800
    v_mfma_f32_16x16x32_bf16 v[96:99], v[44:47], v[248:251], v[96:99]
    ds_read_b64_tr_b16 v[56:57], v7 offset:24576
    v_mfma_f32_16x16x32_bf16 v[100:103], v[44:47], v[252:255], v[100:103]
    ds_read_b64_tr_b16 v[58:59], v7 offset:25088
    v_mfma_f32_16x16x32_bf16 v[100:103], v[40:43], v[244:247], v[100:103]
    ds_read_b64_tr_b16 v[60:61], v7 offset:28672
    v_mfma_f32_16x16x32_bf16 v[100:103], v[36:39], v[236:239], v[100:103]
    ds_read_b64_tr_b16 v[62:63], v7 offset:29184
    v_mfma_f32_16x16x32_bf16 v[100:103], v[32:35], v[228:231], v[100:103]
    s_setprio 1
    v_mov_b64 v[188:189], 0
    v_mov_b64 v[190:191], 0
    v_mov_b64 v[192:193], 0
    v_mov_b64 v[194:195], 0
    v_mov_b64 v[196:197], 0
    s_waitcnt lgkmcnt(0)
    v_mfma_f32_16x16x32_bf16 v[104:107], v[48:51], v[224:227], v[104:107]
    ds_read_b64_tr_b16 v[32:33], v8 offset:0
    ds_read_b64_tr_b16 v[34:35], v8 offset:512
    v_mfma_f32_16x16x32_bf16 v[104:107], v[52:55], v[232:235], v[104:107]
    ds_read_b64_tr_b16 v[36:37], v8 offset:4096
    v_mfma_f32_16x16x32_bf16 v[104:107], v[56:59], v[240:243], v[104:107]
    ds_read_b64_tr_b16 v[38:39], v8 offset:4608
    v_mfma_f32_16x16x32_bf16 v[104:107], v[60:63], v[248:251], v[104:107]
    ds_read_b64_tr_b16 v[40:41], v8 offset:16384
    v_mfma_f32_16x16x32_bf16 v[108:111], v[60:63], v[252:255], v[108:111]
    ds_read_b64_tr_b16 v[42:43], v8 offset:16896
    v_mfma_f32_16x16x32_bf16 v[108:111], v[56:59], v[244:247], v[108:111]
    ds_read_b64_tr_b16 v[44:45], v8 offset:20480
    v_mfma_f32_16x16x32_bf16 v[108:111], v[52:55], v[236:239], v[108:111]
    ds_read_b64_tr_b16 v[46:47], v8 offset:20992
    v_mfma_f32_16x16x32_bf16 v[108:111], v[48:51], v[228:231], v[108:111]
    s_setprio 0
    s_cmp_lg_u32 s68, 0
    s_cbranch_scc1 L_nopoll0V
    s_mov_b32 s81, 196608
    v_lshlrev_b32 v21, 7, v15
    buffer_load_dword v20, v21, s[52:55], s81 offen sc1
L_nopoll0V:
    v_mov_b64 v[198:199], 0
    v_mov_b64 v[200:201], 0
    v_mov_b64 v[202:203], 0
    v_mov_b64 v[204:205], 0
    v_mov_b64 v[206:207], 0
    s_waitcnt lgkmcnt(0)
    v_mfma_f32_16x16x32_bf16 v[112:115], v[32:35], v[224:227], v[112:115]
    ds_read_b64_tr_b16 v[48:49], v8 offset:8192
    ds_read_b64_tr_b16 v[50:51], v8 offset:8704
    v_mfma_f32_16x16x32_bf16 v[112:115], v[36:39], v[232:235], v[112:115]
    ds_read_b64_tr_b16 v[52:53], v8 offset:12288
    v_mfma_f32_16x16x32_bf16 v[112:115], v[40:43], v[240:243], v[112:115]
    ds_read_b64_tr_b16 v[54:55], v8 offset:12800
    v_mfma_f32_16x16x32_bf16 v[112:115], v[44:47], v[248:251], v[112:115]
    ds_read_b64_tr_b16 v[56:57], v8 offset:24576
    v_mfma_f32_16x16x32_bf16 v[116:119], v[44:47], v[252:255], v[116:119]
    ds_read_b64_tr_b16 v[58:59], v8 offset:25088
    v_mfma_f32_16x16x32_bf16 v[116:119], v[40:43], v[244:247], v[116:119]
    ds_read_b64_tr_b16 v[60:61], v8 offset:28672
    v_mfma_f32_16x16x32_bf16 v[116:119], v[36:39], v[236:239], v[116:119]
    ds_read_b64_tr_b16 v[62:63], v8 offset:29184
    v_mfma_f32_16x16x32_bf16 v[116:119], v[32:35], v[228:231], v[116:119]
    s_waitcnt lgkmcnt(0)
    s_branch L_join
.p2align 12
.fill 224, 4, 0xbf800000
L_pathP:
    s_mov_b32 s44, s6
    s_mov_b32 s45, s7
    s_mov_b32 s46, 524288
    s_mov_b32 s47, 0x20000
    s_mov_b32 s36, s16
    s_mov_b32 s37, s17
    s_mov_b32 s38, 1835008
    s_mov_b32 s39, 0x20000
    s_mov_b32 s40, s18
    s_mov_b32 s41, s19
    s_mov_b32 s42, 1835008
    s_mov_b32 s43, 0x20000
    s_cmp_lt_u32 s70, 2
    s_cselect_b64 s[48:49], s[8:9], s[10:11]
    s_mov_b32 s50, 16384
    s_mov_b32 s51, 0x20000
    v_bfe_u32 v21, v15, 4, 1
    v_lshlrev_b32 v21, 7, v21
    v_xor_b32 v11, v21, v14
    s_add_u32 s91, s68, s79
    s_and_b32 s91, s91, 7
    s_lshl_b32 s91, s91, 11
    s_add_u32 m0, s76, 16384
    s_lshl_b32 s73, s72, 7
    buffer_load_dwordx4 v1, s[32:35], s73 offen lds
    s_add_u32 m0, s75, 131072
    s_nop 0
    buffer_load_dwordx4 v11, s[48:51], s91 offen lds
    buffer_load_dwordx4 v11, s[48:51], s91 offen offset:1024 lds
    s_add_u32 m0, s76, 81920
    s_mul_i32 s74, s72, 65536
    buffer_load_dwordx4 v3, s[44:47], s74 offen lds
    s_add_u32 m0, s76, 90112
    s_add_u32 s74, s74, 128
    s_add_u32 s72, s72, 1
    buffer_load_dwordx4 v3, s[44:47], s74 offen lds
    s_add_u32 m0, s76, 24576
    s_and_b32 s72, s72, 7
    buffer_load_dwordx4 v2, s[32:35], s73 offen lds
    s_lshr_b32 s80, s68, 2
    s_lshl_b32 s81, s80, 16
    v_add_u32 v26, s81, v14
    s_and_b32 s81, s68, 1
    s_mul_i32 s81, s81, 49152
    v_add_u32 v24, s81, v14
    v_add_u32 v25, s81, v29
    s_mul_i32 s81, s80, 49152
    s_and_b32 s86, s68, 3
    s_lshl_b32 s87, s86, 11
    s_add_u32 s83, s87, s81
    s_lshl_b32 s87, s2, 2
    s_add_u32 s86, s86, s87
    s_and_b32 s86, s86, 31
    s_lshl_b32 s85, s86, 11
    s_add_u32 s1, s101, 3145728
    s_xor_b32 s1, s1, 1024
    s_lshl1_add_u32 s79, s77, s80
    s_lshl_b32 s79, s79, 7
    s_add_u32 s79, s79, 131072
    s_lshr_b32 s86, s77, 3
    s_lshl3_add_u32 s86, s86, s68
    s_mul_i32 s86, s86, 224
    s_and_b32 s87, s77, 7
    s_lshl1_add_u32 s87, s87, s80
    s_add_u32 s86, s86, s87
    s_lshl_b32 s86, s86, 10
    s_add_u32 s89, s86, 5242880
    s_lshr_b32 s97, s77, 1
    s_lshl_b32 s97, s97, 9
    s_add_u32 s97, s97, 204800
    s_lshl_b32 s81, s68, 24
    s_add_u32 s98, s98, s81
    s_mul_i32 s86, s68, 2304
    s_add_u32 s86, s86, 65536
    s_xor_b32 s87, s68, 1
    s_mul_i32 s87, s87, 2304
    s_add_u32 s87, s87, 65536
    s_waitcnt vmcnt(6)
    s_setprio 3
    s_barrier
    s_add_u32 m0, s76, 32768
    s_lshl_b32 s73, s72, 7
    buffer_load_dwordx4 v1, s[32:35], s73 offen lds
    s_waitcnt lgkmcnt(0)
    ds_read_b128 v[128:131], v5 offset:0
    ds_read_b128 v[132:135], v6 offset:0
    ds_read_b64_tr_b16 v[32:33], v9 offset:0
    ds_read_b64_tr_b16 v[34:35], v9 offset:512
    ds_read_b64_tr_b16 v[36:37], v9 offset:8192
    ds_read_b64_tr_b16 v[38:39], v9 offset:8704
    ds_read_b64_tr_b16 v[40:41], v10 offset:0
    ds_read_b64_tr_b16 v[42:43], v10 offset:512
    ds_read_b64_tr_b16 v[44:45], v10 offset:8192
    ds_read_b64_tr_b16 v[46:47], v10 offset:8704
    s_add_u32 m0, s76, 98304
    s_mul_i32 s74, s72, 65536
    buffer_load_dwordx4 v3, s[44:47], s74 offen lds
    s_add_u32 m0, s76, 106496
    s_add_u32 s74, s74, 128
    s_add_u32 s72, s72, 1
    buffer_load_dwordx4 v3, s[44:47], s74 offen lds
    s_add_u32 m0, s76, 40960
    s_and_b32 s72, s72, 7
    buffer_load_dwordx4 v2, s[32:35], s73 offen lds
    s_waitcnt lgkmcnt(0)
    v_mfma_f32_16x16x32_bf16 v[64:67], v[32:35], v[128:131], 0
    ds_read_b128 v[136:139], v7 offset:0
    ds_read_b128 v[140:143], v8 offset:0
    v_mfma_f32_16x16x32_bf16 v[68:71], v[32:35], v[132:135], 0
    ds_read_b64_tr_b16 v[48:49], v9 offset:4096
    v_mfma_f32_16x16x32_bf16 v[72:75], v[36:39], v[128:131], 0
    ds_read_b64_tr_b16 v[50:51], v9 offset:4608
    ds_read_b64_tr_b16 v[52:53], v9 offset:12288
    v_mfma_f32_16x16x32_bf16 v[76:79], v[36:39], v[132:135], 0
    ds_read_b64_tr_b16 v[54:55], v9 offset:12800
    v_mfma_f32_16x16x32_bf16 v[80:83], v[40:43], v[128:131], 0
    ds_read_b64_tr_b16 v[56:57], v10 offset:4096
    ds_read_b64_tr_b16 v[58:59], v10 offset:4608
    v_mfma_f32_16x16x32_bf16 v[84:87], v[40:43], v[132:135], 0
    ds_read_b64_tr_b16 v[60:61], v10 offset:12288
    v_mfma_f32_16x16x32_bf16 v[88:91], v[44:47], v[128:131], 0
    ds_read_b64_tr_b16 v[62:63], v10 offset:12800
    v_mfma_f32_16x16x32_bf16 v[92:95], v[44:47], v[132:135], 0
    s_waitcnt vmcnt(4)
    s_setprio 3
    s_barrier
    s_add_u32 m0, s76, 49152
    s_lshl_b32 s73, s72, 7
    buffer_load_dwordx4 v1, s[32:35], s73 offen lds
    s_waitcnt lgkmcnt(0)
    v_mfma_f32_16x16x32_bf16 v[64:67], v[48:51], v[136:139], v[64:67]
    ds_read_b128 v[144:147], v5 offset:16384
    ds_read_b128 v[148:151], v6 offset:16384
    v_mfma_f32_16x16x32_bf16 v[68:71], v[48:51], v[140:143], v[68:71]
    ds_read_b64_tr_b16 v[32:33], v9 offset:16384
    v_mfma_f32_16x16x32_bf16 v[72:75], v[52:55], v[136:139], v[72:75]
    ds_read_b64_tr_b16 v[34:35], v9 offset:16896
    ds_read_b64_tr_b16 v[36:37], v9 offset:24576
    v_mfma_f32_16x16x32_bf16 v[76:79], v[52:55], v[140:143], v[76:79]
    ds_read_b64_tr_b16 v[38:39], v9 offset:25088
    v_mfma_f32_16x16x32_bf16 v[80:83], v[56:59], v[136:139], v[80:83]
    ds_read_b64_tr_b16 v[40:41], v10 offset:16384
    ds_read_b64_tr_b16 v[42:43], v10 offset:16896
    v_mfma_f32_16x16x32_bf16 v[84:87], v[56:59], v[140:143], v[84:87]
    ds_read_b64_tr_b16 v[44:45], v10 offset:24576
    v_mfma_f32_16x16x32_bf16 v[88:91], v[60:63], v[136:139], v[88:91]
    ds_read_b64_tr_b16 v[46:47], v10 offset:25088
    v_mfma_f32_16x16x32_bf16 v[92:95], v[60:63], v[140:143], v[92:95]
    s_setprio 2
    s_add_u32 m0, s76, 114688
    s_mul_i32 s74, s72, 65536
    buffer_load_dwordx4 v3, s[44:47], s74 offen lds
    s_add_u32 m0, s76, 122880
    s_add_u32 s74, s74, 128
    s_add_u32 s72, s72, 1
    buffer_load_dwordx4 v3, s[44:47], s74 offen lds
    s_add_u32 m0, s76, 57344
    s_and_b32 s72, s72, 7
    buffer_load_dwordx4 v2, s[32:35], s73 offen lds
    s_waitcnt lgkmcnt(0)
    v_mfma_f32_16x16x32_bf16 v[64:67], v[32:35], v[144:147], v[64:67]
    ds_read_b128 v[152:155], v7 offset:16384
    ds_read_b128 v[156:159], v8 offset:16384
    v_mfma_f32_16x16x32_bf16 v[68:71], v[32:35], v[148:151], v[68:71]
    ds_read_b64_tr_b16 v[48:49], v9 offset:20480
    v_mfma_f32_16x16x32_bf16 v[72:75], v[36:39], v[144:147], v[72:75]
    ds_read_b64_tr_b16 v[50:51], v9 offset:20992
    ds_read_b64_tr_b16 v[52:53], v9 offset:28672
    v_mfma_f32_16x16x32_bf16 v[76:79], v[36:39], v[148:151], v[76:79]
    ds_read_b64_tr_b16 v[54:55], v9 offset:29184
    v_mfma_f32_16x16x32_bf16 v[80:83], v[40:43], v[144:147], v[80:83]
    ds_read_b64_tr_b16 v[56:57], v10 offset:20480
    ds_read_b64_tr_b16 v[58:59], v10 offset:20992
    v_mfma_f32_16x16x32_bf16 v[84:87], v[40:43], v[148:151], v[84:87]
    ds_read_b64_tr_b16 v[60:61], v10 offset:28672
    v_mfma_f32_16x16x32_bf16 v[88:91], v[44:47], v[144:147], v[88:91]
    ds_read_b64_tr_b16 v[62:63], v10 offset:29184
    v_mfma_f32_16x16x32_bf16 v[92:95], v[44:47], v[148:151], v[92:95]
    s_waitcnt vmcnt(4)
    s_setprio 3
    s_barrier
    s_add_u32 m0, s76, 0
    s_lshl_b32 s73, s72, 7
    buffer_load_dwordx4 v1, s[32:35], s73 offen lds
    s_waitcnt lgkmcnt(0)
    v_mfma_f32_16x16x32_bf16 v[64:67], v[48:51], v[152:155], v[64:67]
    ds_read_b128 v[160:163], v5 offset:32768
    ds_read_b128 v[164:167], v6 offset:32768
    v_mfma_f32_16x16x32_bf16 v[68:71], v[48:51], v[156:159], v[68:71]
    ds_read_b64_tr_b16 v[32:33], v9 offset:32768
    v_mfma_f32_16x16x32_bf16 v[72:75], v[52:55], v[152:155], v[72:75]
    ds_read_b64_tr_b16 v[34:35], v9 offset:33280
    ds_read_b64_tr_b16 v[36:37], v9 offset:40960
    v_mfma_f32_16x16x32_bf16 v[76:79], v[52:55], v[156:159], v[76:79]
    ds_read_b64_tr_b16 v[38:39], v9 offset:41472
    v_mfma_f32_16x16x32_bf16 v[80:83], v[56:59], v[152:155], v[80:83]
    ds_read_b64_tr_b16 v[40:41], v10 offset:32768
    ds_read_b64_tr_b16 v[42:43], v10 offset:33280
    v_mfma_f32_16x16x32_bf16 v[84:87], v[56:59], v[156:159], v[84:87]
    ds_read_b64_tr_b16 v[44:45], v10 offset:40960
    v_mfma_f32_16x16x32_bf16 v[88:91], v[60:63], v[152:155], v[88:91]
    ds_read_b64_tr_b16 v[46:47], v10 offset:41472
    v_mfma_f32_16x16x32_bf16 v[92:95], v[60:63], v[156:159], v[92:95]
    s_setprio 2
    s_add_u32 m0, s76, 65536
    s_mul_i32 s74, s72, 65536
    buffer_load_dwordx4 v3, s[44:47], s74 offen lds
    s_add_u32 m0, s76, 73728
    s_add_u32 s74, s74, 128
    s_add_u32 s72, s72, 1
    buffer_load_dwordx4 v3, s[44:47], s74 offen lds
    s_add_u32 m0, s76, 8192
    s_and_b32 s72, s72, 7
    buffer_load_dwordx4 v2, s[32:35], s73 offen lds
    s_waitcnt lgkmcnt(0)
    v_mfma_f32_16x16x32_bf16 v[64:67], v[32:35], v[160:163], v[64:67]
    ds_read_b128 v[168:171], v7 offset:32768
    ds_read_b128 v[172:175], v8 offset:32768
    v_mfma_f32_16x16x32_bf16 v[68:71], v[32:35], v[164:167], v[68:71]
    ds_read_b64_tr_b16 v[48:49], v9 offset:36864
    v_mfma_f32_16x16x32_bf16 v[72:75], v[36:39], v[160:163], v[72:75]
    ds_read_b64_tr_b16 v[50:51], v9 offset:37376
    ds_read_b64_tr_b16 v[52:53], v9 offset:45056
    v_mfma_f32_16x16x32_bf16 v[76:79], v[36:39], v[164:167], v[76:79]
    ds_read_b64_tr_b16 v[54:55], v9 offset:45568
    v_mfma_f32_16x16x32_bf16 v[80:83], v[40:43], v[160:163], v[80:83]
    ds_read_b64_tr_b16 v[56:57], v10 offset:36864
    ds_read_b64_tr_b16 v[58:59], v10 offset:37376
    v_mfma_f32_16x16x32_bf16 v[84:87], v[40:43], v[164:167], v[84:87]
    ds_read_b64_tr_b16 v[60:61], v10 offset:45056
    v_mfma_f32_16x16x32_bf16 v[88:91], v[44:47], v[160:163], v[88:91]
    ds_read_b64_tr_b16 v[62:63], v10 offset:45568
    v_mfma_f32_16x16x32_bf16 v[92:95], v[44:47], v[164:167], v[92:95]
    s_waitcnt vmcnt(4)
    s_setprio 3
    s_barrier
    s_add_u32 m0, s76, 16384
    s_lshl_b32 s73, s72, 7
    buffer_load_dwordx4 v1, s[32:35], s73 offen lds
    s_waitcnt lgkmcnt(0)
    v_mfma_f32_16x16x32_bf16 v[64:67], v[48:51], v[168:171], v[64:67]
    ds_read_b128 v[176:179], v5 offset:49152
    ds_read_b128 v[180:183], v6 offset:49152
    v_mfma_f32_16x16x32_bf16 v[68:71], v[48:51], v[172:175], v[68:71]
    ds_read_b64_tr_b16 v[32:33], v9 offset:49152
    v_mfma_f32_16x16x32_bf16 v[72:75], v[52:55], v[168:171], v[72:75]
    ds_read_b64_tr_b16 v[34:35], v9 offset:49664
    ds_read_b64_tr_b16 v[36:37], v9 offset:57344
    v_mfma_f32_16x16x32_bf16 v[76:79], v[52:55], v[172:175], v[76:79]
    ds_read_b64_tr_b16 v[38:39], v9 offset:57856
    v_mfma_f32_16x16x32_bf16 v[80:83], v[56:59], v[168:171], v[80:83]
    ds_read_b64_tr_b16 v[40:41], v10 offset:49152
    ds_read_b64_tr_b16 v[42:43], v10 offset:49664
    v_mfma_f32_16x16x32_bf16 v[84:87], v[56:59], v[172:175], v[84:87]
    ds_read_b64_tr_b16 v[44:45], v10 offset:57344
    v_mfma_f32_16x16x32_bf16 v[88:91], v[60:63], v[168:171], v[88:91]
    ds_read_b64_tr_b16 v[46:47], v10 offset:57856
    v_mfma_f32_16x16x32_bf16 v[92:95], v[60:63], v[172:175], v[92:95]
    s_setprio 2
    s_add_u32 m0, s76, 81920
    s_mul_i32 s74, s72, 65536
    buffer_load_dwordx4 v3, s[44:47], s74 offen lds
    s_add_u32 m0, s76, 90112
    s_add_u32 s74, s74, 128
    s_add_u32 s72, s72, 1
    buffer_load_dwordx4 v3, s[44:47], s74 offen lds
    s_add_u32 m0, s76, 24576
    s_and_b32 s72, s72, 7
    buffer_load_dwordx4 v2, s[32:35], s73 offen lds
    s_waitcnt lgkmcnt(0)
    v_mfma_f32_16x16x32_bf16 v[64:67], v[32:35], v[176:179], v[64:67]
    ds_read_b128 v[184:187], v7 offset:49152
    ds_read_b128 v[188:191], v8 offset:49152
    v_mfma_f32_16x16x32_bf16 v[68:71], v[32:35], v[180:183], v[68:71]
    ds_read_b64_tr_b16 v[48:49], v9 offset:53248
    v_mfma_f32_16x16x32_bf16 v[72:75], v[36:39], v[176:179], v[72:75]
    ds_read_b64_tr_b16 v[50:51], v9 offset:53760
    ds_read_b64_tr_b16 v[52:53], v9 offset:61440
    v_mfma_f32_16x16x32_bf16 v[76:79], v[36:39], v[180:183], v[76:79]
    ds_read_b64_tr_b16 v[54:55], v9 offset:61952
    v_mfma_f32_16x16x32_bf16 v[80:83], v[40:43], v[176:179], v[80:83]
    ds_read_b64_tr_b16 v[56:57], v10 offset:53248
    ds_read_b64_tr_b16 v[58:59], v10 offset:53760
    v_mfma_f32_16x16x32_bf16 v[84:87], v[40:43], v[180:183], v[84:87]
    ds_read_b64_tr_b16 v[60:61], v10 offset:61440
    v_mfma_f32_16x16x32_bf16 v[88:91], v[44:47], v[176:179], v[88:91]
    ds_read_b64_tr_b16 v[62:63], v10 offset:61952
    v_mfma_f32_16x16x32_bf16 v[92:95], v[44:47], v[180:183], v[92:95]
    s_waitcnt vmcnt(4)
    s_setprio 3
    s_barrier
    s_add_u32 m0, s76, 32768
    s_lshl_b32 s73, s72, 7
    buffer_load_dwordx4 v1, s[32:35], s73 offen lds
    s_waitcnt lgkmcnt(0)
    v_mfma_f32_16x16x32_bf16 v[64:67], v[48:51], v[184:187], v[64:67]
    ds_read_b128 v[192:195], v5 offset:0
    ds_read_b128 v[196:199], v6 offset:0
    v_mfma_f32_16x16x32_bf16 v[68:71], v[48:51], v[188:191], v[68:71]
    ds_read_b64_tr_b16 v[32:33], v9 offset:0
    v_mfma_f32_16x16x32_bf16 v[72:75], v[52:55], v[184:187], v[72:75]
    ds_read_b64_tr_b16 v[34:35], v9 offset:512
    ds_read_b64_tr_b16 v[36:37], v9 offset:8192
    v_mfma_f32_16x16x32_bf16 v[76:79], v[52:55], v[188:191], v[76:79]
    ds_read_b64_tr_b16 v[38:39], v9 offset:8704
    v_mfma_f32_16x16x32_bf16 v[80:83], v[56:59], v[184:187], v[80:83]
    ds_read_b64_tr_b16 v[40:41], v10 offset:0
    ds_read_b64_tr_b16 v[42:43], v10 offset:512
    v_mfma_f32_16x16x32_bf16 v[84:87], v[56:59], v[188:191], v[84:87]
    ds_read_b64_tr_b16 v[44:45], v10 offset:8192
    v_mfma_f32_16x16x32_bf16 v[88:91], v[60:63], v[184:187], v[88:91]
    ds_read_b64_tr_b16 v[46:47], v10 offset:8704
    v_mfma_f32_16x16x32_bf16 v[92:95], v[60:63], v[188:191], v[92:95]
    s_setprio 2
    s_add_u32 m0, s76, 98304
    s_mul_i32 s74, s72, 65536
    buffer_load_dwordx4 v3, s[44:47], s74 offen lds
    s_add_u32 m0, s76, 106496
    s_add_u32 s74, s74, 128
    s_add_u32 s72, s72, 1
    buffer_load_dwordx4 v3, s[44:47], s74 offen lds
    s_add_u32 m0, s76, 40960
    s_and_b32 s72, s72, 7
    buffer_load_dwordx4 v2, s[32:35], s73 offen lds
    s_waitcnt lgkmcnt(0)
    v_mfma_f32_16x16x32_bf16 v[64:67], v[32:35], v[192:195], v[64:67]
    ds_read_b128 v[200:203], v7 offset:0
    ds_read_b128 v[204:207], v8 offset:0
    v_mfma_f32_16x16x32_bf16 v[68:71], v[32:35], v[196:199], v[68:71]
    ds_read_b64_tr_b16 v[48:49], v9 offset:4096
    v_mfma_f32_16x16x32_bf16 v[72:75], v[36:39], v[192:195], v[72:75]
    ds_read_b64_tr_b16 v[50:51], v9 offset:4608
    ds_read_b64_tr_b16 v[52:53], v9 offset:12288
    v_mfma_f32_16x16x32_bf16 v[76:79], v[36:39], v[196:199], v[76:79]
    ds_read_b64_tr_b16 v[54:55], v9 offset:12800
    v_mfma_f32_16x16x32_bf16 v[80:83], v[40:43], v[192:195], v[80:83]
    ds_read_b64_tr_b16 v[56:57], v10 offset:4096
    ds_read_b64_tr_b16 v[58:59], v10 offset:4608
    v_mfma_f32_16x16x32_bf16 v[84:87], v[40:43], v[196:199], v[84:87]
    ds_read_b64_tr_b16 v[60:61], v10 offset:12288
    v_mfma_f32_16x16x32_bf16 v[88:91], v[44:47], v[192:195], v[88:91]
    ds_read_b64_tr_b16 v[62:63], v10 offset:12800
    v_mfma_f32_16x16x32_bf16 v[92:95], v[44:47], v[196:199], v[92:95]
    s_waitcnt vmcnt(4)
    s_setprio 3
    s_barrier
    s_add_u32 m0, s76, 49152
    s_lshl_b32 s73, s72, 7
    buffer_load_dwordx4 v1, s[32:35], s73 offen lds
    s_waitcnt lgkmcnt(0)
    v_mfma_f32_16x16x32_bf16 v[64:67], v[48:51], v[200:203], v[64:67]
    ds_read_b128 v[208:211], v5 offset:16384
    ds_read_b128 v[212:215], v6 offset:16384
    v_mfma_f32_16x16x32_bf16 v[68:71], v[48:51], v[204:207], v[68:71]
    ds_read_b64_tr_b16 v[32:33], v9 offset:16384
    v_mfma_f32_16x16x32_bf16 v[72:75], v[52:55], v[200:203], v[72:75]
    ds_read_b64_tr_b16 v[34:35], v9 offset:16896
    ds_read_b64_tr_b16 v[36:37], v9 offset:24576
    v_mfma_f32_16x16x32_bf16 v[76:79], v[52:55], v[204:207], v[76:79]
    ds_read_b64_tr_b16 v[38:39], v9 offset:25088
    v_mfma_f32_16x16x32_bf16 v[80:83], v[56:59], v[200:203], v[80:83]
    ds_read_b64_tr_b16 v[40:41], v10 offset:16384
    ds_read_b64_tr_b16 v[42:43], v10 offset:16896
    v_mfma_f32_16x16x32_bf16 v[84:87], v[56:59], v[204:207], v[84:87]
    ds_read_b64_tr_b16 v[44:45], v10 offset:24576
    v_mfma_f32_16x16x32_bf16 v[88:91], v[60:63], v[200:203], v[88:91]
    ds_read_b64_tr_b16 v[46:47], v10 offset:25088
    v_mfma_f32_16x16x32_bf16 v[92:95], v[60:63], v[204:207], v[92:95]
    s_setprio 2
    s_add_u32 m0, s76, 114688
    s_mul_i32 s74, s72, 65536
    buffer_load_dwordx4 v3, s[44:47], s74 offen lds
    s_add_u32 m0, s76, 122880
    s_add_u32 s74, s74, 128
    s_add_u32 s72, s72, 1
    buffer_load_dwordx4 v3, s[44:47], s74 offen lds
    s_add_u32 m0, s76, 57344
    s_and_b32 s72, s72, 7
    buffer_load_dwordx4 v2, s[32:35], s73 offen lds
    s_waitcnt lgkmcnt(0)
    v_mfma_f32_16x16x32_bf16 v[64:67], v[32:35], v[208:211], v[64:67]
    ds_read_b128 v[216:219], v7 offset:16384
    ds_read_b128 v[220:223], v8 offset:16384
    v_mfma_f32_16x16x32_bf16 v[68:71], v[32:35], v[212:215], v[68:71]
    ds_read_b64_tr_b16 v[48:49], v9 offset:20480
    v_mfma_f32_16x16x32_bf16 v[72:75], v[36:39], v[208:211], v[72:75]
    ds_read_b64_tr_b16 v[50:51], v9 offset:20992
    ds_read_b64_tr_b16 v[52:53], v9 offset:28672
    v_mfma_f32_16x16x32_bf16 v[76:79], v[36:39], v[212:215], v[76:79]
    ds_read_b64_tr_b16 v[54:55], v9 offset:29184
    v_mfma_f32_16x16x32_bf16 v[80:83], v[40:43], v[208:211], v[80:83]
    ds_read_b64_tr_b16 v[56:57], v10 offset:20480
    ds_read_b64_tr_b16 v[58:59], v10 offset:20992
    v_mfma_f32_16x16x32_bf16 v[84:87], v[40:43], v[212:215], v[84:87]
    ds_read_b64_tr_b16 v[60:61], v10 offset:28672
    v_mfma_f32_16x16x32_bf16 v[88:91], v[44:47], v[208:211], v[88:91]
    ds_read_b64_tr_b16 v[62:63], v10 offset:29184
    v_mfma_f32_16x16x32_bf16 v[92:95], v[44:47], v[212:215], v[92:95]
    s_waitcnt vmcnt(4)
    s_setprio 3
    s_barrier
    s_add_u32 m0, s76, 65536
    s_mul_i32 s74, s72, 229376
    buffer_load_dwordx4 v27, s[36:39], s74 offen lds
    s_waitcnt lgkmcnt(0)
    v_mfma_f32_16x16x32_bf16 v[64:67], v[48:51], v[216:219], v[64:67]
    ds_read_b128 v[224:227], v5 offset:32768
    ds_read_b128 v[228:231], v6 offset:32768
    v_mfma_f32_16x16x32_bf16 v[68:71], v[48:51], v[220:223], v[68:71]
    ds_read_b64_tr_b16 v[32:33], v9 offset:32768
    v_mfma_f32_16x16x32_bf16 v[72:75], v[52:55], v[216:219], v[72:75]
    ds_read_b64_tr_b16 v[34:35], v9 offset:33280
    ds_read_b64_tr_b16 v[36:37], v9 offset:40960
    v_mfma_f32_16x16x32_bf16 v[76:79], v[52:55], v[220:223], v[76:79]
    ds_read_b64_tr_b16 v[38:39], v9 offset:41472
    v_mfma_f32_16x16x32_bf16 v[80:83], v[56:59], v[216:219], v[80:83]
    ds_read_b64_tr_b16 v[40:41], v10 offset:32768
    ds_read_b64_tr_b16 v[42:43], v10 offset:33280
    v_mfma_f32_16x16x32_bf16 v[84:87], v[56:59], v[220:223], v[84:87]
    ds_read_b64_tr_b16 v[44:45], v10 offset:40960
    v_mfma_f32_16x16x32_bf16 v[88:91], v[60:63], v[216:219], v[88:91]
    ds_read_b64_tr_b16 v[46:47], v10 offset:41472
    v_mfma_f32_16x16x32_bf16 v[92:95], v[60:63], v[220:223], v[92:95]
    s_setprio 2
    s_add_u32 m0, s76, 73728
    s_add_u32 s72, s72, 1
    s_and_b32 s72, s72, 7
    buffer_load_dwordx4 v27, s[40:43], s74 offen lds
    s_add_u32 m0, s76, 0
    s_mul_i32 s74, s72, 229376
    buffer_load_dwordx4 v27, s[36:39], s74 offen lds
    s_add_u32 m0, s76, 8192
    s_add_u32 s72, s72, 1
    s_and_b32 s72, s72, 7
    buffer_load_dwordx4 v27, s[40:43], s74 offen lds
    s_waitcnt lgkmcnt(0)
    v_mfma_f32_16x16x32_bf16 v[64:67], v[32:35], v[224:227], v[64:67]
    ds_read_b128 v[232:235], v7 offset:32768
    ds_read_b128 v[236:239], v8 offset:32768
    v_mfma_f32_16x16x32_bf16 v[68:71], v[32:35], v[228:231], v[68:71]
    ds_read_b64_tr_b16 v[48:49], v9 offset:36864
    v_mfma_f32_16x16x32_bf16 v[72:75], v[36:39], v[224:227], v[72:75]
    ds_read_b64_tr_b16 v[50:51], v9 offset:37376
    ds_read_b64_tr_b16 v[52:53], v9 offset:45056
    v_mfma_f32_16x16x32_bf16 v[76:79], v[36:39], v[228:231], v[76:79]
    ds_read_b64_tr_b16 v[54:55], v9 offset:45568
    v_mfma_f32_16x16x32_bf16 v[80:83], v[40:43], v[224:227], v[80:83]
    ds_read_b64_tr_b16 v[56:57], v10 offset:36864
    ds_read_b64_tr_b16 v[58:59], v10 offset:37376
    v_mfma_f32_16x16x32_bf16 v[84:87], v[40:43], v[228:231], v[84:87]
    ds_read_b64_tr_b16 v[60:61], v10 offset:45056
    v_mfma_f32_16x16x32_bf16 v[88:91], v[44:47], v[224:227], v[88:91]
    ds_read_b64_tr_b16 v[62:63], v10 offset:45568
    v_mfma_f32_16x16x32_bf16 v[92:95], v[44:47], v[228:231], v[92:95]
    s_waitcnt vmcnt(4)
    s_setprio 3
    s_barrier
    s_add_u32 m0, s76, 81920
    s_mul_i32 s74, s72, 229376
    buffer_load_dwordx4 v27, s[36:39], s74 offen lds
    s_waitcnt lgkmcnt(0)
    v_mfma_f32_16x16x32_bf16 v[64:67], v[48:51], v[232:235], v[64:67]
    ds_read_b128 v[240:243], v5 offset:49152
    ds_read_b128 v[244:247], v6 offset:49152
    v_mfma_f32_16x16x32_bf16 v[68:71], v[48:51], v[236:239], v[68:71]
    ds_read_b64_tr_b16 v[32:33], v9 offset:49152
    v_mfma_f32_16x16x32_bf16 v[72:75], v[52:55], v[232:235], v[72:75]
    ds_read_b64_tr_b16 v[34:35], v9 offset:49664
    ds_read_b64_tr_b16 v[36:37], v9 offset:57344
    v_mfma_f32_16x16x32_bf16 v[76:79], v[52:55], v[236:239], v[76:79]
    ds_read_b64_tr_b16 v[38:39], v9 offset:57856
    v_mfma_f32_16x16x32_bf16 v[80:83], v[56:59], v[232:235], v[80:83]
    ds_read_b64_tr_b16 v[40:41], v10 offset:49152
    ds_read_b64_tr_b16 v[42:43], v10 offset:49664
    v_mfma_f32_16x16x32_bf16 v[84:87], v[56:59], v[236:239], v[84:87]
    ds_read_b64_tr_b16 v[44:45], v10 offset:57344
    v_mfma_f32_16x16x32_bf16 v[88:91], v[60:63], v[232:235], v[88:91]
    ds_read_b64_tr_b16 v[46:47], v10 offset:57856
    v_mfma_f32_16x16x32_bf16 v[92:95], v[60:63], v[236:239], v[92:95]
    s_setprio 2
    s_add_u32 m0, s76, 90112
    s_add_u32 s72, s72, 1
    s_and_b32 s72, s72, 7
    buffer_load_dwordx4 v27, s[40:43], s74 offen lds
    s_add_u32 m0, s76, 16384
    s_mul_i32 s74, s72, 229376
    buffer_load_dwordx4 v27, s[36:39], s74 offen lds
    s_add_u32 m0, s76, 24576
    s_add_u32 s72, s72, 1
    s_and_b32 s72, s72, 7
    buffer_load_dwordx4 v27, s[40:43], s74 offen lds
    s_waitcnt lgkmcnt(0)
    v_mfma_f32_16x16x32_bf16 v[64:67], v[32:35], v[240:243], v[64:67]
    ds_read_b128 v[248:251], v7 offset:49152
    ds_read_b128 v[252:255], v8 offset:49152
    v_mfma_f32_16x16x32_bf16 v[68:71], v[32:35], v[244:247], v[68:71]
    ds_read_b64_tr_b16 v[48:49], v9 offset:53248
    v_mfma_f32_16x16x32_bf16 v[72:75], v[36:39], v[240:243], v[72:75]
    ds_read_b64_tr_b16 v[50:51], v9 offset:53760
    ds_read_b64_tr_b16 v[52:53], v9 offset:61440
    v_mfma_f32_16x16x32_bf16 v[76:79], v[36:39], v[244:247], v[76:79]
    ds_read_b64_tr_b16 v[54:55], v9 offset:61952
    v_mfma_f32_16x16x32_bf16 v[80:83], v[40:43], v[240:243], v[80:83]
    ds_read_b64_tr_b16 v[56:57], v10 offset:53248
    ds_read_b64_tr_b16 v[58:59], v10 offset:53760
    v_mfma_f32_16x16x32_bf16 v[84:87], v[40:43], v[244:247], v[84:87]
    ds_read_b64_tr_b16 v[60:61], v10 offset:61440
    v_mfma_f32_16x16x32_bf16 v[88:91], v[44:47], v[240:243], v[88:91]
    ds_read_b64_tr_b16 v[62:63], v10 offset:61952
    v_mfma_f32_16x16x32_bf16 v[92:95], v[44:47], v[244:247], v[92:95]
    v_subrev_u32 v5, 65536, v9
    v_subrev_u32 v6, 65536, v10
    v_add_u32 v7, 65536, v9
    v_add_u32 v8, 65536, v10
    s_waitcnt vmcnt(4)
    s_setprio 3
    s_barrier
    s_waitcnt lgkmcnt(0)
    v_mfma_f32_16x16x32_bf16 v[64:67], v[48:51], v[248:251], v[64:67]
    ds_read_b64_tr_b16 v[32:33], v9 offset:0
    ds_read_b64_tr_b16 v[34:35], v9 offset:512
    v_mfma_f32_16x16x32_bf16 v[68:71], v[48:51], v[252:255], v[68:71]
    ds_read_b64_tr_b16 v[36:37], v9 offset:4096
    v_mfma_f32_16x16x32_bf16 v[72:75], v[52:55], v[248:251], v[72:75]
    ds_read_b64_tr_b16 v[38:39], v9 offset:4608
    v_mfma_f32_16x16x32_bf16 v[76:79], v[52:55], v[252:255], v[76:79]
    ds_read_b64_tr_b16 v[40:41], v5 offset:0
    v_mfma_f32_16x16x32_bf16 v[80:83], v[56:59], v[248:251], v[80:83]
    ds_read_b64_tr_b16 v[42:43], v5 offset:512
    v_mfma_f32_16x16x32_bf16 v[84:87], v[56:59], v[252:255], v[84:87]
    ds_read_b64_tr_b16 v[44:45], v5 offset:4096
    v_mfma_f32_16x16x32_bf16 v[88:91], v[60:63], v[248:251], v[88:91]
    ds_read_b64_tr_b16 v[46:47], v5 offset:4608
    v_mfma_f32_16x16x32_bf16 v[92:95], v[60:63], v[252:255], v[92:95]
    s_setprio 2
    s_add_u32 s88, s84, 3149824
    s_add_u32 s84, s84, 3145728
    s_and_b32 s80, s98, 0xffff80
    v_lshlrev_b32 v22, 2, v15
    s_mov_b32 exec_hi, 0
    buffer_store_dword v17, v22, s[52:55], s80 offen sc1
    s_mov_b32 exec_hi, -1
    v_cvt_pk_bf16_f32 v64, v64, v65
    v_cvt_pk_bf16_f32 v65, v66, v67
    v_cvt_pk_bf16_f32 v66, v68, v69
    v_cvt_pk_bf16_f32 v67, v70, v71
    v_cvt_pk_bf16_f32 v72, v72, v73
    v_cvt_pk_bf16_f32 v73, v74, v75
    v_cvt_pk_bf16_f32 v74, v76, v77
    v_cvt_pk_bf16_f32 v75, v78, v79
    v_permlane16_swap_b32 v64, v66
    v_permlane16_swap_b32 v65, v67
    v_and_b32 v64, -2, v64
    buffer_store_dwordx4 v[64:67], v4, s[52:55], s84 offen offset:0 sc1
    v_permlane16_swap_b32 v72, v74
    v_permlane16_swap_b32 v73, v75
    v_and_b32 v72, -2, v72
    buffer_store_dwordx4 v[72:75], v4, s[52:55], s88 offen offset:0 sc1
    s_waitcnt lgkmcnt(0)
    v_mfma_f32_16x16x32_bf16 v[96:99], v[32:35], v[128:131], 0
    ds_read_b64_tr_b16 v[48:49], v9 offset:8192
    ds_read_b64_tr_b16 v[50:51], v9 offset:8704
    v_mfma_f32_16x16x32_bf16 v[96:99], v[36:39], v[136:139], v[96:99]
    ds_read_b64_tr_b16 v[52:53], v9 offset:12288
    v_mfma_f32_16x16x32_bf16 v[96:99], v[40:43], v[144:147], v[96:99]
    ds_read_b64_tr_b16 v[54:55], v9 offset:12800
    v_mfma_f32_16x16x32_bf16 v[96:99], v[44:47], v[152:155], v[96:99]
    ds_read_b64_tr_b16 v[56:57], v5 offset:8192
    v_mfma_f32_16x16x32_bf16 v[100:103], v[32:35], v[132:135], 0
    ds_read_b64_tr_b16 v[58:59], v5 offset:8704
    v_mfma_f32_16x16x32_bf16 v[100:103], v[36:39], v[140:143], v[100:103]
    ds_read_b64_tr_b16 v[60:61], v5 offset:12288
    v_mfma_f32_16x16x32_bf16 v[100:103], v[40:43], v[148:151], v[100:103]
    ds_read_b64_tr_b16 v[62:63], v5 offset:12800
    v_mfma_f32_16x16x32_bf16 v[100:103], v[44:47], v[156:159], v[100:103]
    s_setprio 1
    v_cvt_pk_bf16_f32 v80, v80, v81
    v_cvt_pk_bf16_f32 v81, v82, v83
    v_cvt_pk_bf16_f32 v82, v84, v85
    v_cvt_pk_bf16_f32 v83, v86, v87
    v_cvt_pk_bf16_f32 v88, v88, v89
    v_cvt_pk_bf16_f32 v89, v90, v91
    v_cvt_pk_bf16_f32 v90, v92, v93
    v_cvt_pk_bf16_f32 v91, v94, v95
    v_permlane16_swap_b32 v80, v82
    v_permlane16_swap_b32 v81, v83
    v_and_b32 v80, -2, v80
    buffer_store_dwordx4 v[80:83], v4, s[52:55], s84 offen offset:1024 sc1
    v_permlane16_swap_b32 v88, v90
    v_permlane16_swap_b32 v89, v91
    v_and_b32 v88, -2, v88
    buffer_store_dwordx4 v[88:91], v4, s[52:55], s88 offen offset:1024 sc1
    s_waitcnt lgkmcnt(0)
    v_mfma_f32_16x16x32_bf16 v[104:107], v[48:51], v[128:131], 0
    ds_read_b64_tr_b16 v[32:33], v10 offset:0
    ds_read_b64_tr_b16 v[34:35], v10 offset:512
    v_mfma_f32_16x16x32_bf16 v[104:107], v[52:55], v[136:139], v[104:107]
    ds_read_b64_tr_b16 v[36:37], v10 offset:4096
    v_mfma_f32_16x16x32_bf16 v[104:107], v[56:59], v[144:147], v[104:107]
    ds_read_b64_tr_b16 v[38:39], v10 offset:4608
    v_mfma_f32_16x16x32_bf16 v[104:107], v[60:63], v[152:155], v[104:107]
    ds_read_b64_tr_b16 v[40:41], v6 offset:0
    v_mfma_f32_16x16x32_bf16 v[108:111], v[48:51], v[132:135], 0
    ds_read_b64_tr_b16 v[42:43], v6 offset:512
    v_mfma_f32_16x16x32_bf16 v[108:111], v[52:55], v[140:143], v[108:111]
    ds_read_b64_tr_b16 v[44:45], v6 offset:4096
    v_mfma_f32_16x16x32_bf16 v[108:111], v[56:59], v[148:151], v[108:111]
    ds_read_b64_tr_b16 v[46:47], v6 offset:4608
    v_mfma_f32_16x16x32_bf16 v[108:111], v[60:63], v[156:159], v[108:111]
    s_setprio 0
    s_waitcnt lgkmcnt(0)
    v_mfma_f32_16x16x32_bf16 v[112:115], v[32:35], v[128:131], 0
    ds_read_b64_tr_b16 v[48:49], v10 offset:8192
    ds_read_b64_tr_b16 v[50:51], v10 offset:8704
    v_mfma_f32_16x16x32_bf16 v[112:115], v[36:39], v[136:139], v[112:115]
    ds_read_b64_tr_b16 v[52:53], v10 offset:12288
    v_mfma_f32_16x16x32_bf16 v[112:115], v[40:43], v[144:147], v[112:115]
    ds_read_b64_tr_b16 v[54:55], v10 offset:12800
    v_mfma_f32_16x16x32_bf16 v[112:115], v[44:47], v[152:155], v[112:115]
    ds_read_b64_tr_b16 v[56:57], v6 offset:8192
    v_mfma_f32_16x16x32_bf16 v[116:119], v[32:35], v[132:135], 0
    ds_read_b64_tr_b16 v[58:59], v6 offset:8704
    v_mfma_f32_16x16x32_bf16 v[116:119], v[36:39], v[140:143], v[116:119]
    ds_read_b64_tr_b16 v[60:61], v6 offset:12288
    v_mfma_f32_16x16x32_bf16 v[116:119], v[40:43], v[148:151], v[116:119]
    ds_read_b64_tr_b16 v[62:63], v6 offset:12800
    v_mfma_f32_16x16x32_bf16 v[116:119], v[44:47], v[156:159], v[116:119]
    s_waitcnt vmcnt(5)
    s_setprio 3
    s_barrier
    s_add_u32 m0, s76, 98304
    s_mul_i32 s74, s72, 229376
    buffer_load_dwordx4 v27, s[36:39], s74 offen lds
    s_waitcnt lgkmcnt(0)
    v_mfma_f32_16x16x32_bf16 v[120:123], v[48:51], v[128:131], 0
    ds_read_b64_tr_b16 v[32:33], v9 offset:16384
    ds_read_b64_tr_b16 v[34:35], v9 offset:16896
    v_mfma_f32_16x16x32_bf16 v[120:123], v[52:55], v[136:139], v[120:123]
    ds_read_b64_tr_b16 v[36:37], v9 offset:20480
    v_mfma_f32_16x16x32_bf16 v[120:123], v[56:59], v[144:147], v[120:123]
    ds_read_b64_tr_b16 v[38:39], v9 offset:20992
    v_mfma_f32_16x16x32_bf16 v[120:123], v[60:63], v[152:155], v[120:123]
    ds_read_b64_tr_b16 v[40:41], v5 offset:16384
    v_mfma_f32_16x16x32_bf16 v[124:127], v[48:51], v[132:135], 0
    ds_read_b64_tr_b16 v[42:43], v5 offset:16896
    v_mfma_f32_16x16x32_bf16 v[124:127], v[52:55], v[140:143], v[124:127]
    ds_read_b64_tr_b16 v[44:45], v5 offset:20480
    v_mfma_f32_16x16x32_bf16 v[124:127], v[56:59], v[148:151], v[124:127]
    ds_read_b64_tr_b16 v[46:47], v5 offset:20992
    v_mfma_f32_16x16x32_bf16 v[124:127], v[60:63], v[156:159], v[124:127]
    s_setprio 2
    s_add_u32 m0, s76, 106496
    s_add_u32 s72, s72, 1
    s_and_b32 s72, s72, 7
    buffer_load_dwordx4 v27, s[40:43], s74 offen lds
    s_add_u32 m0, s76, 32768
    s_mul_i32 s74, s72, 229376
    buffer_load_dwordx4 v27, s[36:39], s74 offen lds
    s_add_u32 m0, s76, 40960
    s_add_u32 s72, s72, 1
    s_and_b32 s72, s72, 7
    buffer_load_dwordx4 v27, s[40:43], s74 offen lds
    s_waitcnt lgkmcnt(0)
    v_mfma_f32_16x16x32_bf16 v[96:99], v[32:35], v[160:163], v[96:99]
    ds_read_b64_tr_b16 v[48:49], v9 offset:24576
    ds_read_b64_tr_b16 v[50:51], v9 offset:25088
    v_mfma_f32_16x16x32_bf16 v[96:99], v[36:39], v[168:171], v[96:99]
    ds_read_b64_tr_b16 v[52:53], v9 offset:28672
    v_mfma_f32_16x16x32_bf16 v[96:99], v[40:43], v[176:179], v[96:99]
    ds_read_b64_tr_b16 v[54:55], v9 offset:29184
    v_mfma_f32_16x16x32_bf16 v[96:99], v[44:47], v[184:187], v[96:99]
    ds_read_b64_tr_b16 v[56:57], v5 offset:24576
    v_mfma_f32_16x16x32_bf16 v[100:103], v[44:47], v[188:191], v[100:103]
    ds_read_b64_tr_b16 v[58:59], v5 offset:25088
    v_mfma_f32_16x16x32_bf16 v[100:103], v[40:43], v[180:183], v[100:103]
    ds_read_b64_tr_b16 v[60:61], v5 offset:28672
    v_mfma_f32_16x16x32_bf16 v[100:103], v[36:39], v[172:175], v[100:103]
    ds_read_b64_tr_b16 v[62:63], v5 offset:29184
    v_mfma_f32_16x16x32_bf16 v[100:103], v[32:35], v[164:167], v[100:103]
    s_waitcnt vmcnt(4)
    s_setprio 3
    s_barrier
    s_waitcnt lgkmcnt(0)
    v_mfma_f32_16x16x32_bf16 v[104:107], v[48:51], v[160:163], v[104:107]
    ds_read_b64_tr_b16 v[32:33], v10 offset:16384
    ds_read_b64_tr_b16 v[34:35], v10 offset:16896
    v_mfma_f32_16x16x32_bf16 v[104:107], v[52:55], v[168:171], v[104:107]
    ds_read_b64_tr_b16 v[36:37], v10 offset:20480
    v_mfma_f32_16x16x32_bf16 v[104:107], v[56:59], v[176:179], v[104:107]
    ds_read_b64_tr_b16 v[38:39], v10 offset:20992
    v_mfma_f32_16x16x32_bf16 v[104:107], v[60:63], v[184:187], v[104:107]
    ds_read_b64_tr_b16 v[40:41], v6 offset:16384
    v_mfma_f32_16x16x32_bf16 v[108:111], v[60:63], v[188:191], v[108:111]
    ds_read_b64_tr_b16 v[42:43], v6 offset:16896
    v_mfma_f32_16x16x32_bf16 v[108:111], v[56:59], v[180:183], v[108:111]
    ds_read_b64_tr_b16 v[44:45], v6 offset:20480
    v_mfma_f32_16x16x32_bf16 v[108:111], v[52:55], v[172:175], v[108:111]
    ds_read_b64_tr_b16 v[46:47], v6 offset:20992
    v_mfma_f32_16x16x32_bf16 v[108:111], v[48:51], v[164:167], v[108:111]
    s_setprio 2
    v_and_b32 v152, 31, v15
    v_lshlrev_b32 v152, 2, v152
    v_mov_b32 v154, 0xdddddddd
    v_mov_b32 v141, 0x3f803f80
    s_mov_b32 vcc_lo, 0x22
    s_mov_b32 vcc_hi, 0x22
    v_cndmask_b32 v140, 0, v141, vcc
    v_mov_b32 v141, v140
    s_waitcnt lgkmcnt(0)
    v_mfma_f32_16x16x32_bf16 v[112:115], v[32:35], v[160:163], v[112:115]
    ds_read_b64_tr_b16 v[48:49], v10 offset:24576
    ds_read_b64_tr_b16 v[50:51], v10 offset:25088
    v_mfma_f32_16x16x32_bf16 v[112:115], v[36:39], v[168:171], v[112:115]
    ds_read_b64_tr_b16 v[52:53], v10 offset:28672
    v_mfma_f32_16x16x32_bf16 v[112:115], v[40:43], v[176:179], v[112:115]
    ds_read_b64_tr_b16 v[54:55], v10 offset:29184
    v_mfma_f32_16x16x32_bf16 v[112:115], v[44:47], v[184:187], v[112:115]
    ds_read_b64_tr_b16 v[56:57], v6 offset:24576
    v_mfma_f32_16x16x32_bf16 v[116:119], v[44:47], v[188:191], v[116:119]
    ds_read_b64_tr_b16 v[58:59], v6 offset:25088
    v_mfma_f32_16x16x32_bf16 v[116:119], v[40:43], v[180:183], v[116:119]
    ds_read_b64_tr_b16 v[60:61], v6 offset:28672
    v_mfma_f32_16x16x32_bf16 v[116:119], v[36:39], v[172:175], v[116:119]
    ds_read_b64_tr_b16 v[62:63], v6 offset:29184
    v_mfma_f32_16x16x32_bf16 v[116:119], v[32:35], v[164:167], v[116:119]
    s_waitcnt vmcnt(0)
    s_setprio 3
    s_barrier
    s_waitcnt lgkmcnt(0)
    v_mfma_f32_16x16x32_bf16 v[120:123], v[48:51], v[160:163], v[120:123]
    ds_read_b64_tr_b16 v[32:33], v9 offset:32768
    ds_read_b64_tr_b16 v[34:35], v9 offset:33280
    v_mfma_f32_16x16x32_bf16 v[120:123], v[52:55], v[168:171], v[120:123]
    ds_read_b64_tr_b16 v[36:37], v9 offset:36864
    v_mfma_f32_16x16x32_bf16 v[120:123], v[56:59], v[176:179], v[120:123]
    ds_read_b64_tr_b16 v[38:39], v9 offset:37376
    v_mfma_f32_16x16x32_bf16 v[120:123], v[60:63], v[184:187], v[120:123]
    ds_read_b64_tr_b16 v[40:41], v5 offset:32768
    v_mfma_f32_16x16x32_bf16 v[124:127], v[60:63], v[188:191], v[124:127]
    ds_read_b64_tr_b16 v[42:43], v5 offset:33280
    v_mfma_f32_16x16x32_bf16 v[124:127], v[56:59], v[180:183], v[124:127]
    ds_read_b64_tr_b16 v[44:45], v5 offset:36864
    v_mfma_f32_16x16x32_bf16 v[124:127], v[52:55], v[172:175], v[124:127]
    ds_read_b64_tr_b16 v[46:47], v5 offset:37376
    v_mfma_f32_16x16x32_bf16 v[124:127], v[48:51], v[164:167], v[124:127]
    s_setprio 2
    s_add_u32 m0, s76, 131072
    s_mul_i32 s74, s72, 229376
    buffer_load_dwordx4 v27, s[36:39], s74 offen lds
    s_add_u32 m0, s76, 139264
    s_add_u32 s72, s72, 1
    s_and_b32 s72, s72, 7
    buffer_load_dwordx4 v27, s[40:43], s74 offen lds
    v_mov_b64 v[142:143], v[140:141]
    v_mov_b64 v[144:145], v[140:141]
    v_mov_b64 v[146:147], v[140:141]
    v_mov_b64 v[148:149], v[140:141]
    v_mov_b64 v[150:151], v[140:141]
    s_waitcnt lgkmcnt(0)
    v_mfma_f32_16x16x32_bf16 v[96:99], v[32:35], v[192:195], v[96:99]
    ds_read_b64_tr_b16 v[48:49], v9 offset:40960
    ds_read_b64_tr_b16 v[50:51], v9 offset:41472
    v_mfma_f32_16x16x32_bf16 v[96:99], v[36:39], v[200:203], v[96:99]
    ds_read_b64_tr_b16 v[52:53], v9 offset:45056
    v_mfma_f32_16x16x32_bf16 v[96:99], v[40:43], v[208:211], v[96:99]
    ds_read_b64_tr_b16 v[54:55], v9 offset:45568
    v_mfma_f32_16x16x32_bf16 v[96:99], v[44:47], v[216:219], v[96:99]
    ds_read_b64_tr_b16 v[56:57], v5 offset:40960
    v_mfma_f32_16x16x32_bf16 v[100:103], v[44:47], v[220:223], v[100:103]
    ds_read_b64_tr_b16 v[58:59], v5 offset:41472
    v_mfma_f32_16x16x32_bf16 v[100:103], v[40:43], v[212:215], v[100:103]
    ds_read_b64_tr_b16 v[60:61], v5 offset:45056
    v_mfma_f32_16x16x32_bf16 v[100:103], v[36:39], v[204:207], v[100:103]
    ds_read_b64_tr_b16 v[62:63], v5 offset:45568
    v_mfma_f32_16x16x32_bf16 v[100:103], v[32:35], v[196:199], v[100:103]
    s_setprio 1
    s_add_u32 m0, s76, 147456
    s_mul_i32 s74, s72, 229376
    buffer_load_dwordx4 v27, s[36:39], s74 offen lds
    s_add_u32 m0, s76, 155648
    s_add_u32 s72, s72, 1
    s_and_b32 s72, s72, 7
    buffer_load_dwordx4 v27, s[40:43], s74 offen lds
    v_add_u32 v159, s100, v31
    v_xor_b32 v160, 64, v159
    v_add_u32 v158, 7168, v0
    v_add_u32 v161, s89, v14
    v_xor_b32 v162, 0x400, v161
    s_waitcnt lgkmcnt(0)
    v_mfma_f32_16x16x32_bf16 v[104:107], v[48:51], v[192:195], v[104:107]
    ds_read_b64_tr_b16 v[32:33], v10 offset:32768
    ds_read_b64_tr_b16 v[34:35], v10 offset:33280
    v_mfma_f32_16x16x32_bf16 v[104:107], v[52:55], v[200:203], v[104:107]
    ds_read_b64_tr_b16 v[36:37], v10 offset:36864
    v_mfma_f32_16x16x32_bf16 v[104:107], v[56:59], v[208:211], v[104:107]
    ds_read_b64_tr_b16 v[38:39], v10 offset:37376
    v_mfma_f32_16x16x32_bf16 v[104:107], v[60:63], v[216:219], v[104:107]
    ds_read_b64_tr_b16 v[40:41], v6 offset:32768
    v_mfma_f32_16x16x32_bf16 v[108:111], v[60:63], v[220:223], v[108:111]
    ds_read_b64_tr_b16 v[42:43], v6 offset:33280
    v_mfma_f32_16x16x32_bf16 v[108:111], v[56:59], v[212:215], v[108:111]
    ds_read_b64_tr_b16 v[44:45], v6 offset:36864
    v_mfma_f32_16x16x32_bf16 v[108:111], v[52:55], v[204:207], v[108:111]
    ds_read_b64_tr_b16 v[46:47], v6 offset:37376
    v_mfma_f32_16x16x32_bf16 v[108:111], v[48:51], v[196:199], v[108:111]
    s_setprio 0
    v_lshlrev_b32 v163, 7, v15
    v_mov_b32 v168, 1
    v_lshl_add_u32 v171, v15, 2, s86
    v_lshl_add_u32 v172, v15, 2, s87
    v_mov_b64 v[176:177], 0
    s_waitcnt lgkmcnt(0)
    v_mfma_f32_16x16x32_bf16 v[112:115], v[32:35], v[192:195], v[112:115]
    ds_read_b64_tr_b16 v[48:49], v10 offset:40960
    ds_read_b64_tr_b16 v[50:51], v10 offset:41472
    v_mfma_f32_16x16x32_bf16 v[112:115], v[36:39], v[200:203], v[112:115]
    ds_read_b64_tr_b16 v[52:53], v10 offset:45056
    v_mfma_f32_16x16x32_bf16 v[112:115], v[40:43], v[208:211], v[112:115]
    ds_read_b64_tr_b16 v[54:55], v10 offset:45568
    v_mfma_f32_16x16x32_bf16 v[112:115], v[44:47], v[216:219], v[112:115]
    ds_read_b64_tr_b16 v[56:57], v6 offset:40960
    v_mfma_f32_16x16x32_bf16 v[116:119], v[44:47], v[220:223], v[116:119]
    ds_read_b64_tr_b16 v[58:59], v6 offset:41472
    v_mfma_f32_16x16x32_bf16 v[116:119], v[40:43], v[212:215], v[116:119]
    ds_read_b64_tr_b16 v[60:61], v6 offset:45056
    v_mfma_f32_16x16x32_bf16 v[116:119], v[36:39], v[204:207], v[116:119]
    ds_read_b64_tr_b16 v[62:63], v6 offset:45568
    v_mfma_f32_16x16x32_bf16 v[116:119], v[32:35], v[196:199], v[116:119]
    s_waitcnt vmcnt(0)
    s_setprio 3
    s_barrier
    s_waitcnt lgkmcnt(0)
    v_mfma_f32_16x16x32_bf16 v[120:123], v[48:51], v[192:195], v[120:123]
    ds_read_b64_tr_b16 v[32:33], v7 offset:0
    ds_read_b64_tr_b16 v[34:35], v7 offset:512
    v_mfma_f32_16x16x32_bf16 v[120:123], v[52:55], v[200:203], v[120:123]
    ds_read_b64_tr_b16 v[36:37], v7 offset:4096
    v_mfma_f32_16x16x32_bf16 v[120:123], v[56:59], v[208:211], v[120:123]
    ds_read_b64_tr_b16 v[38:39], v7 offset:4608
    v_mfma_f32_16x16x32_bf16 v[120:123], v[60:63], v[216:219], v[120:123]
    ds_read_b64_tr_b16 v[40:41], v7 offset:16384
    v_mfma_f32_16x16x32_bf16 v[124:127], v[60:63], v[220:223], v[124:127]
    ds_read_b64_tr_b16 v[42:43], v7 offset:16896
    v_mfma_f32_16x16x32_bf16 v[124:127], v[56:59], v[212:215], v[124:127]
    ds_read_b64_tr_b16 v[44:45], v7 offset:20480
    v_mfma_f32_16x16x32_bf16 v[124:127], v[52:55], v[204:207], v[124:127]
    ds_read_b64_tr_b16 v[46:47], v7 offset:20992
    v_mfma_f32_16x16x32_bf16 v[124:127], v[48:51], v[196:199], v[124:127]
    s_setprio 2
    v_mov_b64 v[178:179], 0
    v_mov_b64 v[180:181], 0
    v_mov_b64 v[182:183], 0
    v_mov_b64 v[184:185], 0
    v_mov_b64 v[186:187], 0
    s_waitcnt lgkmcnt(0)
    v_mfma_f32_16x16x32_bf16 v[96:99], v[32:35], v[224:227], v[96:99]
    ds_read_b64_tr_b16 v[48:49], v7 offset:8192
    ds_read_b64_tr_b16 v[50:51], v7 offset:8704
    v_mfma_f32_16x16x32_bf16 v[96:99], v[36:39], v[232:235], v[96:99]
    ds_read_b64_tr_b16 v[52:53], v7 offset:12288
    v_mfma_f32_16x16x32_bf16 v[96:99], v[40:43], v[240:243], v[96:99]
    ds_read_b64_tr_b16 v[54:55], v7 offset:12800
    v_mfma_f32_16x16x32_bf16 v[96:99], v[44:47], v[248:251], v[96:99]
    ds_read_b64_tr_b16 v[56:57], v7 offset:24576
    v_mfma_f32_16x16x32_bf16 v[100:103], v[44:47], v[252:255], v[100:103]
    ds_read_b64_tr_b16 v[58:59], v7 offset:25088
    v_mfma_f32_16x16x32_bf16 v[100:103], v[40:43], v[244:247], v[100:103]
    ds_read_b64_tr_b16 v[60:61], v7 offset:28672
    v_mfma_f32_16x16x32_bf16 v[100:103], v[36:39], v[236:239], v[100:103]
    ds_read_b64_tr_b16 v[62:63], v7 offset:29184
    v_mfma_f32_16x16x32_bf16 v[100:103], v[32:35], v[228:231], v[100:103]
    s_setprio 1
    v_mov_b64 v[188:189], 0
    v_mov_b64 v[190:191], 0
    v_mov_b64 v[192:193], 0
    v_mov_b64 v[194:195], 0
    v_mov_b64 v[196:197], 0
    s_waitcnt lgkmcnt(0)
    v_mfma_f32_16x16x32_bf16 v[104:107], v[48:51], v[224:227], v[104:107]
    ds_read_b64_tr_b16 v[32:33], v8 offset:0
    ds_read_b64_tr_b16 v[34:35], v8 offset:512
    v_mfma_f32_16x16x32_bf16 v[104:107], v[52:55], v[232:235], v[104:107]
    ds_read_b64_tr_b16 v[36:37], v8 offset:4096
    v_mfma_f32_16x16x32_bf16 v[104:107], v[56:59], v[240:243], v[104:107]
    ds_read_b64_tr_b16 v[38:39], v8 offset:4608
    v_mfma_f32_16x16x32_bf16 v[104:107], v[60:63], v[248:251], v[104:107]
    ds_read_b64_tr_b16 v[40:41], v8 offset:16384
    v_mfma_f32_16x16x32_bf16 v[108:111], v[60:63], v[252:255], v[108:111]
    ds_read_b64_tr_b16 v[42:43], v8 offset:16896
    v_mfma_f32_16x16x32_bf16 v[108:111], v[56:59], v[244:247], v[108:111]
    ds_read_b64_tr_b16 v[44:45], v8 offset:20480
    v_mfma_f32_16x16x32_bf16 v[108:111], v[52:55], v[236:239], v[108:111]
    ds_read_b64_tr_b16 v[46:47], v8 offset:20992
    v_mfma_f32_16x16x32_bf16 v[108:111], v[48:51], v[228:231], v[108:111]
    s_setprio 0
    v_mov_b64 v[198:199], 0
    v_mov_b64 v[200:201], 0
    v_mov_b64 v[202:203], 0
    v_mov_b64 v[204:205], 0
    v_mov_b64 v[206:207], 0
    s_waitcnt lgkmcnt(0)
    v_mfma_f32_16x16x32_bf16 v[112:115], v[32:35], v[224:227], v[112:115]
    ds_read_b64_tr_b16 v[48:49], v8 offset:8192
    ds_read_b64_tr_b16 v[50:51], v8 offset:8704
    v_mfma_f32_16x16x32_bf16 v[112:115], v[36:39], v[232:235], v[112:115]
    ds_read_b64_tr_b16 v[52:53], v8 offset:12288
    v_mfma_f32_16x16x32_bf16 v[112:115], v[40:43], v[240:243], v[112:115]
    ds_read_b64_tr_b16 v[54:55], v8 offset:12800
    v_mfma_f32_16x16x32_bf16 v[112:115], v[44:47], v[248:251], v[112:115]
    ds_read_b64_tr_b16 v[56:57], v8 offset:24576
    v_mfma_f32_16x16x32_bf16 v[116:119], v[44:47], v[252:255], v[116:119]
    ds_read_b64_tr_b16 v[58:59], v8 offset:25088
    v_mfma_f32_16x16x32_bf16 v[116:119], v[40:43], v[244:247], v[116:119]
    ds_read_b64_tr_b16 v[60:61], v8 offset:28672
    v_mfma_f32_16x16x32_bf16 v[116:119], v[36:39], v[236:239], v[116:119]
    ds_read_b64_tr_b16 v[62:63], v8 offset:29184
    v_mfma_f32_16x16x32_bf16 v[116:119], v[32:35], v[228:231], v[116:119]
    s_waitcnt lgkmcnt(0)
    s_branch L_join
.p2align 12
.fill 112, 4, 0xbf800000
L_pathS:
    s_mov_b32 s48, s22
    s_mov_b32 s49, s23
    s_mov_b32 s50, 1024
    s_mov_b32 s51, 0x20000
    s_lshl_b32 s91, s79, 7
    v_add_u32 v11, s91, v14
    v_and_b32 v11, 0x3ff, v11
    v_and_b32 v20, 48, v15
    v_add_u32 v12, 147456, v20
    v_and_b32 v20, 15, v15
    v_lshlrev_b32 v30, 2, v20
    s_lshr_b32 s90, s84, 15
    s_lshl1_add_u32 s90, s90, s85
    s_lshl_b32 s90, s90, 6
    s_add_u32 s90, s90, 131072
    s_add_u32 m0, s76, 16384
    s_lshl_b32 s73, s72, 7
    buffer_load_dwordx4 v1, s[32:35], s73 offen lds
    s_mov_b32 m0, 147456
    s_nop 0
    buffer_load_dwordx4 v11, s[48:51], 0 offen lds
    s_add_u32 m0, s76, 81920
    s_mul_i32 s74, s72, 229376
    buffer_load_dwordx4 v3, s[36:39], s74 offen lds
    s_add_u32 m0, s76, 90112
    s_add_u32 s72, s72, 1
    buffer_load_dwordx4 v3, s[40:43], s74 offen lds
    s_add_u32 m0, s76, 24576
    s_and_b32 s72, s72, 7
    buffer_load_dwordx4 v2, s[32:35], s73 offen lds
    s_lshr_b32 s80, s68, 2
    s_lshl_b32 s81, s80, 16
    v_add_u32 v26, s81, v14
    s_and_b32 s81, s68, 1
    s_mul_i32 s81, s81, 49152
    v_add_u32 v24, s81, v14
    v_add_u32 v25, s81, v29
    s_mul_i32 s81, s80, 49152
    s_and_b32 s86, s68, 3
    s_lshl_b32 s87, s86, 11
    s_add_u32 s83, s87, s81
    s_lshl_b32 s87, s2, 2
    s_add_u32 s86, s86, s87
    s_and_b32 s86, s86, 31
    s_lshl_b32 s85, s86, 11
    s_add_u32 s1, s101, 3145728
    s_xor_b32 s1, s1, 1024
    s_lshl1_add_u32 s79, s77, s80
    s_lshl_b32 s79, s79, 7
    s_add_u32 s79, s79, 131072
    s_lshr_b32 s86, s77, 3
    s_lshl3_add_u32 s86, s86, s68
    s_mul_i32 s86, s86, 224
    s_and_b32 s87, s77, 7
    s_lshl1_add_u32 s87, s87, s80
    s_add_u32 s86, s86, s87
    s_lshl_b32 s86, s86, 10
    s_add_u32 s89, s86, 5242880
    s_lshr_b32 s97, s77, 1
    s_lshl_b32 s97, s97, 9
    s_add_u32 s97, s97, 204800
    s_lshl_b32 s81, s68, 24
    s_add_u32 s98, s98, s81
    s_mul_i32 s86, s68, 2304
    s_add_u32 s86, s86, 65536
    s_xor_b32 s87, s68, 1
    s_mul_i32 s87, s87, 2304
    s_add_u32 s87, s87, 65536
    s_waitcnt vmcnt(5)
    s_setprio 3
    s_barrier
    s_add_u32 m0, s76, 32768
    s_lshl_b32 s73, s72, 7
    buffer_load_dwordx4 v1, s[32:35], s73 offen lds
    s_waitcnt lgkmcnt(0)
    ds_read_b128 v[128:131], v5 offset:0
    ds_read_b128 v[132:135], v6 offset:0
    ds_read_b64_tr_b16 v[32:33], v9 offset:0
    ds_read_b64_tr_b16 v[34:35], v9 offset:512
    ds_read_b64_tr_b16 v[36:37], v9 offset:8192
    ds_read_b64_tr_b16 v[38:39], v9 offset:8704
    ds_read_b64_tr_b16 v[40:41], v10 offset:0
    ds_read_b64_tr_b16 v[42:43], v10 offset:512
    ds_read_b64_tr_b16 v[44:45], v10 offset:8192
    ds_read_b64_tr_b16 v[46:47], v10 offset:8704
    s_add_u32 m0, s76, 98304
    s_mul_i32 s74, s72, 229376
    buffer_load_dwordx4 v3, s[36:39], s74 offen lds
    s_add_u32 m0, s76, 106496
    s_add_u32 s72, s72, 1
    buffer_load_dwordx4 v3, s[40:43], s74 offen lds
    s_add_u32 m0, s76, 40960
    s_and_b32 s72, s72, 7
    buffer_load_dwordx4 v2, s[32:35], s73 offen lds
    s_waitcnt lgkmcnt(0)
    v_mfma_f32_16x16x32_bf16 v[64:67], v[32:35], v[128:131], 0
    ds_read_b128 v[136:139], v7 offset:0
    ds_read_b128 v[140:143], v8 offset:0
    v_mfma_f32_16x16x32_bf16 v[68:71], v[32:35], v[132:135], 0
    ds_read_b64_tr_b16 v[48:49], v9 offset:4096
    v_mfma_f32_16x16x32_bf16 v[72:75], v[36:39], v[128:131], 0
    ds_read_b64_tr_b16 v[50:51], v9 offset:4608
    ds_read_b64_tr_b16 v[52:53], v9 offset:12288
    v_mfma_f32_16x16x32_bf16 v[76:79], v[36:39], v[132:135], 0
    ds_read_b64_tr_b16 v[54:55], v9 offset:12800
    v_mfma_f32_16x16x32_bf16 v[80:83], v[40:43], v[128:131], 0
    ds_read_b64_tr_b16 v[56:57], v10 offset:4096
    ds_read_b64_tr_b16 v[58:59], v10 offset:4608
    v_mfma_f32_16x16x32_bf16 v[84:87], v[40:43], v[132:135], 0
    ds_read_b64_tr_b16 v[60:61], v10 offset:12288
    v_mfma_f32_16x16x32_bf16 v[88:91], v[44:47], v[128:131], 0
    ds_read_b64_tr_b16 v[62:63], v10 offset:12800
    v_mfma_f32_16x16x32_bf16 v[92:95], v[44:47], v[132:135], 0
    s_waitcnt vmcnt(4)
    s_setprio 3
    s_barrier
    s_add_u32 m0, s76, 49152
    s_lshl_b32 s73, s72, 7
    buffer_load_dwordx4 v1, s[32:35], s73 offen lds
    s_waitcnt lgkmcnt(0)
    v_mfma_f32_16x16x32_bf16 v[64:67], v[48:51], v[136:139], v[64:67]
    ds_read_b128 v[144:147], v5 offset:16384
    ds_read_b128 v[148:151], v6 offset:16384
    v_mfma_f32_16x16x32_bf16 v[68:71], v[48:51], v[140:143], v[68:71]
    ds_read_b64_tr_b16 v[32:33], v9 offset:16384
    ds_read_b64_tr_b16 v[34:35], v9 offset:16896
    v_mfma_f32_16x16x32_bf16 v[72:75], v[52:55], v[136:139], v[72:75]
    ds_read_b64_tr_b16 v[36:37], v9 offset:24576
    ds_read_b64_tr_b16 v[38:39], v9 offset:25088
    v_mfma_f32_16x16x32_bf16 v[76:79], v[52:55], v[140:143], v[76:79]
    ds_read_b64_tr_b16 v[40:41], v10 offset:16384
    v_mfma_f32_16x16x32_bf16 v[80:83], v[56:59], v[136:139], v[80:83]
    ds_read_b64_tr_b16 v[42:43], v10 offset:16896
    ds_read_b64_tr_b16 v[44:45], v10 offset:24576
    v_mfma_f32_16x16x32_bf16 v[84:87], v[56:59], v[140:143], v[84:87]
    ds_read_b64_tr_b16 v[46:47], v10 offset:25088
    ds_read_b128 v[100:103], v12 offset:0
    v_mfma_f32_16x16x32_bf16 v[88:91], v[60:63], v[136:139], v[88:91]
    ds_read_b128 v[104:107], v12 offset:64
    v_mfma_f32_16x16x32_bf16 v[92:95], v[60:63], v[140:143], v[92:95]
    s_setprio 2
    s_add_u32 m0, s76, 114688
    s_mul_i32 s74, s72, 229376
    buffer_load_dwordx4 v3, s[36:39], s74 offen lds
    s_add_u32 m0, s76, 122880
    s_add_u32 s72, s72, 1
    buffer_load_dwordx4 v3, s[40:43], s74 offen lds
    s_add_u32 m0, s76, 57344
    s_and_b32 s72, s72, 7
    buffer_load_dwordx4 v2, s[32:35], s73 offen lds
    s_waitcnt lgkmcnt(0)
    v_mfma_f32_16x16x32_bf16 v[64:67], v[32:35], v[144:147], v[64:67]
    ds_read_b128 v[152:155], v7 offset:16384
    ds_read_b128 v[156:159], v8 offset:16384
    v_mfma_f32_16x16x32_bf16 v[96:99], v[100:103], v[128:131], 0
    ds_read_b64_tr_b16 v[48:49], v9 offset:20480
    v_mfma_f32_16x16x32_bf16 v[68:71], v[32:35], v[148:151], v[68:71]
    ds_read_b64_tr_b16 v[50:51], v9 offset:20992
    v_mfma_f32_16x16x32_bf16 v[72:75], v[36:39], v[144:147], v[72:75]
    ds_read_b64_tr_b16 v[52:53], v9 offset:28672
    ds_read_b64_tr_b16 v[54:55], v9 offset:29184
    v_mfma_f32_16x16x32_bf16 v[76:79], v[36:39], v[148:151], v[76:79]
    ds_read_b64_tr_b16 v[56:57], v10 offset:20480
    v_mfma_f32_16x16x32_bf16 v[80:83], v[40:43], v[144:147], v[80:83]
    ds_read_b64_tr_b16 v[58:59], v10 offset:20992
    v_mfma_f32_16x16x32_bf16 v[96:99], v[104:107], v[136:139], v[96:99]
    ds_read_b64_tr_b16 v[60:61], v10 offset:28672
    ds_read_b64_tr_b16 v[62:63], v10 offset:29184
    v_mfma_f32_16x16x32_bf16 v[84:87], v[40:43], v[148:151], v[84:87]
    ds_read_b128 v[108:111], v12 offset:128
    v_mfma_f32_16x16x32_bf16 v[88:91], v[44:47], v[144:147], v[88:91]
    ds_read_b128 v[112:115], v12 offset:192
    v_mfma_f32_16x16x32_bf16 v[92:95], v[44:47], v[148:151], v[92:95]
    s_waitcnt vmcnt(4)
    s_setprio 3
    s_barrier
    s_add_u32 m0, s76, 0
    s_lshl_b32 s73, s72, 7
    buffer_load_dwordx4 v1, s[32:35], s73 offen lds
    s_waitcnt lgkmcnt(0)
    v_mfma_f32_16x16x32_bf16 v[64:67], v[48:51], v[152:155], v[64:67]
    ds_read_b128 v[160:163], v5 offset:32768
    ds_read_b128 v[164:167], v6 offset:32768
    v_mfma_f32_16x16x32_bf16 v[96:99], v[108:111], v[144:147], v[96:99]
    ds_read_b64_tr_b16 v[32:33], v9 offset:32768
    v_mfma_f32_16x16x32_bf16 v[68:71], v[48:51], v[156:159], v[68:71]
    ds_read_b64_tr_b16 v[34:35], v9 offset:33280
    v_mfma_f32_16x16x32_bf16 v[72:75], v[52:55], v[152:155], v[72:75]
    ds_read_b64_tr_b16 v[36:37], v9 offset:40960
    v_mfma_f32_16x16x32_bf16 v[76:79], v[52:55], v[156:159], v[76:79]
    ds_read_b64_tr_b16 v[38:39], v9 offset:41472
    ds_read_b64_tr_b16 v[40:41], v10 offset:32768
    v_mfma_f32_16x16x32_bf16 v[80:83], v[56:59], v[152:155], v[80:83]
    ds_read_b64_tr_b16 v[42:43], v10 offset:33280
    v_mfma_f32_16x16x32_bf16 v[96:99], v[112:115], v[152:155], v[96:99]
    ds_read_b64_tr_b16 v[44:45], v10 offset:40960
    v_mfma_f32_16x16x32_bf16 v[84:87], v[56:59], v[156:159], v[84:87]
    ds_read_b64_tr_b16 v[46:47], v10 offset:41472
    v_mfma_f32_16x16x32_bf16 v[88:91], v[60:63], v[152:155], v[88:91]
    ds_read_b128 v[100:103], v12 offset:256
    v_mfma_f32_16x16x32_bf16 v[92:95], v[60:63], v[156:159], v[92:95]
    s_setprio 2
    s_add_u32 m0, s76, 65536
    s_mul_i32 s74, s72, 229376
    buffer_load_dwordx4 v3, s[36:39], s74 offen lds
    s_add_u32 m0, s76, 73728
    s_add_u32 s72, s72, 1
    buffer_load_dwordx4 v3, s[40:43], s74 offen lds
    s_add_u32 m0, s76, 8192
    s_and_b32 s72, s72, 7
    buffer_load_dwordx4 v2, s[32:35], s73 offen lds
    s_waitcnt lgkmcnt(0)
    v_mfma_f32_16x16x32_bf16 v[64:67], v[32:35], v[160:163], v[64:67]
    ds_read_b128 v[168:171], v7 offset:32768
    ds_read_b128 v[172:175], v8 offset:32768
    v_mfma_f32_16x16x32_bf16 v[96:99], v[100:103], v[160:163], v[96:99]
    ds_read_b64_tr_b16 v[48:49], v9 offset:36864
    v_mfma_f32_16x16x32_bf16 v[68:71], v[32:35], v[164:167], v[68:71]
    ds_read_b64_tr_b16 v[50:51], v9 offset:37376
    ds_read_b64_tr_b16 v[52:53], v9 offset:45056
    v_mfma_f32_16x16x32_bf16 v[72:75], v[36:39], v[160:163], v[72:75]
    ds_read_b64_tr_b16 v[54:55], v9 offset:45568
    v_mfma_f32_16x16x32_bf16 v[76:79], v[36:39], v[164:167], v[76:79]
    ds_read_b64_tr_b16 v[56:57], v10 offset:36864
    v_mfma_f32_16x16x32_bf16 v[80:83], v[40:43], v[160:163], v[80:83]
    ds_read_b64_tr_b16 v[58:59], v10 offset:37376
    ds_read_b64_tr_b16 v[60:61], v10 offset:45056
    v_mfma_f32_16x16x32_bf16 v[84:87], v[40:43], v[164:167], v[84:87]
    ds_read_b64_tr_b16 v[62:63], v10 offset:45568
    v_mfma_f32_16x16x32_bf16 v[88:91], v[44:47], v[160:163], v[88:91]
    ds_read_b128 v[108:111], v12 offset:320
    v_mfma_f32_16x16x32_bf16 v[92:95], v[44:47], v[164:167], v[92:95]
    s_waitcnt vmcnt(4)
    s_setprio 3
    s_barrier
    s_add_u32 m0, s76, 16384
    s_lshl_b32 s73, s72, 7
    buffer_load_dwordx4 v1, s[32:35], s73 offen lds
    s_waitcnt lgkmcnt(0)
    v_mfma_f32_16x16x32_bf16 v[64:67], v[48:51], v[168:171], v[64:67]
    ds_read_b128 v[176:179], v5 offset:49152
    ds_read_b128 v[180:183], v6 offset:49152
    v_mfma_f32_16x16x32_bf16 v[96:99], v[108:111], v[168:171], v[96:99]
    ds_read_b64_tr_b16 v[32:33], v9 offset:49152
    v_mfma_f32_16x16x32_bf16 v[68:71], v[48:51], v[172:175], v[68:71]
    ds_read_b64_tr_b16 v[34:35], v9 offset:49664
    ds_read_b64_tr_b16 v[36:37], v9 offset:57344
    v_mfma_f32_16x16x32_bf16 v[72:75], v[52:55], v[168:171], v[72:75]
    ds_read_b64_tr_b16 v[38:39], v9 offset:57856
    v_mfma_f32_16x16x32_bf16 v[76:79], v[52:55], v[172:175], v[76:79]
    ds_read_b64_tr_b16 v[40:41], v10 offset:49152
    v_mfma_f32_16x16x32_bf16 v[80:83], v[56:59], v[168:171], v[80:83]
    ds_read_b64_tr_b16 v[42:43], v10 offset:49664
    ds_read_b64_tr_b16 v[44:45], v10 offset:57344
    v_mfma_f32_16x16x32_bf16 v[84:87], v[56:59], v[172:175], v[84:87]
    ds_read_b64_tr_b16 v[46:47], v10 offset:57856
    v_mfma_f32_16x16x32_bf16 v[88:91], v[60:63], v[168:171], v[88:91]
    ds_read_b128 v[100:103], v12 offset:384
    v_mfma_f32_16x16x32_bf16 v[92:95], v[60:63], v[172:175], v[92:95]
    s_setprio 2
    s_add_u32 m0, s76, 81920
    s_mul_i32 s74, s72, 229376
    buffer_load_dwordx4 v3, s[36:39], s74 offen lds
    s_add_u32 m0, s76, 90112
    s_add_u32 s72, s72, 1
    buffer_load_dwordx4 v3, s[40:43], s74 offen lds
    s_add_u32 m0, s76, 24576
    s_and_b32 s72, s72, 7
    buffer_load_dwordx4 v2, s[32:35], s73 offen lds
    s_waitcnt lgkmcnt(0)
    v_mfma_f32_16x16x32_bf16 v[64:67], v[32:35], v[176:179], v[64:67]
    ds_read_b128 v[184:187], v7 offset:49152
    ds_read_b128 v[188:191], v8 offset:49152
    v_mfma_f32_16x16x32_bf16 v[96:99], v[100:103], v[176:179], v[96:99]
    ds_read_b64_tr_b16 v[48:49], v9 offset:53248
    v_mfma_f32_16x16x32_bf16 v[68:71], v[32:35], v[180:183], v[68:71]
    ds_read_b64_tr_b16 v[50:51], v9 offset:53760
    ds_read_b64_tr_b16 v[52:53], v9 offset:61440
    v_mfma_f32_16x16x32_bf16 v[72:75], v[36:39], v[176:179], v[72:75]
    ds_read_b64_tr_b16 v[54:55], v9 offset:61952
    v_mfma_f32_16x16x32_bf16 v[76:79], v[36:39], v[180:183], v[76:79]
    ds_read_b64_tr_b16 v[56:57], v10 offset:53248
    v_mfma_f32_16x16x32_bf16 v[80:83], v[40:43], v[176:179], v[80:83]
    ds_read_b64_tr_b16 v[58:59], v10 offset:53760
    ds_read_b64_tr_b16 v[60:61], v10 offset:61440
    v_mfma_f32_16x16x32_bf16 v[84:87], v[40:43], v[180:183], v[84:87]
    ds_read_b64_tr_b16 v[62:63], v10 offset:61952
    v_mfma_f32_16x16x32_bf16 v[88:91], v[44:47], v[176:179], v[88:91]
    ds_read_b128 v[108:111], v12 offset:448
    v_mfma_f32_16x16x32_bf16 v[92:95], v[44:47], v[180:183], v[92:95]
    s_waitcnt vmcnt(4)
    s_setprio 3
    s_barrier
    s_add_u32 m0, s76, 32768
    s_lshl_b32 s73, s72, 7
    buffer_load_dwordx4 v1, s[32:35], s73 offen lds
    s_waitcnt lgkmcnt(0)
    v_mfma_f32_16x16x32_bf16 v[64:67], v[48:51], v[184:187], v[64:67]
    ds_read_b128 v[192:195], v5 offset:0
    ds_read_b128 v[196:199], v6 offset:0
    v_mfma_f32_16x16x32_bf16 v[96:99], v[108:111], v[184:187], v[96:99]
    ds_read_b64_tr_b16 v[32:33], v9 offset:0
    v_mfma_f32_16x16x32_bf16 v[68:71], v[48:51], v[188:191], v[68:71]
    ds_read_b64_tr_b16 v[34:35], v9 offset:512
    ds_read_b64_tr_b16 v[36:37], v9 offset:8192
    v_mfma_f32_16x16x32_bf16 v[72:75], v[52:55], v[184:187], v[72:75]
    ds_read_b64_tr_b16 v[38:39], v9 offset:8704
    v_mfma_f32_16x16x32_bf16 v[76:79], v[52:55], v[188:191], v[76:79]
    ds_read_b64_tr_b16 v[40:41], v10 offset:0
    v_mfma_f32_16x16x32_bf16 v[80:83], v[56:59], v[184:187], v[80:83]
    ds_read_b64_tr_b16 v[42:43], v10 offset:512
    ds_read_b64_tr_b16 v[44:45], v10 offset:8192
    v_mfma_f32_16x16x32_bf16 v[84:87], v[56:59], v[188:191], v[84:87]
    ds_read_b64_tr_b16 v[46:47], v10 offset:8704
    v_mfma_f32_16x16x32_bf16 v[88:91], v[60:63], v[184:187], v[88:91]
    ds_read_b128 v[100:103], v12 offset:512
    v_mfma_f32_16x16x32_bf16 v[92:95], v[60:63], v[188:191], v[92:95]
    s_setprio 2
    s_add_u32 m0, s76, 98304
    s_mul_i32 s74, s72, 229376
    buffer_load_dwordx4 v3, s[36:39], s74 offen lds
    s_add_u32 m0, s76, 106496
    s_add_u32 s72, s72, 1
    buffer_load_dwordx4 v3, s[40:43], s74 offen lds
    s_add_u32 m0, s76, 40960
    s_and_b32 s72, s72, 7
    buffer_load_dwordx4 v2, s[32:35], s73 offen lds
    s_waitcnt lgkmcnt(0)
    v_mfma_f32_16x16x32_bf16 v[64:67], v[32:35], v[192:195], v[64:67]
    ds_read_b128 v[200:203], v7 offset:0
    ds_read_b128 v[204:207], v8 offset:0
    v_mfma_f32_16x16x32_bf16 v[96:99], v[100:103], v[192:195], v[96:99]
    ds_read_b64_tr_b16 v[48:49], v9 offset:4096
    v_mfma_f32_16x16x32_bf16 v[68:71], v[32:35], v[196:199], v[68:71]
    ds_read_b64_tr_b16 v[50:51], v9 offset:4608
    ds_read_b64_tr_b16 v[52:53], v9 offset:12288
    v_mfma_f32_16x16x32_bf16 v[72:75], v[36:39], v[192:195], v[72:75]
    ds_read_b64_tr_b16 v[54:55], v9 offset:12800
    v_mfma_f32_16x16x32_bf16 v[76:79], v[36:39], v[196:199], v[76:79]
    ds_read_b64_tr_b16 v[56:57], v10 offset:4096
    v_mfma_f32_16x16x32_bf16 v[80:83], v[40:43], v[192:195], v[80:83]
    ds_read_b64_tr_b16 v[58:59], v10 offset:4608
    ds_read_b64_tr_b16 v[60:61], v10 offset:12288
    v_mfma_f32_16x16x32_bf16 v[84:87], v[40:43], v[196:199], v[84:87]
    ds_read_b64_tr_b16 v[62:63], v10 offset:12800
    v_mfma_f32_16x16x32_bf16 v[88:91], v[44:47], v[192:195], v[88:91]
    ds_read_b128 v[108:111], v12 offset:576
    v_mfma_f32_16x16x32_bf16 v[92:95], v[44:47], v[196:199], v[92:95]
    s_waitcnt vmcnt(4)
    s_setprio 3
    s_barrier
    s_add_u32 m0, s76, 49152
    s_lshl_b32 s73, s72, 7
    buffer_load_dwordx4 v1, s[32:35], s73 offen lds
    s_waitcnt lgkmcnt(0)
    v_mfma_f32_16x16x32_bf16 v[64:67], v[48:51], v[200:203], v[64:67]
    ds_read_b128 v[208:211], v5 offset:16384
    ds_read_b128 v[212:215], v6 offset:16384
    v_mfma_f32_16x16x32_bf16 v[96:99], v[108:111], v[200:203], v[96:99]
    ds_read_b64_tr_b16 v[32:33], v9 offset:16384
    v_mfma_f32_16x16x32_bf16 v[68:71], v[48:51], v[204:207], v[68:71]
    ds_read_b64_tr_b16 v[34:35], v9 offset:16896
    ds_read_b64_tr_b16 v[36:37], v9 offset:24576
    v_mfma_f32_16x16x32_bf16 v[72:75], v[52:55], v[200:203], v[72:75]
    ds_read_b64_tr_b16 v[38:39], v9 offset:25088
    v_mfma_f32_16x16x32_bf16 v[76:79], v[52:55], v[204:207], v[76:79]
    ds_read_b64_tr_b16 v[40:41], v10 offset:16384
    v_mfma_f32_16x16x32_bf16 v[80:83], v[56:59], v[200:203], v[80:83]
    ds_read_b64_tr_b16 v[42:43], v10 offset:16896
    ds_read_b64_tr_b16 v[44:45], v10 offset:24576
    v_mfma_f32_16x16x32_bf16 v[84:87], v[56:59], v[204:207], v[84:87]
    ds_read_b64_tr_b16 v[46:47], v10 offset:25088
    v_mfma_f32_16x16x32_bf16 v[88:91], v[60:63], v[200:203], v[88:91]
    ds_read_b128 v[100:103], v12 offset:640
    v_mfma_f32_16x16x32_bf16 v[92:95], v[60:63], v[204:207], v[92:95]
    s_setprio 2
    s_add_u32 m0, s76, 114688
    s_mul_i32 s74, s72, 229376
    buffer_load_dwordx4 v3, s[36:39], s74 offen lds
    s_add_u32 m0, s76, 122880
    s_add_u32 s72, s72, 1
    buffer_load_dwordx4 v3, s[40:43], s74 offen lds
    s_add_u32 m0, s76, 57344
    s_and_b32 s72, s72, 7
    buffer_load_dwordx4 v2, s[32:35], s73 offen lds
    s_waitcnt lgkmcnt(0)
    v_mfma_f32_16x16x32_bf16 v[64:67], v[32:35], v[208:211], v[64:67]
    ds_read_b128 v[216:219], v7 offset:16384
    ds_read_b128 v[220:223], v8 offset:16384
    v_mfma_f32_16x16x32_bf16 v[96:99], v[100:103], v[208:211], v[96:99]
    ds_read_b64_tr_b16 v[48:49], v9 offset:20480
    v_mfma_f32_16x16x32_bf16 v[68:71], v[32:35], v[212:215], v[68:71]
    ds_read_b64_tr_b16 v[50:51], v9 offset:20992
    ds_read_b64_tr_b16 v[52:53], v9 offset:28672
    v_mfma_f32_16x16x32_bf16 v[72:75], v[36:39], v[208:211], v[72:75]
    ds_read_b64_tr_b16 v[54:55], v9 offset:29184
    v_mfma_f32_16x16x32_bf16 v[76:79], v[36:39], v[212:215], v[76:79]
    ds_read_b64_tr_b16 v[56:57], v10 offset:20480
    v_mfma_f32_16x16x32_bf16 v[80:83], v[40:43], v[208:211], v[80:83]
    ds_read_b64_tr_b16 v[58:59], v10 offset:20992
    ds_read_b64_tr_b16 v[60:61], v10 offset:28672
    v_mfma_f32_16x16x32_bf16 v[84:87], v[40:43], v[212:215], v[84:87]
    ds_read_b64_tr_b16 v[62:63], v10 offset:29184
    v_mfma_f32_16x16x32_bf16 v[88:91], v[44:47], v[208:211], v[88:91]
    ds_read_b128 v[108:111], v12 offset:704
    v_mfma_f32_16x16x32_bf16 v[92:95], v[44:47], v[212:215], v[92:95]
    s_waitcnt vmcnt(4)
    s_setprio 3
    s_barrier
    s_add_u32 m0, s76, 65536
    s_mul_i32 s74, s72, 229376
    buffer_load_dwordx4 v27, s[36:39], s74 offen lds
    s_waitcnt lgkmcnt(0)
    v_mfma_f32_16x16x32_bf16 v[64:67], v[48:51], v[216:219], v[64:67]
    ds_read_b128 v[224:227], v5 offset:32768
    ds_read_b128 v[228:231], v6 offset:32768
    v_mfma_f32_16x16x32_bf16 v[96:99], v[108:111], v[216:219], v[96:99]
    ds_read_b64_tr_b16 v[32:33], v9 offset:32768
    v_mfma_f32_16x16x32_bf16 v[68:71], v[48:51], v[220:223], v[68:71]
    ds_read_b64_tr_b16 v[34:35], v9 offset:33280
    ds_read_b64_tr_b16 v[36:37], v9 offset:40960
    v_mfma_f32_16x16x32_bf16 v[72:75], v[52:55], v[216:219], v[72:75]
    ds_read_b64_tr_b16 v[38:39], v9 offset:41472
    v_mfma_f32_16x16x32_bf16 v[76:79], v[52:55], v[220:223], v[76:79]
    ds_read_b64_tr_b16 v[40:41], v10 offset:32768
    v_mfma_f32_16x16x32_bf16 v[80:83], v[56:59], v[216:219], v[80:83]
    ds_read_b64_tr_b16 v[42:43], v10 offset:33280
    ds_read_b64_tr_b16 v[44:45], v10 offset:40960
    v_mfma_f32_16x16x32_bf16 v[84:87], v[56:59], v[220:223], v[84:87]
    ds_read_b64_tr_b16 v[46:47], v10 offset:41472
    v_mfma_f32_16x16x32_bf16 v[88:91], v[60:63], v[216:219], v[88:91]
    ds_read_b128 v[100:103], v12 offset:768
    v_mfma_f32_16x16x32_bf16 v[92:95], v[60:63], v[220:223], v[92:95]
    s_setprio 2
    s_add_u32 m0, s76, 73728
    s_add_u32 s72, s72, 1
    s_and_b32 s72, s72, 7
    buffer_load_dwordx4 v27, s[40:43], s74 offen lds
    s_add_u32 m0, s76, 0
    s_mul_i32 s74, s72, 229376
    buffer_load_dwordx4 v27, s[36:39], s74 offen lds
    s_add_u32 m0, s76, 8192
    s_add_u32 s72, s72, 1
    s_and_b32 s72, s72, 7
    buffer_load_dwordx4 v27, s[40:43], s74 offen lds
    s_waitcnt lgkmcnt(0)
    v_mfma_f32_16x16x32_bf16 v[64:67], v[32:35], v[224:227], v[64:67]
    ds_read_b128 v[232:235], v7 offset:32768
    ds_read_b128 v[236:239], v8 offset:32768
    v_mfma_f32_16x16x32_bf16 v[96:99], v[100:103], v[224:227], v[96:99]
    ds_read_b64_tr_b16 v[48:49], v9 offset:36864
    v_mfma_f32_16x16x32_bf16 v[68:71], v[32:35], v[228:231], v[68:71]
    ds_read_b64_tr_b16 v[50:51], v9 offset:37376
    ds_read_b64_tr_b16 v[52:53], v9 offset:45056
    v_mfma_f32_16x16x32_bf16 v[72:75], v[36:39], v[224:227], v[72:75]
    ds_read_b64_tr_b16 v[54:55], v9 offset:45568
    v_mfma_f32_16x16x32_bf16 v[76:79], v[36:39], v[228:231], v[76:79]
    ds_read_b64_tr_b16 v[56:57], v10 offset:36864
    v_mfma_f32_16x16x32_bf16 v[80:83], v[40:43], v[224:227], v[80:83]
    ds_read_b64_tr_b16 v[58:59], v10 offset:37376
    ds_read_b64_tr_b16 v[60:61], v10 offset:45056
    v_mfma_f32_16x16x32_bf16 v[84:87], v[40:43], v[228:231], v[84:87]
    ds_read_b64_tr_b16 v[62:63], v10 offset:45568
    v_mfma_f32_16x16x32_bf16 v[88:91], v[44:47], v[224:227], v[88:91]
    ds_read_b128 v[108:111], v12 offset:832
    v_mfma_f32_16x16x32_bf16 v[92:95], v[44:47], v[228:231], v[92:95]
    s_waitcnt vmcnt(4)
    s_setprio 3
    s_barrier
    s_add_u32 m0, s76, 81920
    s_mul_i32 s74, s72, 229376
    buffer_load_dwordx4 v27, s[36:39], s74 offen lds
    s_waitcnt lgkmcnt(0)
    v_mfma_f32_16x16x32_bf16 v[64:67], v[48:51], v[232:235], v[64:67]
    ds_read_b128 v[240:243], v5 offset:49152
    ds_read_b128 v[244:247], v6 offset:49152
    v_mfma_f32_16x16x32_bf16 v[96:99], v[108:111], v[232:235], v[96:99]
    ds_read_b64_tr_b16 v[32:33], v9 offset:49152
    v_mfma_f32_16x16x32_bf16 v[68:71], v[48:51], v[236:239], v[68:71]
    ds_read_b64_tr_b16 v[34:35], v9 offset:49664
    ds_read_b64_tr_b16 v[36:37], v9 offset:57344
    v_mfma_f32_16x16x32_bf16 v[72:75], v[52:55], v[232:235], v[72:75]
    ds_read_b64_tr_b16 v[38:39], v9 offset:57856
    v_mfma_f32_16x16x32_bf16 v[76:79], v[52:55], v[236:239], v[76:79]
    ds_read_b64_tr_b16 v[40:41], v10 offset:49152
    ds_read_b64_tr_b16 v[42:43], v10 offset:49664
    v_mfma_f32_16x16x32_bf16 v[80:83], v[56:59], v[232:235], v[80:83]
    ds_read_b64_tr_b16 v[44:45], v10 offset:57344
    v_mfma_f32_16x16x32_bf16 v[84:87], v[56:59], v[236:239], v[84:87]
    ds_read_b64_tr_b16 v[46:47], v10 offset:57856
    ds_read_b128 v[100:103], v12 offset:896
    v_mfma_f32_16x16x32_bf16 v[88:91], v[60:63], v[232:235], v[88:91]
    ds_read_b128 v[116:119], v12 offset:960
    v_mfma_f32_16x16x32_bf16 v[92:95], v[60:63], v[236:239], v[92:95]
    s_setprio 2
    s_add_u32 m0, s76, 90112
    s_add_u32 s72, s72, 1
    s_and_b32 s72, s72, 7
    buffer_load_dwordx4 v27, s[40:43], s74 offen lds
    s_add_u32 m0, s76, 16384
    s_mul_i32 s74, s72, 229376
    buffer_load_dwordx4 v27, s[36:39], s74 offen lds
    s_add_u32 m0, s76, 24576
    s_add_u32 s72, s72, 1
    s_and_b32 s72, s72, 7
    buffer_load_dwordx4 v27, s[40:43], s74 offen lds
    s_waitcnt lgkmcnt(0)
    v_mfma_f32_16x16x32_bf16 v[64:67], v[32:35], v[240:243], v[64:67]
    ds_read_b128 v[248:251], v7 offset:49152
    ds_read_b128 v[252:255], v8 offset:49152
    v_mfma_f32_16x16x32_bf16 v[96:99], v[100:103], v[240:243], v[96:99]
    ds_read_b64_tr_b16 v[48:49], v9 offset:53248
    v_mfma_f32_16x16x32_bf16 v[68:71], v[32:35], v[244:247], v[68:71]
    ds_read_b64_tr_b16 v[50:51], v9 offset:53760
    v_mfma_f32_16x16x32_bf16 v[72:75], v[36:39], v[240:243], v[72:75]
    ds_read_b64_tr_b16 v[52:53], v9 offset:61440
    v_mfma_f32_16x16x32_bf16 v[76:79], v[36:39], v[244:247], v[76:79]
    ds_read_b64_tr_b16 v[54:55], v9 offset:61952
    ds_read_b64_tr_b16 v[56:57], v10 offset:53248
    v_mfma_f32_16x16x32_bf16 v[80:83], v[40:43], v[240:243], v[80:83]
    ds_read_b64_tr_b16 v[58:59], v10 offset:53760
    v_mfma_f32_16x16x32_bf16 v[84:87], v[40:43], v[244:247], v[84:87]
    ds_read_b64_tr_b16 v[60:61], v10 offset:61440
    v_mfma_f32_16x16x32_bf16 v[88:91], v[44:47], v[240:243], v[88:91]
    ds_read_b64_tr_b16 v[62:63], v10 offset:61952
    v_mfma_f32_16x16x32_bf16 v[92:95], v[44:47], v[244:247], v[92:95]
    s_setprio 1
    v_subrev_u32 v5, 65536, v9
    v_subrev_u32 v6, 65536, v10
    v_add_u32 v7, 65536, v9
    v_add_u32 v8, 65536, v10
    s_waitcnt lgkmcnt(0)
    v_mfma_f32_16x16x32_bf16 v[64:67], v[48:51], v[248:251], v[64:67]
    v_mfma_f32_16x16x32_bf16 v[96:99], v[116:119], v[248:251], v[96:99]
    v_mfma_f32_16x16x32_bf16 v[68:71], v[48:51], v[252:255], v[68:71]
    v_mfma_f32_16x16x32_bf16 v[72:75], v[52:55], v[248:251], v[72:75]
    v_mfma_f32_16x16x32_bf16 v[76:79], v[52:55], v[252:255], v[76:79]
    v_mfma_f32_16x16x32_bf16 v[80:83], v[56:59], v[248:251], v[80:83]
    v_mfma_f32_16x16x32_bf16 v[84:87], v[56:59], v[252:255], v[84:87]
    v_mfma_f32_16x16x32_bf16 v[88:91], v[60:63], v[248:251], v[88:91]
    v_mfma_f32_16x16x32_bf16 v[92:95], v[60:63], v[252:255], v[92:95]
    s_setprio 0
    v_mul_f32 v18, v64, v64
    v_mul_f32 v19, v65, v65
    v_fma_f32 v18, v18, s96, v16
    v_fma_f32 v19, v19, s96, v16
    v_mul_f32 v18, v18, v64
    v_mul_f32 v19, v19, v65
    v_exp_f32 v18, v18
    v_exp_f32 v19, v19
    v_mul_f32 v64, v64, v72
    v_add_f32 v18, 1.0, v18
    v_add_f32 v19, 1.0, v19
    v_rcp_f32 v18, v18
    v_rcp_f32 v19, v19
    v_mul_f32 v65, v65, v73
    v_mul_f32 v64, v64, v18
    v_mul_f32 v65, v65, v19
    v_cvt_pk_bf16_f32 v64, v64, v65
    v_mul_f32 v22, 0xbfb8aa3b, v96
    v_exp_f32 v22, v22
    s_nop 0
    v_add_f32 v22, 1.0, v22
    v_rcp_f32 v22, v22
    s_nop 0
    buffer_store_dword v22, v30, s[52:55], s90 offen sc1
    s_waitcnt vmcnt(5)
    s_setprio 3
    s_barrier
    ds_read_b64_tr_b16 v[32:33], v9 offset:0
    ds_read_b64_tr_b16 v[34:35], v9 offset:512
    ds_read_b64_tr_b16 v[36:37], v9 offset:4096
    ds_read_b64_tr_b16 v[38:39], v9 offset:4608
    ds_read_b64_tr_b16 v[40:41], v5 offset:0
    ds_read_b64_tr_b16 v[42:43], v5 offset:512
    ds_read_b64_tr_b16 v[44:45], v5 offset:4096
    ds_read_b64_tr_b16 v[46:47], v5 offset:4608
    s_add_u32 m0, s76, 98304
    s_mul_i32 s74, s72, 229376
    buffer_load_dwordx4 v27, s[36:39], s74 offen lds
    s_add_u32 m0, s76, 106496
    s_add_u32 s72, s72, 1
    s_and_b32 s72, s72, 7
    buffer_load_dwordx4 v27, s[40:43], s74 offen lds
    v_mul_f32 v18, v66, v66
    v_mul_f32 v19, v67, v67
    v_fma_f32 v18, v18, s96, v16
    v_fma_f32 v19, v19, s96, v16
    v_mul_f32 v18, v18, v66
    v_mul_f32 v19, v19, v67
    v_exp_f32 v18, v18
    v_exp_f32 v19, v19
    v_mul_f32 v66, v66, v74
    v_add_f32 v18, 1.0, v18
    s_waitcnt lgkmcnt(0)
    v_mfma_f32_16x16x32_bf16 v[96:99], v[32:35], v[128:131], 0
    ds_read_b64_tr_b16 v[48:49], v9 offset:8192
    ds_read_b64_tr_b16 v[50:51], v9 offset:8704
    v_mfma_f32_16x16x32_bf16 v[96:99], v[36:39], v[136:139], v[96:99]
    ds_read_b64_tr_b16 v[52:53], v9 offset:12288
    v_mfma_f32_16x16x32_bf16 v[96:99], v[40:43], v[144:147], v[96:99]
    ds_read_b64_tr_b16 v[54:55], v9 offset:12800
    v_mfma_f32_16x16x32_bf16 v[96:99], v[44:47], v[152:155], v[96:99]
    ds_read_b64_tr_b16 v[56:57], v5 offset:8192
    v_mfma_f32_16x16x32_bf16 v[100:103], v[32:35], v[132:135], 0
    ds_read_b64_tr_b16 v[58:59], v5 offset:8704
    v_mfma_f32_16x16x32_bf16 v[100:103], v[36:39], v[140:143], v[100:103]
    ds_read_b64_tr_b16 v[60:61], v5 offset:12288
    v_mfma_f32_16x16x32_bf16 v[100:103], v[40:43], v[148:151], v[100:103]
    ds_read_b64_tr_b16 v[62:63], v5 offset:12800
    v_mfma_f32_16x16x32_bf16 v[100:103], v[44:47], v[156:159], v[100:103]
    s_setprio 2
    s_add_u32 m0, s76, 32768
    s_mul_i32 s74, s72, 229376
    buffer_load_dwordx4 v27, s[36:39], s74 offen lds
    s_add_u32 m0, s76, 40960
    s_add_u32 s72, s72, 1
    s_and_b32 s72, s72, 7
    buffer_load_dwordx4 v27, s[40:43], s74 offen lds
    v_add_f32 v19, 1.0, v19
    v_rcp_f32 v18, v18
    v_rcp_f32 v19, v19
    v_mul_f32 v67, v67, v75
    v_mul_f32 v66, v66, v18
    v_mul_f32 v67, v67, v19
    v_cvt_pk_bf16_f32 v65, v66, v67
    v_mul_f32 v18, v68, v68
    v_mul_f32 v19, v69, v69
    v_fma_f32 v18, v18, s96, v16
    s_waitcnt lgkmcnt(0)
    v_mfma_f32_16x16x32_bf16 v[104:107], v[48:51], v[128:131], 0
    ds_read_b64_tr_b16 v[32:33], v10 offset:0
    ds_read_b64_tr_b16 v[34:35], v10 offset:512
    v_mfma_f32_16x16x32_bf16 v[104:107], v[52:55], v[136:139], v[104:107]
    ds_read_b64_tr_b16 v[36:37], v10 offset:4096
    v_mfma_f32_16x16x32_bf16 v[104:107], v[56:59], v[144:147], v[104:107]
    ds_read_b64_tr_b16 v[38:39], v10 offset:4608
    v_mfma_f32_16x16x32_bf16 v[104:107], v[60:63], v[152:155], v[104:107]
    ds_read_b64_tr_b16 v[40:41], v6 offset:0
    v_mfma_f32_16x16x32_bf16 v[108:111], v[48:51], v[132:135], 0
    ds_read_b64_tr_b16 v[42:43], v6 offset:512
    v_mfma_f32_16x16x32_bf16 v[108:111], v[52:55], v[140:143], v[108:111]
    ds_read_b64_tr_b16 v[44:45], v6 offset:4096
    v_mfma_f32_16x16x32_bf16 v[108:111], v[56:59], v[148:151], v[108:111]
    ds_read_b64_tr_b16 v[46:47], v6 offset:4608
    v_mfma_f32_16x16x32_bf16 v[108:111], v[60:63], v[156:159], v[108:111]
    s_setprio 1
    s_add_u32 m0, s76, 131072
    s_mul_i32 s74, s72, 229376
    buffer_load_dwordx4 v27, s[36:39], s74 offen lds
    s_add_u32 m0, s76, 139264
    s_add_u32 s72, s72, 1
    s_and_b32 s72, s72, 7
    buffer_load_dwordx4 v27, s[40:43], s74 offen lds
    s_add_u32 m0, s76, 147456
    s_mul_i32 s74, s72, 229376
    buffer_load_dwordx4 v27, s[36:39], s74 offen lds
    s_cmp_lg_u32 s68, 0
    s_cbranch_scc1 L_nos0lS
    buffer_load_dword v28, v17, s[56:59], 0 offen sc1
L_nos0lS:
    s_add_u32 m0, s76, 155648
    s_add_u32 s72, s72, 1
    s_and_b32 s72, s72, 7
    buffer_load_dwordx4 v27, s[40:43], s74 offen lds
    v_fma_f32 v19, v19, s96, v16
    v_mul_f32 v18, v18, v68
    v_mul_f32 v19, v19, v69
    v_exp_f32 v18, v18
    v_exp_f32 v19, v19
    v_mul_f32 v68, v68, v76
    v_add_f32 v18, 1.0, v18
    v_add_f32 v19, 1.0, v19
    v_rcp_f32 v18, v18
    v_rcp_f32 v19, v19
    s_waitcnt lgkmcnt(0)
    v_mfma_f32_16x16x32_bf16 v[112:115], v[32:35], v[128:131], 0
    ds_read_b64_tr_b16 v[48:49], v10 offset:8192
    ds_read_b64_tr_b16 v[50:51], v10 offset:8704
    v_mfma_f32_16x16x32_bf16 v[112:115], v[36:39], v[136:139], v[112:115]
    ds_read_b64_tr_b16 v[52:53], v10 offset:12288
    v_mfma_f32_16x16x32_bf16 v[112:115], v[40:43], v[144:147], v[112:115]
    ds_read_b64_tr_b16 v[54:55], v10 offset:12800
    v_mfma_f32_16x16x32_bf16 v[112:115], v[44:47], v[152:155], v[112:115]
    ds_read_b64_tr_b16 v[56:57], v6 offset:8192
    v_mfma_f32_16x16x32_bf16 v[116:119], v[32:35], v[132:135], 0
    ds_read_b64_tr_b16 v[58:59], v6 offset:8704
    v_mfma_f32_16x16x32_bf16 v[116:119], v[36:39], v[140:143], v[116:119]
    ds_read_b64_tr_b16 v[60:61], v6 offset:12288
    v_mfma_f32_16x16x32_bf16 v[116:119], v[40:43], v[148:151], v[116:119]
    ds_read_b64_tr_b16 v[62:63], v6 offset:12800
    v_mfma_f32_16x16x32_bf16 v[116:119], v[44:47], v[156:159], v[116:119]
    s_waitcnt vmcnt(9)
    s_setprio 3
    s_barrier
    s_waitcnt lgkmcnt(0)
    v_mfma_f32_16x16x32_bf16 v[120:123], v[48:51], v[128:131], 0
    ds_read_b64_tr_b16 v[32:33], v9 offset:16384
    ds_read_b64_tr_b16 v[34:35], v9 offset:16896
    v_mfma_f32_16x16x32_bf16 v[120:123], v[52:55], v[136:139], v[120:123]
    ds_read_b64_tr_b16 v[36:37], v9 offset:20480
    v_mfma_f32_16x16x32_bf16 v[120:123], v[56:59], v[144:147], v[120:123]
    ds_read_b64_tr_b16 v[38:39], v9 offset:20992
    v_mfma_f32_16x16x32_bf16 v[120:123], v[60:63], v[152:155], v[120:123]
    ds_read_b64_tr_b16 v[40:41], v5 offset:16384
    v_mfma_f32_16x16x32_bf16 v[124:127], v[48:51], v[132:135], 0
    ds_read_b64_tr_b16 v[42:43], v5 offset:16896
    v_mfma_f32_16x16x32_bf16 v[124:127], v[52:55], v[140:143], v[124:127]
    ds_read_b64_tr_b16 v[44:45], v5 offset:20480
    v_mfma_f32_16x16x32_bf16 v[124:127], v[56:59], v[148:151], v[124:127]
    ds_read_b64_tr_b16 v[46:47], v5 offset:20992
    v_mfma_f32_16x16x32_bf16 v[124:127], v[60:63], v[156:159], v[124:127]
    s_setprio 2
    v_mul_f32 v69, v69, v77
    v_mul_f32 v68, v68, v18
    v_mul_f32 v69, v69, v19
    v_cvt_pk_bf16_f32 v66, v68, v69
    v_mul_f32 v18, v70, v70
    v_mul_f32 v19, v71, v71
    v_fma_f32 v18, v18, s96, v16
    v_fma_f32 v19, v19, s96, v16
    v_mul_f32 v18, v18, v70
    v_mul_f32 v19, v19, v71
    v_exp_f32 v18, v18
    v_and_b32 v152, 31, v15
    v_lshlrev_b32 v152, 2, v152
    v_mov_b32 v154, 0xdddddddd
    v_mov_b32 v141, 0x3f803f80
    s_waitcnt lgkmcnt(0)
    v_mfma_f32_16x16x32_bf16 v[96:99], v[32:35], v[160:163], v[96:99]
    ds_read_b64_tr_b16 v[48:49], v9 offset:24576
    ds_read_b64_tr_b16 v[50:51], v9 offset:25088
    v_mfma_f32_16x16x32_bf16 v[96:99], v[36:39], v[168:171], v[96:99]
    ds_read_b64_tr_b16 v[52:53], v9 offset:28672
    v_mfma_f32_16x16x32_bf16 v[96:99], v[40:43], v[176:179], v[96:99]
    ds_read_b64_tr_b16 v[54:55], v9 offset:29184
    v_mfma_f32_16x16x32_bf16 v[96:99], v[44:47], v[184:187], v[96:99]
    ds_read_b64_tr_b16 v[56:57], v5 offset:24576
    v_mfma_f32_16x16x32_bf16 v[100:103], v[44:47], v[188:191], v[100:103]
    ds_read_b64_tr_b16 v[58:59], v5 offset:25088
    v_mfma_f32_16x16x32_bf16 v[100:103], v[40:43], v[180:183], v[100:103]
    ds_read_b64_tr_b16 v[60:61], v5 offset:28672
    v_mfma_f32_16x16x32_bf16 v[100:103], v[36:39], v[172:175], v[100:103]
    ds_read_b64_tr_b16 v[62:63], v5 offset:29184
    v_mfma_f32_16x16x32_bf16 v[100:103], v[32:35], v[164:167], v[100:103]
    s_setprio 1
    v_exp_f32 v19, v19
    v_mul_f32 v70, v70, v78
    v_add_f32 v18, 1.0, v18
    v_add_f32 v19, 1.0, v19
    v_rcp_f32 v18, v18
    v_rcp_f32 v19, v19
    v_mul_f32 v71, v71, v79
    v_mul_f32 v70, v70, v18
    v_mul_f32 v71, v71, v19
    v_cvt_pk_bf16_f32 v67, v70, v71
    s_mov_b32 vcc_lo, 0x22
    s_mov_b32 vcc_hi, 0x22
    v_cndmask_b32 v140, 0, v141, vcc
    v_mov_b32 v141, v140
    v_mov_b64 v[142:143], v[140:141]
    v_mov_b64 v[144:145], v[140:141]
    s_waitcnt lgkmcnt(0)
    v_mfma_f32_16x16x32_bf16 v[104:107], v[48:51], v[160:163], v[104:107]
    ds_read_b64_tr_b16 v[32:33], v10 offset:16384
    ds_read_b64_tr_b16 v[34:35], v10 offset:16896
    v_mfma_f32_16x16x32_bf16 v[104:107], v[52:55], v[168:171], v[104:107]
    ds_read_b64_tr_b16 v[36:37], v10 offset:20480
    v_mfma_f32_16x16x32_bf16 v[104:107], v[56:59], v[176:179], v[104:107]
    ds_read_b64_tr_b16 v[38:39], v10 offset:20992
    v_mfma_f32_16x16x32_bf16 v[104:107], v[60:63], v[184:187], v[104:107]
    ds_read_b64_tr_b16 v[40:41], v6 offset:16384
    v_mfma_f32_16x16x32_bf16 v[108:111], v[60:63], v[188:191], v[108:111]
    ds_read_b64_tr_b16 v[42:43], v6 offset:16896
    v_mfma_f32_16x16x32_bf16 v[108:111], v[56:59], v[180:183], v[108:111]
    ds_read_b64_tr_b16 v[44:45], v6 offset:20480
    v_mfma_f32_16x16x32_bf16 v[108:111], v[52:55], v[172:175], v[108:111]
    ds_read_b64_tr_b16 v[46:47], v6 offset:20992
    v_mfma_f32_16x16x32_bf16 v[108:111], v[48:51], v[164:167], v[108:111]
    s_setprio 0
    v_permlane16_swap_b32 v64, v66
    v_permlane16_swap_b32 v65, v67
    v_mul_f32 v18, v80, v80
    v_mul_f32 v19, v81, v81
    v_fma_f32 v18, v18, s96, v16
    v_fma_f32 v19, v19, s96, v16
    v_mul_f32 v18, v18, v80
    v_mul_f32 v19, v19, v81
    v_exp_f32 v18, v18
    v_exp_f32 v19, v19
    v_mov_b64 v[146:147], v[140:141]
    v_mov_b64 v[148:149], v[140:141]
    v_mov_b64 v[150:151], v[140:141]
    s_waitcnt lgkmcnt(0)
    v_mfma_f32_16x16x32_bf16 v[112:115], v[32:35], v[160:163], v[112:115]
    ds_read_b64_tr_b16 v[48:49], v10 offset:24576
    ds_read_b64_tr_b16 v[50:51], v10 offset:25088
    v_mfma_f32_16x16x32_bf16 v[112:115], v[36:39], v[168:171], v[112:115]
    ds_read_b64_tr_b16 v[52:53], v10 offset:28672
    v_mfma_f32_16x16x32_bf16 v[112:115], v[40:43], v[176:179], v[112:115]
    ds_read_b64_tr_b16 v[54:55], v10 offset:29184
    v_mfma_f32_16x16x32_bf16 v[112:115], v[44:47], v[184:187], v[112:115]
    ds_read_b64_tr_b16 v[56:57], v6 offset:24576
    v_mfma_f32_16x16x32_bf16 v[116:119], v[44:47], v[188:191], v[116:119]
    ds_read_b64_tr_b16 v[58:59], v6 offset:25088
    v_mfma_f32_16x16x32_bf16 v[116:119], v[40:43], v[180:183], v[116:119]
    ds_read_b64_tr_b16 v[60:61], v6 offset:28672
    v_mfma_f32_16x16x32_bf16 v[116:119], v[36:39], v[172:175], v[116:119]
    ds_read_b64_tr_b16 v[62:63], v6 offset:29184
    v_mfma_f32_16x16x32_bf16 v[116:119], v[32:35], v[164:167], v[116:119]
    s_waitcnt vmcnt(0)
    s_setprio 3
    s_barrier
    s_waitcnt lgkmcnt(0)
    v_mfma_f32_16x16x32_bf16 v[120:123], v[48:51], v[160:163], v[120:123]
    ds_read_b64_tr_b16 v[32:33], v9 offset:32768
    ds_read_b64_tr_b16 v[34:35], v9 offset:33280
    v_mfma_f32_16x16x32_bf16 v[120:123], v[52:55], v[168:171], v[120:123]
    ds_read_b64_tr_b16 v[36:37], v9 offset:36864
    v_mfma_f32_16x16x32_bf16 v[120:123], v[56:59], v[176:179], v[120:123]
    ds_read_b64_tr_b16 v[38:39], v9 offset:37376
    v_mfma_f32_16x16x32_bf16 v[120:123], v[60:63], v[184:187], v[120:123]
    ds_read_b64_tr_b16 v[40:41], v5 offset:32768
    v_mfma_f32_16x16x32_bf16 v[124:127], v[60:63], v[188:191], v[124:127]
    ds_read_b64_tr_b16 v[42:43], v5 offset:33280
    v_mfma_f32_16x16x32_bf16 v[124:127], v[56:59], v[180:183], v[124:127]
    ds_read_b64_tr_b16 v[44:45], v5 offset:36864
    v_mfma_f32_16x16x32_bf16 v[124:127], v[52:55], v[172:175], v[124:127]
    ds_read_b64_tr_b16 v[46:47], v5 offset:37376
    v_mfma_f32_16x16x32_bf16 v[124:127], v[48:51], v[164:167], v[124:127]
    s_setprio 2
    v_mul_f32 v80, v80, v88
    v_add_f32 v18, 1.0, v18
    v_add_f32 v19, 1.0, v19
    v_rcp_f32 v18, v18
    v_rcp_f32 v19, v19
    v_mul_f32 v81, v81, v89
    v_mul_f32 v80, v80, v18
    v_mul_f32 v81, v81, v19
    v_cvt_pk_bf16_f32 v80, v80, v81
    v_mul_f32 v18, v82, v82
    s_add_u32 s82, s0, 0
    buffer_store_dwordx4 v[64:67], v4, s[52:55], s82 offen sc1
    v_add_u32 v159, s100, v31
    v_xor_b32 v160, 64, v159
    v_add_u32 v158, 7168, v0
    v_add_u32 v161, s89, v14
    v_xor_b32 v162, 0x400, v161
    s_waitcnt lgkmcnt(0)
    v_mfma_f32_16x16x32_bf16 v[96:99], v[32:35], v[192:195], v[96:99]
    ds_read_b64_tr_b16 v[48:49], v9 offset:40960
    ds_read_b64_tr_b16 v[50:51], v9 offset:41472
    v_mfma_f32_16x16x32_bf16 v[96:99], v[36:39], v[200:203], v[96:99]
    ds_read_b64_tr_b16 v[52:53], v9 offset:45056
    v_mfma_f32_16x16x32_bf16 v[96:99], v[40:43], v[208:211], v[96:99]
    ds_read_b64_tr_b16 v[54:55], v9 offset:45568
    v_mfma_f32_16x16x32_bf16 v[96:99], v[44:47], v[216:219], v[96:99]
    ds_read_b64_tr_b16 v[56:57], v5 offset:40960
    v_mfma_f32_16x16x32_bf16 v[100:103], v[44:47], v[220:223], v[100:103]
    ds_read_b64_tr_b16 v[58:59], v5 offset:41472
    v_mfma_f32_16x16x32_bf16 v[100:103], v[40:43], v[212:215], v[100:103]
    ds_read_b64_tr_b16 v[60:61], v5 offset:45056
    v_mfma_f32_16x16x32_bf16 v[100:103], v[36:39], v[204:207], v[100:103]
    ds_read_b64_tr_b16 v[62:63], v5 offset:45568
    v_mfma_f32_16x16x32_bf16 v[100:103], v[32:35], v[196:199], v[100:103]
    s_setprio 1
    v_mul_f32 v19, v83, v83
    v_fma_f32 v18, v18, s96, v16
    v_fma_f32 v19, v19, s96, v16
    v_mul_f32 v18, v18, v82
    v_mul_f32 v19, v19, v83
    v_exp_f32 v18, v18
    v_exp_f32 v19, v19
    v_mul_f32 v82, v82, v90
    v_add_f32 v18, 1.0, v18
    v_add_f32 v19, 1.0, v19
    v_rcp_f32 v18, v18
    v_lshlrev_b32 v163, 7, v15
    v_mov_b32 v168, 1
    v_lshl_add_u32 v171, v15, 2, s86
    v_lshl_add_u32 v172, v15, 2, s87
    s_waitcnt lgkmcnt(0)
    v_mfma_f32_16x16x32_bf16 v[104:107], v[48:51], v[192:195], v[104:107]
    ds_read_b64_tr_b16 v[32:33], v10 offset:32768
    ds_read_b64_tr_b16 v[34:35], v10 offset:33280
    v_mfma_f32_16x16x32_bf16 v[104:107], v[52:55], v[200:203], v[104:107]
    ds_read_b64_tr_b16 v[36:37], v10 offset:36864
    v_mfma_f32_16x16x32_bf16 v[104:107], v[56:59], v[208:211], v[104:107]
    ds_read_b64_tr_b16 v[38:39], v10 offset:37376
    v_mfma_f32_16x16x32_bf16 v[104:107], v[60:63], v[216:219], v[104:107]
    ds_read_b64_tr_b16 v[40:41], v6 offset:32768
    v_mfma_f32_16x16x32_bf16 v[108:111], v[60:63], v[220:223], v[108:111]
    ds_read_b64_tr_b16 v[42:43], v6 offset:33280
    v_mfma_f32_16x16x32_bf16 v[108:111], v[56:59], v[212:215], v[108:111]
    ds_read_b64_tr_b16 v[44:45], v6 offset:36864
    v_mfma_f32_16x16x32_bf16 v[108:111], v[52:55], v[204:207], v[108:111]
    ds_read_b64_tr_b16 v[46:47], v6 offset:37376
    v_mfma_f32_16x16x32_bf16 v[108:111], v[48:51], v[196:199], v[108:111]
    s_setprio 0
    v_rcp_f32 v19, v19
    v_mul_f32 v83, v83, v91
    v_mul_f32 v82, v82, v18
    v_mul_f32 v83, v83, v19
    v_cvt_pk_bf16_f32 v81, v82, v83
    v_mul_f32 v18, v84, v84
    v_mul_f32 v19, v85, v85
    v_fma_f32 v18, v18, s96, v16
    v_fma_f32 v19, v19, s96, v16
    v_mul_f32 v18, v18, v84
    v_mov_b64 v[176:177], 0
    v_mov_b64 v[178:179], 0
    v_mov_b64 v[180:181], 0
    v_mov_b64 v[182:183], 0
    s_waitcnt lgkmcnt(0)
    v_mfma_f32_16x16x32_bf16 v[112:115], v[32:35], v[192:195], v[112:115]
    ds_read_b64_tr_b16 v[48:49], v10 offset:40960
    ds_read_b64_tr_b16 v[50:51], v10 offset:41472
    v_mfma_f32_16x16x32_bf16 v[112:115], v[36:39], v[200:203], v[112:115]
    ds_read_b64_tr_b16 v[52:53], v10 offset:45056
    v_mfma_f32_16x16x32_bf16 v[112:115], v[40:43], v[208:211], v[112:115]
    ds_read_b64_tr_b16 v[54:55], v10 offset:45568
    v_mfma_f32_16x16x32_bf16 v[112:115], v[44:47], v[216:219], v[112:115]
    ds_read_b64_tr_b16 v[56:57], v6 offset:40960
    v_mfma_f32_16x16x32_bf16 v[116:119], v[44:47], v[220:223], v[116:119]
    ds_read_b64_tr_b16 v[58:59], v6 offset:41472
    v_mfma_f32_16x16x32_bf16 v[116:119], v[40:43], v[212:215], v[116:119]
    ds_read_b64_tr_b16 v[60:61], v6 offset:45056
    v_mfma_f32_16x16x32_bf16 v[116:119], v[36:39], v[204:207], v[116:119]
    ds_read_b64_tr_b16 v[62:63], v6 offset:45568
    v_mfma_f32_16x16x32_bf16 v[116:119], v[32:35], v[196:199], v[116:119]
    s_setprio 3
    s_barrier
    s_waitcnt lgkmcnt(0)
    v_mfma_f32_16x16x32_bf16 v[120:123], v[48:51], v[192:195], v[120:123]
    ds_read_b64_tr_b16 v[32:33], v7 offset:0
    ds_read_b64_tr_b16 v[34:35], v7 offset:512
    v_mfma_f32_16x16x32_bf16 v[120:123], v[52:55], v[200:203], v[120:123]
    ds_read_b64_tr_b16 v[36:37], v7 offset:4096
    v_mfma_f32_16x16x32_bf16 v[120:123], v[56:59], v[208:211], v[120:123]
    ds_read_b64_tr_b16 v[38:39], v7 offset:4608
    v_mfma_f32_16x16x32_bf16 v[120:123], v[60:63], v[216:219], v[120:123]
    ds_read_b64_tr_b16 v[40:41], v7 offset:16384
    v_mfma_f32_16x16x32_bf16 v[124:127], v[60:63], v[220:223], v[124:127]
    ds_read_b64_tr_b16 v[42:43], v7 offset:16896
    v_mfma_f32_16x16x32_bf16 v[124:127], v[56:59], v[212:215], v[124:127]
    ds_read_b64_tr_b16 v[44:45], v7 offset:20480
    v_mfma_f32_16x16x32_bf16 v[124:127], v[52:55], v[204:207], v[124:127]
    ds_read_b64_tr_b16 v[46:47], v7 offset:20992
    v_mfma_f32_16x16x32_bf16 v[124:127], v[48:51], v[196:199], v[124:127]
    s_setprio 2
    v_mul_f32 v19, v19, v85
    v_exp_f32 v18, v18
    v_exp_f32 v19, v19
    v_mul_f32 v84, v84, v92
    v_add_f32 v18, 1.0, v18
    v_add_f32 v19, 1.0, v19
    v_rcp_f32 v18, v18
    v_rcp_f32 v19, v19
    v_mul_f32 v85, v85, v93
    v_mul_f32 v84, v84, v18
    v_mov_b64 v[184:185], 0
    v_mov_b64 v[186:187], 0
    v_mov_b64 v[188:189], 0
    v_mov_b64 v[190:191], 0
    s_waitcnt lgkmcnt(0)
    v_mfma_f32_16x16x32_bf16 v[96:99], v[32:35], v[224:227], v[96:99]
    ds_read_b64_tr_b16 v[48:49], v7 offset:8192
    ds_read_b64_tr_b16 v[50:51], v7 offset:8704
    v_mfma_f32_16x16x32_bf16 v[96:99], v[36:39], v[232:235], v[96:99]
    ds_read_b64_tr_b16 v[52:53], v7 offset:12288
    v_mfma_f32_16x16x32_bf16 v[96:99], v[40:43], v[240:243], v[96:99]
    ds_read_b64_tr_b16 v[54:55], v7 offset:12800
    v_mfma_f32_16x16x32_bf16 v[96:99], v[44:47], v[248:251], v[96:99]
    ds_read_b64_tr_b16 v[56:57], v7 offset:24576
    v_mfma_f32_16x16x32_bf16 v[100:103], v[44:47], v[252:255], v[100:103]
    ds_read_b64_tr_b16 v[58:59], v7 offset:25088
    v_mfma_f32_16x16x32_bf16 v[100:103], v[40:43], v[244:247], v[100:103]
    ds_read_b64_tr_b16 v[60:61], v7 offset:28672
    v_mfma_f32_16x16x32_bf16 v[100:103], v[36:39], v[236:239], v[100:103]
    ds_read_b64_tr_b16 v[62:63], v7 offset:29184
    v_mfma_f32_16x16x32_bf16 v[100:103], v[32:35], v[228:231], v[100:103]
    s_setprio 1
    v_mul_f32 v85, v85, v19
    v_cvt_pk_bf16_f32 v82, v84, v85
    v_mul_f32 v18, v86, v86
    v_mul_f32 v19, v87, v87
    v_fma_f32 v18, v18, s96, v16
    v_fma_f32 v19, v19, s96, v16
    v_mul_f32 v18, v18, v86
    v_mul_f32 v19, v19, v87
    v_exp_f32 v18, v18
    v_exp_f32 v19, v19
    v_mov_b64 v[192:193], 0
    v_mov_b64 v[194:195], 0
    v_mov_b64 v[196:197], 0
    v_mov_b64 v[198:199], 0
    s_waitcnt lgkmcnt(0)
    v_mfma_f32_16x16x32_bf16 v[104:107], v[48:51], v[224:227], v[104:107]
    ds_read_b64_tr_b16 v[32:33], v8 offset:0
    ds_read_b64_tr_b16 v[34:35], v8 offset:512
    v_mfma_f32_16x16x32_bf16 v[104:107], v[52:55], v[232:235], v[104:107]
    ds_read_b64_tr_b16 v[36:37], v8 offset:4096
    v_mfma_f32_16x16x32_bf16 v[104:107], v[56:59], v[240:243], v[104:107]
    ds_read_b64_tr_b16 v[38:39], v8 offset:4608
    v_mfma_f32_16x16x32_bf16 v[104:107], v[60:63], v[248:251], v[104:107]
    ds_read_b64_tr_b16 v[40:41], v8 offset:16384
    v_mfma_f32_16x16x32_bf16 v[108:111], v[60:63], v[252:255], v[108:111]
    ds_read_b64_tr_b16 v[42:43], v8 offset:16896
    v_mfma_f32_16x16x32_bf16 v[108:111], v[56:59], v[244:247], v[108:111]
    ds_read_b64_tr_b16 v[44:45], v8 offset:20480
    v_mfma_f32_16x16x32_bf16 v[108:111], v[52:55], v[236:239], v[108:111]
    ds_read_b64_tr_b16 v[46:47], v8 offset:20992
    v_mfma_f32_16x16x32_bf16 v[108:111], v[48:51], v[228:231], v[108:111]
    s_setprio 0
    s_cmp_lg_u32 s68, 0
    s_cbranch_scc1 L_nopoll0S
    v_cmp_eq_u32 vcc, 0, v28
    s_cbranch_vccnz L_s0retryS
L_s0doneS:
    s_mov_b32 s81, 196608
    v_lshlrev_b32 v21, 7, v15
    buffer_load_dword v20, v21, s[52:55], s81 offen sc1
L_nopoll0S:
    v_mul_f32 v86, v86, v94
    v_add_f32 v18, 1.0, v18
    v_add_f32 v19, 1.0, v19
    v_rcp_f32 v18, v18
    v_rcp_f32 v19, v19
    v_mul_f32 v87, v87, v95
    v_mul_f32 v86, v86, v18
    v_mul_f32 v87, v87, v19
    v_cvt_pk_bf16_f32 v83, v86, v87
    v_permlane16_swap_b32 v80, v82
    s_nop 0
    v_permlane16_swap_b32 v81, v83
    v_mov_b64 v[200:201], 0
    v_mov_b64 v[202:203], 0
    v_mov_b64 v[204:205], 0
    v_mov_b64 v[206:207], 0
    s_waitcnt lgkmcnt(0)
    v_mfma_f32_16x16x32_bf16 v[112:115], v[32:35], v[224:227], v[112:115]
    ds_read_b64_tr_b16 v[48:49], v8 offset:8192
    ds_read_b64_tr_b16 v[50:51], v8 offset:8704
    v_mfma_f32_16x16x32_bf16 v[112:115], v[36:39], v[232:235], v[112:115]
    ds_read_b64_tr_b16 v[52:53], v8 offset:12288
    v_mfma_f32_16x16x32_bf16 v[112:115], v[40:43], v[240:243], v[112:115]
    ds_read_b64_tr_b16 v[54:55], v8 offset:12800
    v_mfma_f32_16x16x32_bf16 v[112:115], v[44:47], v[248:251], v[112:115]
    ds_read_b64_tr_b16 v[56:57], v8 offset:24576
    v_mfma_f32_16x16x32_bf16 v[116:119], v[44:47], v[252:255], v[116:119]
    ds_read_b64_tr_b16 v[58:59], v8 offset:25088
    v_mfma_f32_16x16x32_bf16 v[116:119], v[40:43], v[244:247], v[116:119]
    ds_read_b64_tr_b16 v[60:61], v8 offset:28672
    v_mfma_f32_16x16x32_bf16 v[116:119], v[36:39], v[236:239], v[116:119]
    ds_read_b64_tr_b16 v[62:63], v8 offset:29184
    v_mfma_f32_16x16x32_bf16 v[116:119], v[32:35], v[228:231], v[116:119]
    s_waitcnt lgkmcnt(0)
    s_branch L_join
.p2align 12
.fill 112, 4, 0xbf800000
L_pathC:
    s_cmp_eq_u32 s71, 2
    s_cselect_b64 s[48:49], s[60:61], s[64:65]
    s_cselect_b32 s50, s62, s66
    s_cselect_b32 s80, 28, 8
    s_mov_b32 s51, 0x20000
    s_cmp_eq_u32 s71, 1
    s_cselect_b32 s50, 0, s50
    s_and_b32 s81, s2, 63
    s_mul_i32 s81, s81, s80
    s_sub_u32 s80, s80, 1
    v_min_u32 v11, s80, v15
    v_add_lshl_u32 v11, v11, s81, 7
    s_add_u32 m0, s76, 16384
    s_lshl_b32 s73, s72, 7
    buffer_load_dwordx4 v1, s[32:35], s73 offen lds
    s_add_u32 m0, s76, 81920
    s_mul_i32 s74, s72, 229376
    buffer_load_dwordx4 v3, s[36:39], s74 offen lds
    s_add_u32 m0, s76, 90112
    s_add_u32 s72, s72, 1
    buffer_load_dwordx4 v3, s[40:43], s74 offen lds
    s_add_u32 m0, s76, 24576
    s_and_b32 s72, s72, 7
    buffer_load_dwordx4 v2, s[32:35], s73 offen lds
    s_lshr_b32 s80, s68, 2
    s_lshl_b32 s81, s80, 16
    v_add_u32 v26, s81, v14
    s_and_b32 s81, s68, 1
    s_mul_i32 s81, s81, 49152
    v_add_u32 v24, s81, v14
    v_add_u32 v25, s81, v29
    s_mul_i32 s81, s80, 49152
    s_and_b32 s86, s68, 3
    s_lshl_b32 s87, s86, 11
    s_add_u32 s83, s87, s81
    s_lshl_b32 s87, s2, 2
    s_add_u32 s86, s86, s87
    s_and_b32 s86, s86, 31
    s_lshl_b32 s85, s86, 11
    s_add_u32 s1, s101, 3145728
    s_xor_b32 s1, s1, 1024
    s_lshl1_add_u32 s79, s77, s80
    s_lshl_b32 s79, s79, 7
    s_add_u32 s79, s79, 131072
    s_lshr_b32 s86, s77, 3
    s_lshl3_add_u32 s86, s86, s68
    s_mul_i32 s86, s86, 224
    s_and_b32 s87, s77, 7
    s_lshl1_add_u32 s87, s87, s80
    s_add_u32 s86, s86, s87
    s_lshl_b32 s86, s86, 10
    s_add_u32 s89, s86, 5242880
    s_lshr_b32 s97, s77, 1
    s_lshl_b32 s97, s97, 9
    s_add_u32 s97, s97, 204800
    s_lshl_b32 s81, s68, 24
    s_add_u32 s98, s98, s81
    s_mul_i32 s86, s68, 2304
    s_add_u32 s86, s86, 65536
    s_xor_b32 s87, s68, 1
    s_mul_i32 s87, s87, 2304
    s_add_u32 s87, s87, 65536
    v_lshlrev_b32 v20, 7, v15
    s_mov_b32 s81, 196608
    buffer_store_dword v17, v20, s[52:55], s81 offen sc1
    s_waitcnt vmcnt(5)
    s_setprio 3
    s_barrier
    s_add_u32 m0, s76, 32768
    s_lshl_b32 s73, s72, 7
    buffer_load_dwordx4 v1, s[32:35], s73 offen lds
    s_waitcnt lgkmcnt(0)
    ds_read_b128 v[128:131], v5 offset:0
    ds_read_b128 v[132:135], v6 offset:0
    ds_read_b64_tr_b16 v[32:33], v9 offset:0
    ds_read_b64_tr_b16 v[34:35], v9 offset:512
    ds_read_b64_tr_b16 v[36:37], v9 offset:8192
    ds_read_b64_tr_b16 v[38:39], v9 offset:8704
    ds_read_b64_tr_b16 v[40:41], v10 offset:0
    ds_read_b64_tr_b16 v[42:43], v10 offset:512
    ds_read_b64_tr_b16 v[44:45], v10 offset:8192
    ds_read_b64_tr_b16 v[46:47], v10 offset:8704
    s_add_u32 m0, s76, 98304
    s_mul_i32 s74, s72, 229376
    buffer_load_dwordx4 v3, s[36:39], s74 offen lds
    s_add_u32 m0, s76, 106496
    s_add_u32 s72, s72, 1
    buffer_load_dwordx4 v3, s[40:43], s74 offen lds
    s_add_u32 m0, s76, 40960
    s_and_b32 s72, s72, 7
    buffer_load_dwordx4 v2, s[32:35], s73 offen lds
    s_waitcnt lgkmcnt(0)
    v_mfma_f32_16x16x32_bf16 v[64:67], v[32:35], v[128:131], 0
    ds_read_b128 v[136:139], v7 offset:0
    ds_read_b128 v[140:143], v8 offset:0
    v_mfma_f32_16x16x32_bf16 v[68:71], v[32:35], v[132:135], 0
    ds_read_b64_tr_b16 v[48:49], v9 offset:4096
    v_mfma_f32_16x16x32_bf16 v[72:75], v[36:39], v[128:131], 0
    ds_read_b64_tr_b16 v[50:51], v9 offset:4608
    ds_read_b64_tr_b16 v[52:53], v9 offset:12288
    v_mfma_f32_16x16x32_bf16 v[76:79], v[36:39], v[132:135], 0
    ds_read_b64_tr_b16 v[54:55], v9 offset:12800
    v_mfma_f32_16x16x32_bf16 v[80:83], v[40:43], v[128:131], 0
    ds_read_b64_tr_b16 v[56:57], v10 offset:4096
    ds_read_b64_tr_b16 v[58:59], v10 offset:4608
    v_mfma_f32_16x16x32_bf16 v[84:87], v[40:43], v[132:135], 0
    ds_read_b64_tr_b16 v[60:61], v10 offset:12288
    v_mfma_f32_16x16x32_bf16 v[88:91], v[44:47], v[128:131], 0
    ds_read_b64_tr_b16 v[62:63], v10 offset:12800
    v_mfma_f32_16x16x32_bf16 v[92:95], v[44:47], v[132:135], 0
    s_waitcnt vmcnt(5)
    s_setprio 3
    s_barrier
    s_add_u32 m0, s76, 49152
    s_lshl_b32 s73, s72, 7
    buffer_load_dwordx4 v1, s[32:35], s73 offen lds
    s_waitcnt lgkmcnt(0)
    v_mfma_f32_16x16x32_bf16 v[64:67], v[48:51], v[136:139], v[64:67]
    ds_read_b128 v[144:147], v5 offset:16384
    ds_read_b128 v[148:151], v6 offset:16384
    v_mfma_f32_16x16x32_bf16 v[68:71], v[48:51], v[140:143], v[68:71]
    ds_read_b64_tr_b16 v[32:33], v9 offset:16384
    v_mfma_f32_16x16x32_bf16 v[72:75], v[52:55], v[136:139], v[72:75]
    ds_read_b64_tr_b16 v[34:35], v9 offset:16896
    ds_read_b64_tr_b16 v[36:37], v9 offset:24576
    v_mfma_f32_16x16x32_bf16 v[76:79], v[52:55], v[140:143], v[76:79]
    ds_read_b64_tr_b16 v[38:39], v9 offset:25088
    v_mfma_f32_16x16x32_bf16 v[80:83], v[56:59], v[136:139], v[80:83]
    ds_read_b64_tr_b16 v[40:41], v10 offset:16384
    ds_read_b64_tr_b16 v[42:43], v10 offset:16896
    v_mfma_f32_16x16x32_bf16 v[84:87], v[56:59], v[140:143], v[84:87]
    ds_read_b64_tr_b16 v[44:45], v10 offset:24576
    v_mfma_f32_16x16x32_bf16 v[88:91], v[60:63], v[136:139], v[88:91]
    ds_read_b64_tr_b16 v[46:47], v10 offset:25088
    v_mfma_f32_16x16x32_bf16 v[92:95], v[60:63], v[140:143], v[92:95]
    s_setprio 2
    s_add_u32 m0, s76, 114688
    s_mul_i32 s74, s72, 229376
    buffer_load_dwordx4 v3, s[36:39], s74 offen lds
    s_add_u32 m0, s76, 122880
    s_add_u32 s72, s72, 1
    buffer_load_dwordx4 v3, s[40:43], s74 offen lds
    s_add_u32 m0, s76, 57344
    s_and_b32 s72, s72, 7
    buffer_load_dwordx4 v2, s[32:35], s73 offen lds
    s_waitcnt lgkmcnt(0)
    v_mfma_f32_16x16x32_bf16 v[64:67], v[32:35], v[144:147], v[64:67]
    ds_read_b128 v[152:155], v7 offset:16384
    ds_read_b128 v[156:159], v8 offset:16384
    v_mfma_f32_16x16x32_bf16 v[68:71], v[32:35], v[148:151], v[68:71]
    ds_read_b64_tr_b16 v[48:49], v9 offset:20480
    v_mfma_f32_16x16x32_bf16 v[72:75], v[36:39], v[144:147], v[72:75]
    ds_read_b64_tr_b16 v[50:51], v9 offset:20992
    ds_read_b64_tr_b16 v[52:53], v9 offset:28672
    v_mfma_f32_16x16x32_bf16 v[76:79], v[36:39], v[148:151], v[76:79]
    ds_read_b64_tr_b16 v[54:55], v9 offset:29184
    v_mfma_f32_16x16x32_bf16 v[80:83], v[40:43], v[144:147], v[80:83]
    ds_read_b64_tr_b16 v[56:57], v10 offset:20480
    ds_read_b64_tr_b16 v[58:59], v10 offset:20992
    v_mfma_f32_16x16x32_bf16 v[84:87], v[40:43], v[148:151], v[84:87]
    ds_read_b64_tr_b16 v[60:61], v10 offset:28672
    v_mfma_f32_16x16x32_bf16 v[88:91], v[44:47], v[144:147], v[88:91]
    ds_read_b64_tr_b16 v[62:63], v10 offset:29184
    v_mfma_f32_16x16x32_bf16 v[92:95], v[44:47], v[148:151], v[92:95]
    s_waitcnt vmcnt(4)
    s_setprio 3
    s_barrier
    s_add_u32 m0, s76, 0
    s_lshl_b32 s73, s72, 7
    buffer_load_dwordx4 v1, s[32:35], s73 offen lds
    s_waitcnt lgkmcnt(0)
    v_mfma_f32_16x16x32_bf16 v[64:67], v[48:51], v[152:155], v[64:67]
    ds_read_b128 v[160:163], v5 offset:32768
    ds_read_b128 v[164:167], v6 offset:32768
    v_mfma_f32_16x16x32_bf16 v[68:71], v[48:51], v[156:159], v[68:71]
    ds_read_b64_tr_b16 v[32:33], v9 offset:32768
    v_mfma_f32_16x16x32_bf16 v[72:75], v[52:55], v[152:155], v[72:75]
    ds_read_b64_tr_b16 v[34:35], v9 offset:33280
    ds_read_b64_tr_b16 v[36:37], v9 offset:40960
    v_mfma_f32_16x16x32_bf16 v[76:79], v[52:55], v[156:159], v[76:79]
    ds_read_b64_tr_b16 v[38:39], v9 offset:41472
    v_mfma_f32_16x16x32_bf16 v[80:83], v[56:59], v[152:155], v[80:83]
    ds_read_b64_tr_b16 v[40:41], v10 offset:32768
    ds_read_b64_tr_b16 v[42:43], v10 offset:33280
    v_mfma_f32_16x16x32_bf16 v[84:87], v[56:59], v[156:159], v[84:87]
    ds_read_b64_tr_b16 v[44:45], v10 offset:40960
    v_mfma_f32_16x16x32_bf16 v[88:91], v[60:63], v[152:155], v[88:91]
    ds_read_b64_tr_b16 v[46:47], v10 offset:41472
    v_mfma_f32_16x16x32_bf16 v[92:95], v[60:63], v[156:159], v[92:95]
    s_setprio 2
    s_add_u32 m0, s76, 65536
    s_mul_i32 s74, s72, 229376
    buffer_load_dwordx4 v3, s[36:39], s74 offen lds
    s_add_u32 m0, s76, 73728
    s_add_u32 s72, s72, 1
    buffer_load_dwordx4 v3, s[40:43], s74 offen lds
    s_add_u32 m0, s76, 8192
    s_and_b32 s72, s72, 7
    buffer_load_dwordx4 v2, s[32:35], s73 offen lds
    v_mov_b32 v20, 1
    s_mov_b64 exec, 1
    buffer_store_dword v20, v17, s[56:59], 0 offen sc1
    s_mov_b64 exec, -1
    s_waitcnt lgkmcnt(0)
    v_mfma_f32_16x16x32_bf16 v[64:67], v[32:35], v[160:163], v[64:67]
    ds_read_b128 v[168:171], v7 offset:32768
    ds_read_b128 v[172:175], v8 offset:32768
    v_mfma_f32_16x16x32_bf16 v[68:71], v[32:35], v[164:167], v[68:71]
    ds_read_b64_tr_b16 v[48:49], v9 offset:36864
    v_mfma_f32_16x16x32_bf16 v[72:75], v[36:39], v[160:163], v[72:75]
    ds_read_b64_tr_b16 v[50:51], v9 offset:37376
    ds_read_b64_tr_b16 v[52:53], v9 offset:45056
    v_mfma_f32_16x16x32_bf16 v[76:79], v[36:39], v[164:167], v[76:79]
    ds_read_b64_tr_b16 v[54:55], v9 offset:45568
    v_mfma_f32_16x16x32_bf16 v[80:83], v[40:43], v[160:163], v[80:83]
    ds_read_b64_tr_b16 v[56:57], v10 offset:36864
    ds_read_b64_tr_b16 v[58:59], v10 offset:37376
    v_mfma_f32_16x16x32_bf16 v[84:87], v[40:43], v[164:167], v[84:87]
    ds_read_b64_tr_b16 v[60:61], v10 offset:45056
    v_mfma_f32_16x16x32_bf16 v[88:91], v[44:47], v[160:163], v[88:91]
    ds_read_b64_tr_b16 v[62:63], v10 offset:45568
    v_mfma_f32_16x16x32_bf16 v[92:95], v[44:47], v[164:167], v[92:95]
    s_waitcnt vmcnt(5)
    s_setprio 3
    s_barrier
    s_add_u32 m0, s76, 16384
    s_lshl_b32 s73, s72, 7
    buffer_load_dwordx4 v1, s[32:35], s73 offen lds
    s_waitcnt lgkmcnt(0)
    v_mfma_f32_16x16x32_bf16 v[64:67], v[48:51], v[168:171], v[64:67]
    ds_read_b128 v[176:179], v5 offset:49152
    ds_read_b128 v[180:183], v6 offset:49152
    v_mfma_f32_16x16x32_bf16 v[68:71], v[48:51], v[172:175], v[68:71]
    ds_read_b64_tr_b16 v[32:33], v9 offset:49152
    v_mfma_f32_16x16x32_bf16 v[72:75], v[52:55], v[168:171], v[72:75]
    ds_read_b64_tr_b16 v[34:35], v9 offset:49664
    ds_read_b64_tr_b16 v[36:37], v9 offset:57344
    v_mfma_f32_16x16x32_bf16 v[76:79], v[52:55], v[172:175], v[76:79]
    ds_read_b64_tr_b16 v[38:39], v9 offset:57856
    v_mfma_f32_16x16x32_bf16 v[80:83], v[56:59], v[168:171], v[80:83]
    ds_read_b64_tr_b16 v[40:41], v10 offset:49152
    ds_read_b64_tr_b16 v[42:43], v10 offset:49664
    v_mfma_f32_16x16x32_bf16 v[84:87], v[56:59], v[172:175], v[84:87]
    ds_read_b64_tr_b16 v[44:45], v10 offset:57344
    v_mfma_f32_16x16x32_bf16 v[88:91], v[60:63], v[168:171], v[88:91]
    ds_read_b64_tr_b16 v[46:47], v10 offset:57856
    v_mfma_f32_16x16x32_bf16 v[92:95], v[60:63], v[172:175], v[92:95]
    s_setprio 2
    s_add_u32 m0, s76, 81920
    s_mul_i32 s74, s72, 229376
    buffer_load_dwordx4 v3, s[36:39], s74 offen lds
    s_add_u32 m0, s76, 90112
    s_add_u32 s72, s72, 1
    buffer_load_dwordx4 v3, s[40:43], s74 offen lds
    s_add_u32 m0, s76, 24576
    s_and_b32 s72, s72, 7
    buffer_load_dwordx4 v2, s[32:35], s73 offen lds
    s_waitcnt lgkmcnt(0)
    v_mfma_f32_16x16x32_bf16 v[64:67], v[32:35], v[176:179], v[64:67]
    ds_read_b128 v[184:187], v7 offset:49152
    ds_read_b128 v[188:191], v8 offset:49152
    v_mfma_f32_16x16x32_bf16 v[68:71], v[32:35], v[180:183], v[68:71]
    ds_read_b64_tr_b16 v[48:49], v9 offset:53248
    v_mfma_f32_16x16x32_bf16 v[72:75], v[36:39], v[176:179], v[72:75]
    ds_read_b64_tr_b16 v[50:51], v9 offset:53760
    ds_read_b64_tr_b16 v[52:53], v9 offset:61440
    v_mfma_f32_16x16x32_bf16 v[76:79], v[36:39], v[180:183], v[76:79]
    ds_read_b64_tr_b16 v[54:55], v9 offset:61952
    v_mfma_f32_16x16x32_bf16 v[80:83], v[40:43], v[176:179], v[80:83]
    ds_read_b64_tr_b16 v[56:57], v10 offset:53248
    ds_read_b64_tr_b16 v[58:59], v10 offset:53760
    v_mfma_f32_16x16x32_bf16 v[84:87], v[40:43], v[180:183], v[84:87]
    ds_read_b64_tr_b16 v[60:61], v10 offset:61440
    v_mfma_f32_16x16x32_bf16 v[88:91], v[44:47], v[176:179], v[88:91]
    ds_read_b64_tr_b16 v[62:63], v10 offset:61952
    v_mfma_f32_16x16x32_bf16 v[92:95], v[44:47], v[180:183], v[92:95]
    s_waitcnt vmcnt(5)
    s_setprio 3
    s_barrier
    s_add_u32 m0, s76, 32768
    s_lshl_b32 s73, s72, 7
    buffer_load_dwordx4 v1, s[32:35], s73 offen lds
    s_waitcnt lgkmcnt(0)
    v_mfma_f32_16x16x32_bf16 v[64:67], v[48:51], v[184:187], v[64:67]
    ds_read_b128 v[192:195], v5 offset:0
    ds_read_b128 v[196:199], v6 offset:0
    v_mfma_f32_16x16x32_bf16 v[68:71], v[48:51], v[188:191], v[68:71]
    ds_read_b64_tr_b16 v[32:33], v9 offset:0
    v_mfma_f32_16x16x32_bf16 v[72:75], v[52:55], v[184:187], v[72:75]
    ds_read_b64_tr_b16 v[34:35], v9 offset:512
    ds_read_b64_tr_b16 v[36:37], v9 offset:8192
    v_mfma_f32_16x16x32_bf16 v[76:79], v[52:55], v[188:191], v[76:79]
    ds_read_b64_tr_b16 v[38:39], v9 offset:8704
    v_mfma_f32_16x16x32_bf16 v[80:83], v[56:59], v[184:187], v[80:83]
    ds_read_b64_tr_b16 v[40:41], v10 offset:0
    ds_read_b64_tr_b16 v[42:43], v10 offset:512
    v_mfma_f32_16x16x32_bf16 v[84:87], v[56:59], v[188:191], v[84:87]
    ds_read_b64_tr_b16 v[44:45], v10 offset:8192
    v_mfma_f32_16x16x32_bf16 v[88:91], v[60:63], v[184:187], v[88:91]
    ds_read_b64_tr_b16 v[46:47], v10 offset:8704
    v_mfma_f32_16x16x32_bf16 v[92:95], v[60:63], v[188:191], v[92:95]
    s_setprio 2
    s_add_u32 m0, s76, 98304
    s_mul_i32 s74, s72, 229376
    buffer_load_dwordx4 v3, s[36:39], s74 offen lds
    s_add_u32 m0, s76, 106496
    s_add_u32 s72, s72, 1
    buffer_load_dwordx4 v3, s[40:43], s74 offen lds
    s_add_u32 m0, s76, 40960
    s_and_b32 s72, s72, 7
    buffer_load_dwordx4 v2, s[32:35], s73 offen lds
    s_waitcnt lgkmcnt(0)
    v_mfma_f32_16x16x32_bf16 v[64:67], v[32:35], v[192:195], v[64:67]
    ds_read_b128 v[200:203], v7 offset:0
    ds_read_b128 v[204:207], v8 offset:0
    v_mfma_f32_16x16x32_bf16 v[68:71], v[32:35], v[196:199], v[68:71]
    ds_read_b64_tr_b16 v[48:49], v9 offset:4096
    v_mfma_f32_16x16x32_bf16 v[72:75], v[36:39], v[192:195], v[72:75]
    ds_read_b64_tr_b16 v[50:51], v9 offset:4608
    ds_read_b64_tr_b16 v[52:53], v9 offset:12288
    v_mfma_f32_16x16x32_bf16 v[76:79], v[36:39], v[196:199], v[76:79]
    ds_read_b64_tr_b16 v[54:55], v9 offset:12800
    v_mfma_f32_16x16x32_bf16 v[80:83], v[40:43], v[192:195], v[80:83]
    ds_read_b64_tr_b16 v[56:57], v10 offset:4096
    ds_read_b64_tr_b16 v[58:59], v10 offset:4608
    v_mfma_f32_16x16x32_bf16 v[84:87], v[40:43], v[196:199], v[84:87]
    ds_read_b64_tr_b16 v[60:61], v10 offset:12288
    v_mfma_f32_16x16x32_bf16 v[88:91], v[44:47], v[192:195], v[88:91]
    ds_read_b64_tr_b16 v[62:63], v10 offset:12800
    v_mfma_f32_16x16x32_bf16 v[92:95], v[44:47], v[196:199], v[92:95]
    s_waitcnt vmcnt(4)
    s_setprio 3
    s_barrier
    s_add_u32 m0, s76, 49152
    s_lshl_b32 s73, s72, 7
    buffer_load_dwordx4 v1, s[32:35], s73 offen lds
    s_waitcnt lgkmcnt(0)
    v_mfma_f32_16x16x32_bf16 v[64:67], v[48:51], v[200:203], v[64:67]
    ds_read_b128 v[208:211], v5 offset:16384
    ds_read_b128 v[212:215], v6 offset:16384
    v_mfma_f32_16x16x32_bf16 v[68:71], v[48:51], v[204:207], v[68:71]
    ds_read_b64_tr_b16 v[32:33], v9 offset:16384
    v_mfma_f32_16x16x32_bf16 v[72:75], v[52:55], v[200:203], v[72:75]
    ds_read_b64_tr_b16 v[34:35], v9 offset:16896
    ds_read_b64_tr_b16 v[36:37], v9 offset:24576
    v_mfma_f32_16x16x32_bf16 v[76:79], v[52:55], v[204:207], v[76:79]
    ds_read_b64_tr_b16 v[38:39], v9 offset:25088
    v_mfma_f32_16x16x32_bf16 v[80:83], v[56:59], v[200:203], v[80:83]
    ds_read_b64_tr_b16 v[40:41], v10 offset:16384
    ds_read_b64_tr_b16 v[42:43], v10 offset:16896
    v_mfma_f32_16x16x32_bf16 v[84:87], v[56:59], v[204:207], v[84:87]
    ds_read_b64_tr_b16 v[44:45], v10 offset:24576
    v_mfma_f32_16x16x32_bf16 v[88:91], v[60:63], v[200:203], v[88:91]
    ds_read_b64_tr_b16 v[46:47], v10 offset:25088
    v_mfma_f32_16x16x32_bf16 v[92:95], v[60:63], v[204:207], v[92:95]
    s_setprio 2
    s_add_u32 m0, s76, 114688
    s_mul_i32 s74, s72, 229376
    buffer_load_dwordx4 v3, s[36:39], s74 offen lds
    s_add_u32 m0, s76, 122880
    s_add_u32 s72, s72, 1
    buffer_load_dwordx4 v3, s[40:43], s74 offen lds
    s_add_u32 m0, s76, 57344
    s_and_b32 s72, s72, 7
    buffer_load_dwordx4 v2, s[32:35], s73 offen lds
    s_waitcnt lgkmcnt(0)
    v_mfma_f32_16x16x32_bf16 v[64:67], v[32:35], v[208:211], v[64:67]
    ds_read_b128 v[216:219], v7 offset:16384
    ds_read_b128 v[220:223], v8 offset:16384
    v_mfma_f32_16x16x32_bf16 v[68:71], v[32:35], v[212:215], v[68:71]
    ds_read_b64_tr_b16 v[48:49], v9 offset:20480
    v_mfma_f32_16x16x32_bf16 v[72:75], v[36:39], v[208:211], v[72:75]
    ds_read_b64_tr_b16 v[50:51], v9 offset:20992
    ds_read_b64_tr_b16 v[52:53], v9 offset:28672
    v_mfma_f32_16x16x32_bf16 v[76:79], v[36:39], v[212:215], v[76:79]
    ds_read_b64_tr_b16 v[54:55], v9 offset:29184
    v_mfma_f32_16x16x32_bf16 v[80:83], v[40:43], v[208:211], v[80:83]
    ds_read_b64_tr_b16 v[56:57], v10 offset:20480
    ds_read_b64_tr_b16 v[58:59], v10 offset:20992
    v_mfma_f32_16x16x32_bf16 v[84:87], v[40:43], v[212:215], v[84:87]
    ds_read_b64_tr_b16 v[60:61], v10 offset:28672
    v_mfma_f32_16x16x32_bf16 v[88:91], v[44:47], v[208:211], v[88:91]
    ds_read_b64_tr_b16 v[62:63], v10 offset:29184
    v_mfma_f32_16x16x32_bf16 v[92:95], v[44:47], v[212:215], v[92:95]
    s_waitcnt vmcnt(4)
    s_setprio 3
    s_barrier
    s_add_u32 m0, s76, 65536
    s_mul_i32 s74, s72, 229376
    buffer_load_dwordx4 v27, s[36:39], s74 offen lds
    s_waitcnt lgkmcnt(0)
    v_mfma_f32_16x16x32_bf16 v[64:67], v[48:51], v[216:219], v[64:67]
    ds_read_b128 v[224:227], v5 offset:32768
    ds_read_b128 v[228:231], v6 offset:32768
    v_mfma_f32_16x16x32_bf16 v[68:71], v[48:51], v[220:223], v[68:71]
    ds_read_b64_tr_b16 v[32:33], v9 offset:32768
    v_mfma_f32_16x16x32_bf16 v[72:75], v[52:55], v[216:219], v[72:75]
    ds_read_b64_tr_b16 v[34:35], v9 offset:33280
    ds_read_b64_tr_b16 v[36:37], v9 offset:40960
    v_mfma_f32_16x16x32_bf16 v[76:79], v[52:55], v[220:223], v[76:79]
    ds_read_b64_tr_b16 v[38:39], v9 offset:41472
    v_mfma_f32_16x16x32_bf16 v[80:83], v[56:59], v[216:219], v[80:83]
    ds_read_b64_tr_b16 v[40:41], v10 offset:32768
    ds_read_b64_tr_b16 v[42:43], v10 offset:33280
    v_mfma_f32_16x16x32_bf16 v[84:87], v[56:59], v[220:223], v[84:87]
    ds_read_b64_tr_b16 v[44:45], v10 offset:40960
    v_mfma_f32_16x16x32_bf16 v[88:91], v[60:63], v[216:219], v[88:91]
    ds_read_b64_tr_b16 v[46:47], v10 offset:41472
    v_mfma_f32_16x16x32_bf16 v[92:95], v[60:63], v[220:223], v[92:95]
    s_setprio 2
    s_add_u32 m0, s76, 73728
    s_add_u32 s72, s72, 1
    s_and_b32 s72, s72, 7
    buffer_load_dwordx4 v27, s[40:43], s74 offen lds
    s_add_u32 m0, s76, 0
    s_mul_i32 s74, s72, 229376
    buffer_load_dwordx4 v27, s[36:39], s74 offen lds
    s_add_u32 m0, s76, 8192
    s_add_u32 s72, s72, 1
    s_and_b32 s72, s72, 7
    buffer_load_dwordx4 v27, s[40:43], s74 offen lds
    s_waitcnt lgkmcnt(0)
    v_mfma_f32_16x16x32_bf16 v[64:67], v[32:35], v[224:227], v[64:67]
    ds_read_b128 v[232:235], v7 offset:32768
    ds_read_b128 v[236:239], v8 offset:32768
    v_mfma_f32_16x16x32_bf16 v[68:71], v[32:35], v[228:231], v[68:71]
    ds_read_b64_tr_b16 v[48:49], v9 offset:36864
    v_mfma_f32_16x16x32_bf16 v[72:75], v[36:39], v[224:227], v[72:75]
    ds_read_b64_tr_b16 v[50:51], v9 offset:37376
    ds_read_b64_tr_b16 v[52:53], v9 offset:45056
    v_mfma_f32_16x16x32_bf16 v[76:79], v[36:39], v[228:231], v[76:79]
    ds_read_b64_tr_b16 v[54:55], v9 offset:45568
    v_mfma_f32_16x16x32_bf16 v[80:83], v[40:43], v[224:227], v[80:83]
    ds_read_b64_tr_b16 v[56:57], v10 offset:36864
    ds_read_b64_tr_b16 v[58:59], v10 offset:37376
    v_mfma_f32_16x16x32_bf16 v[84:87], v[40:43], v[228:231], v[84:87]
    ds_read_b64_tr_b16 v[60:61], v10 offset:45056
    v_mfma_f32_16x16x32_bf16 v[88:91], v[44:47], v[224:227], v[88:91]
    ds_read_b64_tr_b16 v[62:63], v10 offset:45568
    v_mfma_f32_16x16x32_bf16 v[92:95], v[44:47], v[228:231], v[92:95]
    s_waitcnt vmcnt(4)
    s_setprio 3
    s_barrier
    s_add_u32 m0, s76, 81920
    s_mul_i32 s74, s72, 229376
    buffer_load_dwordx4 v27, s[36:39], s74 offen lds
    s_waitcnt lgkmcnt(0)
    v_mfma_f32_16x16x32_bf16 v[64:67], v[48:51], v[232:235], v[64:67]
    ds_read_b128 v[240:243], v5 offset:49152
    ds_read_b128 v[244:247], v6 offset:49152
    v_mfma_f32_16x16x32_bf16 v[68:71], v[48:51], v[236:239], v[68:71]
    ds_read_b64_tr_b16 v[32:33], v9 offset:49152
    v_mfma_f32_16x16x32_bf16 v[72:75], v[52:55], v[232:235], v[72:75]
    ds_read_b64_tr_b16 v[34:35], v9 offset:49664
    ds_read_b64_tr_b16 v[36:37], v9 offset:57344
    v_mfma_f32_16x16x32_bf16 v[76:79], v[52:55], v[236:239], v[76:79]
    ds_read_b64_tr_b16 v[38:39], v9 offset:57856
    v_mfma_f32_16x16x32_bf16 v[80:83], v[56:59], v[232:235], v[80:83]
    ds_read_b64_tr_b16 v[40:41], v10 offset:49152
    ds_read_b64_tr_b16 v[42:43], v10 offset:49664
    v_mfma_f32_16x16x32_bf16 v[84:87], v[56:59], v[236:239], v[84:87]
    ds_read_b64_tr_b16 v[44:45], v10 offset:57344
    v_mfma_f32_16x16x32_bf16 v[88:91], v[60:63], v[232:235], v[88:91]
    ds_read_b64_tr_b16 v[46:47], v10 offset:57856
    v_mfma_f32_16x16x32_bf16 v[92:95], v[60:63], v[236:239], v[92:95]
    s_setprio 2
    s_add_u32 m0, s76, 90112
    s_add_u32 s72, s72, 1
    s_and_b32 s72, s72, 7
    buffer_load_dwordx4 v27, s[40:43], s74 offen lds
    s_add_u32 m0, s76, 16384
    s_mul_i32 s74, s72, 229376
    buffer_load_dwordx4 v27, s[36:39], s74 offen lds
    s_add_u32 m0, s76, 24576
    s_add_u32 s72, s72, 1
    s_and_b32 s72, s72, 7
    buffer_load_dwordx4 v27, s[40:43], s74 offen lds
    s_waitcnt lgkmcnt(0)
    v_mfma_f32_16x16x32_bf16 v[64:67], v[32:35], v[240:243], v[64:67]
    ds_read_b128 v[248:251], v7 offset:49152
    ds_read_b128 v[252:255], v8 offset:49152
    v_mfma_f32_16x16x32_bf16 v[68:71], v[32:35], v[244:247], v[68:71]
    ds_read_b64_tr_b16 v[48:49], v9 offset:53248
    v_mfma_f32_16x16x32_bf16 v[72:75], v[36:39], v[240:243], v[72:75]
    ds_read_b64_tr_b16 v[50:51], v9 offset:53760
    ds_read_b64_tr_b16 v[52:53], v9 offset:61440
    v_mfma_f32_16x16x32_bf16 v[76:79], v[36:39], v[244:247], v[76:79]
    ds_read_b64_tr_b16 v[54:55], v9 offset:61952
    v_mfma_f32_16x16x32_bf16 v[80:83], v[40:43], v[240:243], v[80:83]
    ds_read_b64_tr_b16 v[56:57], v10 offset:53248
    ds_read_b64_tr_b16 v[58:59], v10 offset:53760
    v_mfma_f32_16x16x32_bf16 v[84:87], v[40:43], v[244:247], v[84:87]
    ds_read_b64_tr_b16 v[60:61], v10 offset:61440
    v_mfma_f32_16x16x32_bf16 v[88:91], v[44:47], v[240:243], v[88:91]
    ds_read_b64_tr_b16 v[62:63], v10 offset:61952
    v_mfma_f32_16x16x32_bf16 v[92:95], v[44:47], v[244:247], v[92:95]
    s_setprio 1
    v_subrev_u32 v5, 65536, v9
    v_subrev_u32 v6, 65536, v10
    v_add_u32 v7, 65536, v9
    v_add_u32 v8, 65536, v10
    s_waitcnt lgkmcnt(0)
    v_mfma_f32_16x16x32_bf16 v[64:67], v[48:51], v[248:251], v[64:67]
    v_mfma_f32_16x16x32_bf16 v[68:71], v[48:51], v[252:255], v[68:71]
    v_mfma_f32_16x16x32_bf16 v[72:75], v[52:55], v[248:251], v[72:75]
    v_mfma_f32_16x16x32_bf16 v[76:79], v[52:55], v[252:255], v[76:79]
    v_mfma_f32_16x16x32_bf16 v[80:83], v[56:59], v[248:251], v[80:83]
    v_mfma_f32_16x16x32_bf16 v[84:87], v[56:59], v[252:255], v[84:87]
    v_mfma_f32_16x16x32_bf16 v[88:91], v[60:63], v[248:251], v[88:91]
    v_mfma_f32_16x16x32_bf16 v[92:95], v[60:63], v[252:255], v[92:95]
    s_setprio 0
    v_mul_f32 v18, v64, v64
    v_mul_f32 v19, v65, v65
    v_fma_f32 v18, v18, s96, v16
    v_fma_f32 v19, v19, s96, v16
    v_mul_f32 v18, v18, v64
    v_mul_f32 v19, v19, v65
    v_exp_f32 v18, v18
    v_exp_f32 v19, v19
    v_mul_f32 v64, v64, v72
    v_add_f32 v18, 1.0, v18
    v_add_f32 v19, 1.0, v19
    v_rcp_f32 v18, v18
    v_rcp_f32 v19, v19
    v_mul_f32 v65, v65, v73
    v_mul_f32 v64, v64, v18
    v_mul_f32 v65, v65, v19
    v_cvt_pk_bf16_f32 v64, v64, v65
    s_waitcnt vmcnt(4)
    s_setprio 3
    s_barrier
    ds_read_b64_tr_b16 v[32:33], v9 offset:0
    ds_read_b64_tr_b16 v[34:35], v9 offset:512
    ds_read_b64_tr_b16 v[36:37], v9 offset:4096
    ds_read_b64_tr_b16 v[38:39], v9 offset:4608
    ds_read_b64_tr_b16 v[40:41], v5 offset:0
    ds_read_b64_tr_b16 v[42:43], v5 offset:512
    ds_read_b64_tr_b16 v[44:45], v5 offset:4096
    ds_read_b64_tr_b16 v[46:47], v5 offset:4608
    s_add_u32 m0, s76, 98304
    s_mul_i32 s74, s72, 229376
    buffer_load_dwordx4 v27, s[36:39], s74 offen lds
    s_add_u32 m0, s76, 106496
    s_add_u32 s72, s72, 1
    s_and_b32 s72, s72, 7
    buffer_load_dwordx4 v27, s[40:43], s74 offen lds
    v_mul_f32 v18, v66, v66
    v_mul_f32 v19, v67, v67
    v_fma_f32 v18, v18, s96, v16
    v_fma_f32 v19, v19, s96, v16
    v_mul_f32 v18, v18, v66
    v_mul_f32 v19, v19, v67
    v_exp_f32 v18, v18
    v_exp_f32 v19, v19
    v_mul_f32 v66, v66, v74
    v_add_f32 v18, 1.0, v18
    s_waitcnt lgkmcnt(0)
    v_mfma_f32_16x16x32_bf16 v[96:99], v[32:35], v[128:131], 0
    ds_read_b64_tr_b16 v[48:49], v9 offset:8192
    ds_read_b64_tr_b16 v[50:51], v9 offset:8704
    v_mfma_f32_16x16x32_bf16 v[96:99], v[36:39], v[136:139], v[96:99]
    ds_read_b64_tr_b16 v[52:53], v9 offset:12288
    v_mfma_f32_16x16x32_bf16 v[96:99], v[40:43], v[144:147], v[96:99]
    ds_read_b64_tr_b16 v[54:55], v9 offset:12800
    v_mfma_f32_16x16x32_bf16 v[96:99], v[44:47], v[152:155], v[96:99]
    ds_read_b64_tr_b16 v[56:57], v5 offset:8192
    v_mfma_f32_16x16x32_bf16 v[100:103], v[32:35], v[132:135], 0
    ds_read_b64_tr_b16 v[58:59], v5 offset:8704
    v_mfma_f32_16x16x32_bf16 v[100:103], v[36:39], v[140:143], v[100:103]
    ds_read_b64_tr_b16 v[60:61], v5 offset:12288
    v_mfma_f32_16x16x32_bf16 v[100:103], v[40:43], v[148:151], v[100:103]
    ds_read_b64_tr_b16 v[62:63], v5 offset:12800
    v_mfma_f32_16x16x32_bf16 v[100:103], v[44:47], v[156:159], v[100:103]
    s_setprio 2
    s_add_u32 m0, s76, 32768
    s_mul_i32 s74, s72, 229376
    buffer_load_dwordx4 v27, s[36:39], s74 offen lds
    s_add_u32 m0, s76, 40960
    s_add_u32 s72, s72, 1
    s_and_b32 s72, s72, 7
    buffer_load_dwordx4 v27, s[40:43], s74 offen lds
    v_add_f32 v19, 1.0, v19
    v_rcp_f32 v18, v18
    v_rcp_f32 v19, v19
    v_mul_f32 v67, v67, v75
    v_mul_f32 v66, v66, v18
    v_mul_f32 v67, v67, v19
    v_cvt_pk_bf16_f32 v65, v66, v67
    v_mul_f32 v18, v68, v68
    v_mul_f32 v19, v69, v69
    v_fma_f32 v18, v18, s96, v16
    s_waitcnt lgkmcnt(0)
    v_mfma_f32_16x16x32_bf16 v[104:107], v[48:51], v[128:131], 0
    ds_read_b64_tr_b16 v[32:33], v10 offset:0
    ds_read_b64_tr_b16 v[34:35], v10 offset:512
    v_mfma_f32_16x16x32_bf16 v[104:107], v[52:55], v[136:139], v[104:107]
    ds_read_b64_tr_b16 v[36:37], v10 offset:4096
    v_mfma_f32_16x16x32_bf16 v[104:107], v[56:59], v[144:147], v[104:107]
    ds_read_b64_tr_b16 v[38:39], v10 offset:4608
    v_mfma_f32_16x16x32_bf16 v[104:107], v[60:63], v[152:155], v[104:107]
    ds_read_b64_tr_b16 v[40:41], v6 offset:0
    v_mfma_f32_16x16x32_bf16 v[108:111], v[48:51], v[132:135], 0
    ds_read_b64_tr_b16 v[42:43], v6 offset:512
    v_mfma_f32_16x16x32_bf16 v[108:111], v[52:55], v[140:143], v[108:111]
    ds_read_b64_tr_b16 v[44:45], v6 offset:4096
    v_mfma_f32_16x16x32_bf16 v[108:111], v[56:59], v[148:151], v[108:111]
    ds_read_b64_tr_b16 v[46:47], v6 offset:4608
    v_mfma_f32_16x16x32_bf16 v[108:111], v[60:63], v[156:159], v[108:111]
    s_setprio 1
    s_add_u32 m0, s76, 131072
    s_mul_i32 s74, s72, 229376
    buffer_load_dwordx4 v27, s[36:39], s74 offen lds
    s_add_u32 m0, s76, 139264
    s_add_u32 s72, s72, 1
    s_and_b32 s72, s72, 7
    buffer_load_dwordx4 v27, s[40:43], s74 offen lds
    s_add_u32 m0, s76, 147456
    s_mul_i32 s74, s72, 229376
    buffer_load_dwordx4 v27, s[36:39], s74 offen lds
    s_cmp_lg_u32 s68, 0
    s_cbranch_scc1 L_nos0lC
    buffer_load_dword v28, v17, s[56:59], 0 offen sc1
L_nos0lC:
    s_add_u32 m0, s76, 155648
    s_add_u32 s72, s72, 1
    s_and_b32 s72, s72, 7
    buffer_load_dwordx4 v27, s[40:43], s74 offen lds
    v_fma_f32 v19, v19, s96, v16
    v_mul_f32 v18, v18, v68
    v_mul_f32 v19, v19, v69
    v_exp_f32 v18, v18
    v_exp_f32 v19, v19
    v_mul_f32 v68, v68, v76
    v_add_f32 v18, 1.0, v18
    v_add_f32 v19, 1.0, v19
    v_rcp_f32 v18, v18
    v_rcp_f32 v19, v19
    s_waitcnt lgkmcnt(0)
    v_mfma_f32_16x16x32_bf16 v[112:115], v[32:35], v[128:131], 0
    ds_read_b64_tr_b16 v[48:49], v10 offset:8192
    ds_read_b64_tr_b16 v[50:51], v10 offset:8704
    v_mfma_f32_16x16x32_bf16 v[112:115], v[36:39], v[136:139], v[112:115]
    ds_read_b64_tr_b16 v[52:53], v10 offset:12288
    v_mfma_f32_16x16x32_bf16 v[112:115], v[40:43], v[144:147], v[112:115]
    ds_read_b64_tr_b16 v[54:55], v10 offset:12800
    v_mfma_f32_16x16x32_bf16 v[112:115], v[44:47], v[152:155], v[112:115]
    ds_read_b64_tr_b16 v[56:57], v6 offset:8192
    v_mfma_f32_16x16x32_bf16 v[116:119], v[32:35], v[132:135], 0
    ds_read_b64_tr_b16 v[58:59], v6 offset:8704
    v_mfma_f32_16x16x32_bf16 v[116:119], v[36:39], v[140:143], v[116:119]
    ds_read_b64_tr_b16 v[60:61], v6 offset:12288
    v_mfma_f32_16x16x32_bf16 v[116:119], v[40:43], v[148:151], v[116:119]
    ds_read_b64_tr_b16 v[62:63], v6 offset:12800
    v_mfma_f32_16x16x32_bf16 v[116:119], v[44:47], v[156:159], v[116:119]
    s_waitcnt vmcnt(8)
    s_setprio 3
    s_barrier
    s_waitcnt lgkmcnt(0)
    v_mfma_f32_16x16x32_bf16 v[120:123], v[48:51], v[128:131], 0
    ds_read_b64_tr_b16 v[32:33], v9 offset:16384
    ds_read_b64_tr_b16 v[34:35], v9 offset:16896
    v_mfma_f32_16x16x32_bf16 v[120:123], v[52:55], v[136:139], v[120:123]
    ds_read_b64_tr_b16 v[36:37], v9 offset:20480
    v_mfma_f32_16x16x32_bf16 v[120:123], v[56:59], v[144:147], v[120:123]
    ds_read_b64_tr_b16 v[38:39], v9 offset:20992
    v_mfma_f32_16x16x32_bf16 v[120:123], v[60:63], v[152:155], v[120:123]
    ds_read_b64_tr_b16 v[40:41], v5 offset:16384
    v_mfma_f32_16x16x32_bf16 v[124:127], v[48:51], v[132:135], 0
    ds_read_b64_tr_b16 v[42:43], v5 offset:16896
    v_mfma_f32_16x16x32_bf16 v[124:127], v[52:55], v[140:143], v[124:127]
    ds_read_b64_tr_b16 v[44:45], v5 offset:20480
    v_mfma_f32_16x16x32_bf16 v[124:127], v[56:59], v[148:151], v[124:127]
    ds_read_b64_tr_b16 v[46:47], v5 offset:20992
    v_mfma_f32_16x16x32_bf16 v[124:127], v[60:63], v[156:159], v[124:127]
    s_setprio 2
    v_mul_f32 v69, v69, v77
    v_mul_f32 v68, v68, v18
    v_mul_f32 v69, v69, v19
    v_cvt_pk_bf16_f32 v66, v68, v69
    v_mul_f32 v18, v70, v70
    v_mul_f32 v19, v71, v71
    v_fma_f32 v18, v18, s96, v16
    v_fma_f32 v19, v19, s96, v16
    v_mul_f32 v18, v18, v70
    v_mul_f32 v19, v19, v71
    v_exp_f32 v18, v18
    v_and_b32 v152, 31, v15
    v_lshlrev_b32 v152, 2, v152
    v_mov_b32 v154, 0xdddddddd
    v_mov_b32 v141, 0x3f803f80
    s_waitcnt lgkmcnt(0)
    v_mfma_f32_16x16x32_bf16 v[96:99], v[32:35], v[160:163], v[96:99]
    ds_read_b64_tr_b16 v[48:49], v9 offset:24576
    ds_read_b64_tr_b16 v[50:51], v9 offset:25088
    v_mfma_f32_16x16x32_bf16 v[96:99], v[36:39], v[168:171], v[96:99]
    ds_read_b64_tr_b16 v[52:53], v9 offset:28672
    v_mfma_f32_16x16x32_bf16 v[96:99], v[40:43], v[176:179], v[96:99]
    ds_read_b64_tr_b16 v[54:55], v9 offset:29184
    v_mfma_f32_16x16x32_bf16 v[96:99], v[44:47], v[184:187], v[96:99]
    ds_read_b64_tr_b16 v[56:57], v5 offset:24576
    v_mfma_f32_16x16x32_bf16 v[100:103], v[44:47], v[188:191], v[100:103]
    ds_read_b64_tr_b16 v[58:59], v5 offset:25088
    v_mfma_f32_16x16x32_bf16 v[100:103], v[40:43], v[180:183], v[100:103]
    ds_read_b64_tr_b16 v[60:61], v5 offset:28672
    v_mfma_f32_16x16x32_bf16 v[100:103], v[36:39], v[172:175], v[100:103]
    ds_read_b64_tr_b16 v[62:63], v5 offset:29184
    v_mfma_f32_16x16x32_bf16 v[100:103], v[32:35], v[164:167], v[100:103]
    s_setprio 1
    buffer_load_dword v11, v11, s[48:51], 0 offen
    v_exp_f32 v19, v19
    v_mul_f32 v70, v70, v78
    v_add_f32 v18, 1.0, v18
    v_add_f32 v19, 1.0, v19
    v_rcp_f32 v18, v18
    v_rcp_f32 v19, v19
    v_mul_f32 v71, v71, v79
    v_mul_f32 v70, v70, v18
    v_mul_f32 v71, v71, v19
    v_cvt_pk_bf16_f32 v67, v70, v71
    s_mov_b32 vcc_lo, 0x22
    s_mov_b32 vcc_hi, 0x22
    v_cndmask_b32 v140, 0, v141, vcc
    v_mov_b32 v141, v140
    v_mov_b64 v[142:143], v[140:141]
    v_mov_b64 v[144:145], v[140:141]
    s_waitcnt lgkmcnt(0)
    v_mfma_f32_16x16x32_bf16 v[104:107], v[48:51], v[160:163], v[104:107]
    ds_read_b64_tr_b16 v[32:33], v10 offset:16384
    ds_read_b64_tr_b16 v[34:35], v10 offset:16896
    v_mfma_f32_16x16x32_bf16 v[104:107], v[52:55], v[168:171], v[104:107]
    ds_read_b64_tr_b16 v[36:37], v10 offset:20480
    v_mfma_f32_16x16x32_bf16 v[104:107], v[56:59], v[176:179], v[104:107]
    ds_read_b64_tr_b16 v[38:39], v10 offset:20992
    v_mfma_f32_16x16x32_bf16 v[104:107], v[60:63], v[184:187], v[104:107]
    ds_read_b64_tr_b16 v[40:41], v6 offset:16384
    v_mfma_f32_16x16x32_bf16 v[108:111], v[60:63], v[188:191], v[108:111]
    ds_read_b64_tr_b16 v[42:43], v6 offset:16896
    v_mfma_f32_16x16x32_bf16 v[108:111], v[56:59], v[180:183], v[108:111]
    ds_read_b64_tr_b16 v[44:45], v6 offset:20480
    v_mfma_f32_16x16x32_bf16 v[108:111], v[52:55], v[172:175], v[108:111]
    ds_read_b64_tr_b16 v[46:47], v6 offset:20992
    v_mfma_f32_16x16x32_bf16 v[108:111], v[48:51], v[164:167], v[108:111]
    s_setprio 0
    v_permlane16_swap_b32 v64, v66
    v_permlane16_swap_b32 v65, v67
    v_mul_f32 v18, v80, v80
    v_mul_f32 v19, v81, v81
    v_fma_f32 v18, v18, s96, v16
    v_fma_f32 v19, v19, s96, v16
    v_mul_f32 v18, v18, v80
    v_mul_f32 v19, v19, v81
    v_exp_f32 v18, v18
    v_exp_f32 v19, v19
    v_mov_b64 v[146:147], v[140:141]
    v_mov_b64 v[148:149], v[140:141]
    v_mov_b64 v[150:151], v[140:141]
    s_waitcnt lgkmcnt(0)
    v_mfma_f32_16x16x32_bf16 v[112:115], v[32:35], v[160:163], v[112:115]
    ds_read_b64_tr_b16 v[48:49], v10 offset:24576
    ds_read_b64_tr_b16 v[50:51], v10 offset:25088
    v_mfma_f32_16x16x32_bf16 v[112:115], v[36:39], v[168:171], v[112:115]
    ds_read_b64_tr_b16 v[52:53], v10 offset:28672
    v_mfma_f32_16x16x32_bf16 v[112:115], v[40:43], v[176:179], v[112:115]
    ds_read_b64_tr_b16 v[54:55], v10 offset:29184
    v_mfma_f32_16x16x32_bf16 v[112:115], v[44:47], v[184:187], v[112:115]
    ds_read_b64_tr_b16 v[56:57], v6 offset:24576
    v_mfma_f32_16x16x32_bf16 v[116:119], v[44:47], v[188:191], v[116:119]
    ds_read_b64_tr_b16 v[58:59], v6 offset:25088
    v_mfma_f32_16x16x32_bf16 v[116:119], v[40:43], v[180:183], v[116:119]
    ds_read_b64_tr_b16 v[60:61], v6 offset:28672
    v_mfma_f32_16x16x32_bf16 v[116:119], v[36:39], v[172:175], v[116:119]
    ds_read_b64_tr_b16 v[62:63], v6 offset:29184
    v_mfma_f32_16x16x32_bf16 v[116:119], v[32:35], v[164:167], v[116:119]
    s_waitcnt vmcnt(1)
    s_setprio 3
    s_barrier
    s_waitcnt lgkmcnt(0)
    v_mfma_f32_16x16x32_bf16 v[120:123], v[48:51], v[160:163], v[120:123]
    ds_read_b64_tr_b16 v[32:33], v9 offset:32768
    ds_read_b64_tr_b16 v[34:35], v9 offset:33280
    v_mfma_f32_16x16x32_bf16 v[120:123], v[52:55], v[168:171], v[120:123]
    ds_read_b64_tr_b16 v[36:37], v9 offset:36864
    v_mfma_f32_16x16x32_bf16 v[120:123], v[56:59], v[176:179], v[120:123]
    ds_read_b64_tr_b16 v[38:39], v9 offset:37376
    v_mfma_f32_16x16x32_bf16 v[120:123], v[60:63], v[184:187], v[120:123]
    ds_read_b64_tr_b16 v[40:41], v5 offset:32768
    v_mfma_f32_16x16x32_bf16 v[124:127], v[60:63], v[188:191], v[124:127]
    ds_read_b64_tr_b16 v[42:43], v5 offset:33280
    v_mfma_f32_16x16x32_bf16 v[124:127], v[56:59], v[180:183], v[124:127]
    ds_read_b64_tr_b16 v[44:45], v5 offset:36864
    v_mfma_f32_16x16x32_bf16 v[124:127], v[52:55], v[172:175], v[124:127]
    ds_read_b64_tr_b16 v[46:47], v5 offset:37376
    v_mfma_f32_16x16x32_bf16 v[124:127], v[48:51], v[164:167], v[124:127]
    s_setprio 2
    v_mul_f32 v80, v80, v88
    v_add_f32 v18, 1.0, v18
    v_add_f32 v19, 1.0, v19
    v_rcp_f32 v18, v18
    v_rcp_f32 v19, v19
    v_mul_f32 v81, v81, v89
    v_mul_f32 v80, v80, v18
    v_mul_f32 v81, v81, v19
    v_cvt_pk_bf16_f32 v80, v80, v81
    v_mul_f32 v18, v82, v82
    s_add_u32 s82, s0, 0
    buffer_store_dwordx4 v[64:67], v4, s[52:55], s82 offen sc1
    v_add_u32 v159, s100, v31
    v_xor_b32 v160, 64, v159
    v_add_u32 v158, 7168, v0
    v_add_u32 v161, s89, v14
    v_xor_b32 v162, 0x400, v161
    s_waitcnt lgkmcnt(0)
    v_mfma_f32_16x16x32_bf16 v[96:99], v[32:35], v[192:195], v[96:99]
    ds_read_b64_tr_b16 v[48:49], v9 offset:40960
    ds_read_b64_tr_b16 v[50:51], v9 offset:41472
    v_mfma_f32_16x16x32_bf16 v[96:99], v[36:39], v[200:203], v[96:99]
    ds_read_b64_tr_b16 v[52:53], v9 offset:45056
    v_mfma_f32_16x16x32_bf16 v[96:99], v[40:43], v[208:211], v[96:99]
    ds_read_b64_tr_b16 v[54:55], v9 offset:45568
    v_mfma_f32_16x16x32_bf16 v[96:99], v[44:47], v[216:219], v[96:99]
    ds_read_b64_tr_b16 v[56:57], v5 offset:40960
    v_mfma_f32_16x16x32_bf16 v[100:103], v[44:47], v[220:223], v[100:103]
    ds_read_b64_tr_b16 v[58:59], v5 offset:41472
    v_mfma_f32_16x16x32_bf16 v[100:103], v[40:43], v[212:215], v[100:103]
    ds_read_b64_tr_b16 v[60:61], v5 offset:45056
    v_mfma_f32_16x16x32_bf16 v[100:103], v[36:39], v[204:207], v[100:103]
    ds_read_b64_tr_b16 v[62:63], v5 offset:45568
    v_mfma_f32_16x16x32_bf16 v[100:103], v[32:35], v[196:199], v[100:103]
    s_setprio 1
    v_mul_f32 v19, v83, v83
    v_fma_f32 v18, v18, s96, v16
    v_fma_f32 v19, v19, s96, v16
    v_mul_f32 v18, v18, v82
    v_mul_f32 v19, v19, v83
    v_exp_f32 v18, v18
    v_exp_f32 v19, v19
    v_mul_f32 v82, v82, v90
    v_add_f32 v18, 1.0, v18
    v_add_f32 v19, 1.0, v19
    v_rcp_f32 v18, v18
    v_lshlrev_b32 v163, 7, v15
    v_mov_b32 v168, 1
    v_lshl_add_u32 v171, v15, 2, s86
    v_lshl_add_u32 v172, v15, 2, s87
    s_waitcnt lgkmcnt(0)
    v_mfma_f32_16x16x32_bf16 v[104:107], v[48:51], v[192:195], v[104:107]
    ds_read_b64_tr_b16 v[32:33], v10 offset:32768
    ds_read_b64_tr_b16 v[34:35], v10 offset:33280
    v_mfma_f32_16x16x32_bf16 v[104:107], v[52:55], v[200:203], v[104:107]
    ds_read_b64_tr_b16 v[36:37], v10 offset:36864
    v_mfma_f32_16x16x32_bf16 v[104:107], v[56:59], v[208:211], v[104:107]
    ds_read_b64_tr_b16 v[38:39], v10 offset:37376
    v_mfma_f32_16x16x32_bf16 v[104:107], v[60:63], v[216:219], v[104:107]
    ds_read_b64_tr_b16 v[40:41], v6 offset:32768
    v_mfma_f32_16x16x32_bf16 v[108:111], v[60:63], v[220:223], v[108:111]
    ds_read_b64_tr_b16 v[42:43], v6 offset:33280
    v_mfma_f32_16x16x32_bf16 v[108:111], v[56:59], v[212:215], v[108:111]
    ds_read_b64_tr_b16 v[44:45], v6 offset:36864
    v_mfma_f32_16x16x32_bf16 v[108:111], v[52:55], v[204:207], v[108:111]
    ds_read_b64_tr_b16 v[46:47], v6 offset:37376
    v_mfma_f32_16x16x32_bf16 v[108:111], v[48:51], v[196:199], v[108:111]
    s_setprio 0
    v_rcp_f32 v19, v19
    v_mul_f32 v83, v83, v91
    v_mul_f32 v82, v82, v18
    v_mul_f32 v83, v83, v19
    v_cvt_pk_bf16_f32 v81, v82, v83
    v_mul_f32 v18, v84, v84
    v_mul_f32 v19, v85, v85
    v_fma_f32 v18, v18, s96, v16
    v_fma_f32 v19, v19, s96, v16
    v_mul_f32 v18, v18, v84
    v_mov_b64 v[176:177], 0
    v_mov_b64 v[178:179], 0
    v_mov_b64 v[180:181], 0
    v_mov_b64 v[182:183], 0
    s_waitcnt lgkmcnt(0)
    v_mfma_f32_16x16x32_bf16 v[112:115], v[32:35], v[192:195], v[112:115]
    ds_read_b64_tr_b16 v[48:49], v10 offset:40960
    ds_read_b64_tr_b16 v[50:51], v10 offset:41472
    v_mfma_f32_16x16x32_bf16 v[112:115], v[36:39], v[200:203], v[112:115]
    ds_read_b64_tr_b16 v[52:53], v10 offset:45056
    v_mfma_f32_16x16x32_bf16 v[112:115], v[40:43], v[208:211], v[112:115]
    ds_read_b64_tr_b16 v[54:55], v10 offset:45568
    v_mfma_f32_16x16x32_bf16 v[112:115], v[44:47], v[216:219], v[112:115]
    ds_read_b64_tr_b16 v[56:57], v6 offset:40960
    v_mfma_f32_16x16x32_bf16 v[116:119], v[44:47], v[220:223], v[116:119]
    ds_read_b64_tr_b16 v[58:59], v6 offset:41472
    v_mfma_f32_16x16x32_bf16 v[116:119], v[40:43], v[212:215], v[116:119]
    ds_read_b64_tr_b16 v[60:61], v6 offset:45056
    v_mfma_f32_16x16x32_bf16 v[116:119], v[36:39], v[204:207], v[116:119]
    ds_read_b64_tr_b16 v[62:63], v6 offset:45568
    v_mfma_f32_16x16x32_bf16 v[116:119], v[32:35], v[196:199], v[116:119]
    s_setprio 3
    s_barrier
    s_waitcnt lgkmcnt(0)
    v_mfma_f32_16x16x32_bf16 v[120:123], v[48:51], v[192:195], v[120:123]
    ds_read_b64_tr_b16 v[32:33], v7 offset:0
    ds_read_b64_tr_b16 v[34:35], v7 offset:512
    v_mfma_f32_16x16x32_bf16 v[120:123], v[52:55], v[200:203], v[120:123]
    ds_read_b64_tr_b16 v[36:37], v7 offset:4096
    v_mfma_f32_16x16x32_bf16 v[120:123], v[56:59], v[208:211], v[120:123]
    ds_read_b64_tr_b16 v[38:39], v7 offset:4608
    v_mfma_f32_16x16x32_bf16 v[120:123], v[60:63], v[216:219], v[120:123]
    ds_read_b64_tr_b16 v[40:41], v7 offset:16384
    v_mfma_f32_16x16x32_bf16 v[124:127], v[60:63], v[220:223], v[124:127]
    ds_read_b64_tr_b16 v[42:43], v7 offset:16896
    v_mfma_f32_16x16x32_bf16 v[124:127], v[56:59], v[212:215], v[124:127]
    ds_read_b64_tr_b16 v[44:45], v7 offset:20480
    v_mfma_f32_16x16x32_bf16 v[124:127], v[52:55], v[204:207], v[124:127]
    ds_read_b64_tr_b16 v[46:47], v7 offset:20992
    v_mfma_f32_16x16x32_bf16 v[124:127], v[48:51], v[196:199], v[124:127]
    s_setprio 2
    v_mul_f32 v19, v19, v85
    v_exp_f32 v18, v18
    v_exp_f32 v19, v19
    v_mul_f32 v84, v84, v92
    v_add_f32 v18, 1.0, v18
    v_add_f32 v19, 1.0, v19
    v_rcp_f32 v18, v18
    v_rcp_f32 v19, v19
    v_mul_f32 v85, v85, v93
    v_mul_f32 v84, v84, v18
    v_mov_b64 v[184:185], 0
    v_mov_b64 v[186:187], 0
    v_mov_b64 v[188:189], 0
    v_mov_b64 v[190:191], 0
    s_waitcnt lgkmcnt(0)
    v_mfma_f32_16x16x32_bf16 v[96:99], v[32:35], v[224:227], v[96:99]
    ds_read_b64_tr_b16 v[48:49], v7 offset:8192
    ds_read_b64_tr_b16 v[50:51], v7 offset:8704
    v_mfma_f32_16x16x32_bf16 v[96:99], v[36:39], v[232:235], v[96:99]
    ds_read_b64_tr_b16 v[52:53], v7 offset:12288
    v_mfma_f32_16x16x32_bf16 v[96:99], v[40:43], v[240:243], v[96:99]
    ds_read_b64_tr_b16 v[54:55], v7 offset:12800
    v_mfma_f32_16x16x32_bf16 v[96:99], v[44:47], v[248:251], v[96:99]
    ds_read_b64_tr_b16 v[56:57], v7 offset:24576
    v_mfma_f32_16x16x32_bf16 v[100:103], v[44:47], v[252:255], v[100:103]
    ds_read_b64_tr_b16 v[58:59], v7 offset:25088
    v_mfma_f32_16x16x32_bf16 v[100:103], v[40:43], v[244:247], v[100:103]
    ds_read_b64_tr_b16 v[60:61], v7 offset:28672
    v_mfma_f32_16x16x32_bf16 v[100:103], v[36:39], v[236:239], v[100:103]
    ds_read_b64_tr_b16 v[62:63], v7 offset:29184
    v_mfma_f32_16x16x32_bf16 v[100:103], v[32:35], v[228:231], v[100:103]
    s_setprio 1
    v_mul_f32 v85, v85, v19
    v_cvt_pk_bf16_f32 v82, v84, v85
    v_mul_f32 v18, v86, v86
    v_mul_f32 v19, v87, v87
    v_fma_f32 v18, v18, s96, v16
    v_fma_f32 v19, v19, s96, v16
    v_mul_f32 v18, v18, v86
    v_mul_f32 v19, v19, v87
    v_exp_f32 v18, v18
    v_exp_f32 v19, v19
    v_mov_b64 v[192:193], 0
    v_mov_b64 v[194:195], 0
    v_mov_b64 v[196:197], 0
    v_mov_b64 v[198:199], 0
    s_waitcnt lgkmcnt(0)
    v_mfma_f32_16x16x32_bf16 v[104:107], v[48:51], v[224:227], v[104:107]
    ds_read_b64_tr_b16 v[32:33], v8 offset:0
    ds_read_b64_tr_b16 v[34:35], v8 offset:512
    v_mfma_f32_16x16x32_bf16 v[104:107], v[52:55], v[232:235], v[104:107]
    ds_read_b64_tr_b16 v[36:37], v8 offset:4096
    v_mfma_f32_16x16x32_bf16 v[104:107], v[56:59], v[240:243], v[104:107]
    ds_read_b64_tr_b16 v[38:39], v8 offset:4608
    v_mfma_f32_16x16x32_bf16 v[104:107], v[60:63], v[248:251], v[104:107]
    ds_read_b64_tr_b16 v[40:41], v8 offset:16384
    v_mfma_f32_16x16x32_bf16 v[108:111], v[60:63], v[252:255], v[108:111]
    ds_read_b64_tr_b16 v[42:43], v8 offset:16896
    v_mfma_f32_16x16x32_bf16 v[108:111], v[56:59], v[244:247], v[108:111]
    ds_read_b64_tr_b16 v[44:45], v8 offset:20480
    v_mfma_f32_16x16x32_bf16 v[108:111], v[52:55], v[236:239], v[108:111]
    ds_read_b64_tr_b16 v[46:47], v8 offset:20992
    v_mfma_f32_16x16x32_bf16 v[108:111], v[48:51], v[228:231], v[108:111]
    s_setprio 0
    s_cmp_lg_u32 s68, 0
    s_cbranch_scc1 L_nopoll0C
    v_cmp_eq_u32 vcc, 0, v28
    s_cbranch_vccnz L_s0retryC
L_s0doneC:
    s_mov_b32 s81, 196608
    v_lshlrev_b32 v21, 7, v15
    buffer_load_dword v20, v21, s[52:55], s81 offen sc1
L_nopoll0C:
    v_mul_f32 v86, v86, v94
    v_add_f32 v18, 1.0, v18
    v_add_f32 v19, 1.0, v19
    v_rcp_f32 v18, v18
    v_rcp_f32 v19, v19
    v_mul_f32 v87, v87, v95
    v_mul_f32 v86, v86, v18
    v_mul_f32 v87, v87, v19
    v_cvt_pk_bf16_f32 v83, v86, v87
    v_permlane16_swap_b32 v80, v82
    s_nop 0
    v_permlane16_swap_b32 v81, v83
    v_mov_b64 v[200:201], 0
    v_mov_b64 v[202:203], 0
    v_mov_b64 v[204:205], 0
    v_mov_b64 v[206:207], 0
    s_waitcnt lgkmcnt(0)
    v_mfma_f32_16x16x32_bf16 v[112:115], v[32:35], v[224:227], v[112:115]
    ds_read_b64_tr_b16 v[48:49], v8 offset:8192
    ds_read_b64_tr_b16 v[50:51], v8 offset:8704
    v_mfma_f32_16x16x32_bf16 v[112:115], v[36:39], v[232:235], v[112:115]
    ds_read_b64_tr_b16 v[52:53], v8 offset:12288
    v_mfma_f32_16x16x32_bf16 v[112:115], v[40:43], v[240:243], v[112:115]
    ds_read_b64_tr_b16 v[54:55], v8 offset:12800
    v_mfma_f32_16x16x32_bf16 v[112:115], v[44:47], v[248:251], v[112:115]
    ds_read_b64_tr_b16 v[56:57], v8 offset:24576
    v_mfma_f32_16x16x32_bf16 v[116:119], v[44:47], v[252:255], v[116:119]
    ds_read_b64_tr_b16 v[58:59], v8 offset:25088
    v_mfma_f32_16x16x32_bf16 v[116:119], v[40:43], v[244:247], v[116:119]
    ds_read_b64_tr_b16 v[60:61], v8 offset:28672
    v_mfma_f32_16x16x32_bf16 v[116:119], v[36:39], v[236:239], v[116:119]
    ds_read_b64_tr_b16 v[62:63], v8 offset:29184
    v_mfma_f32_16x16x32_bf16 v[116:119], v[32:35], v[228:231], v[116:119]
    s_waitcnt lgkmcnt(0)
    s_branch L_join
L_s0retryG:
    s_mov_b32 s81, 0
L_s0pollG:
    buffer_load_dword v28, v17, s[56:59], 0 offen sc1
    s_add_u32 s81, s81, 1
    s_waitcnt vmcnt(0)
    v_cmp_eq_u32 vcc, 0, v28
    s_cbranch_vccz L_s0doneG
    s_cmp_lt_u32 s81, 4194304
    s_cbranch_scc1 L_s0pollG
    s_branch L_s0doneG
L_s2retry:
    s_mov_b32 s81, 0
L_s2poll:
    buffer_load_dwordx4 v[164:167], v163, s[52:55], s97 offen sc1
    s_add_u32 s81, s81, 1
    s_waitcnt vmcnt(0)
    v_min3_u32 v164, v164, v165, v166
    v_min_u32 v164, v164, v167
    v_cmp_ne_u32 vcc, 1, v164
    s_cbranch_vccz L_s2done
    s_cmp_lt_u32 s81, 4194304
    s_cbranch_scc1 L_s2poll
    s_branch L_s2done
L_s0retryK:
    s_mov_b32 s81, 0
L_s0pollK:
    buffer_load_dword v28, v17, s[56:59], 0 offen sc1
    s_add_u32 s81, s81, 1
    s_waitcnt vmcnt(0)
    v_cmp_eq_u32 vcc, 0, v28
    s_cbranch_vccz L_s0doneK
    s_cmp_lt_u32 s81, 4194304
    s_cbranch_scc1 L_s0pollK
    s_branch L_s0doneK
L_s0retryV:
    s_mov_b32 s81, 0
L_s0pollV:
    buffer_load_dword v28, v17, s[56:59], 0 offen sc1
    s_add_u32 s81, s81, 1
    s_waitcnt vmcnt(0)
    v_cmp_eq_u32 vcc, 0, v28
    s_cbranch_vccz L_s0doneV
    s_cmp_lt_u32 s81, 4194304
    s_cbranch_scc1 L_s0pollV
    s_branch L_s0doneV
L_s0retryS:
    s_mov_b32 s81, 0
L_s0pollS:
    buffer_load_dword v28, v17, s[56:59], 0 offen sc1
    s_add_u32 s81, s81, 1
    s_waitcnt vmcnt(0)
    v_cmp_eq_u32 vcc, 0, v28
    s_cbranch_vccz L_s0doneS
    s_cmp_lt_u32 s81, 4194304
    s_cbranch_scc1 L_s0pollS
    s_branch L_s0doneS
L_s0retryC:
    s_mov_b32 s81, 0
L_s0pollC:
    buffer_load_dword v28, v17, s[56:59], 0 offen sc1
    s_add_u32 s81, s81, 1
    s_waitcnt vmcnt(0)
    v_cmp_eq_u32 vcc, 0, v28
    s_cbranch_vccz L_s0doneC
    s_cmp_lt_u32 s81, 4194304
    s_cbranch_scc1 L_s0pollC
    s_branch L_s0doneC
L_true_max:
    s_waitcnt vmcnt(0) lgkmcnt(0)
    v_mov_b32 v20, 0xff800000
    s_mov_b32 s80, 0
L_tm1:
    buffer_load_dwordx4 v[136:139], v14, s[52:55], s80 offen sc1
    s_waitcnt vmcnt(0)
    v_mfma_f32_32x32x16_bf16 v[208:223], v[136:139], v[132:135], 0
    s_nop 11
    v_max3_f32 v20, v20, v208, v209
    v_max3_f32 v20, v20, v210, v211
    v_max3_f32 v20, v20, v212, v213
    v_max3_f32 v20, v20, v214, v215
    v_max3_f32 v20, v20, v216, v217
    v_max3_f32 v20, v20, v218, v219
    v_max3_f32 v20, v20, v220, v221
    v_max3_f32 v20, v20, v222, v223
    s_add_u32 s80, s80, 2048
    s_cmp_lt_u32 s80, 131072
    s_cbranch_scc1 L_tm1
    v_mov_b32 v21, v20
    s_nop 1
    v_permlane32_swap_b32 v20, v21
    v_max_f32 v20, v20, v21
    v_sub_f32 v224, 0, v20
    v_mov_b32 v192, 0
    v_sub_f32 v225, 0, v20
    v_mov_b32 v193, 0
    v_sub_f32 v226, 0, v20
    v_mov_b32 v194, 0
    v_sub_f32 v227, 0, v20
    v_mov_b32 v195, 0
    v_sub_f32 v228, 0, v20
    v_mov_b32 v196, 0
    v_sub_f32 v229, 0, v20
    v_mov_b32 v197, 0
    v_sub_f32 v230, 0, v20
    v_mov_b32 v198, 0
    v_sub_f32 v231, 0, v20
    v_mov_b32 v199, 0
    v_sub_f32 v232, 0, v20
    v_mov_b32 v200, 0
    v_sub_f32 v233, 0, v20
    v_mov_b32 v201, 0
    v_sub_f32 v234, 0, v20
    v_mov_b32 v202, 0
    v_sub_f32 v235, 0, v20
    v_mov_b32 v203, 0
    v_sub_f32 v236, 0, v20
    v_mov_b32 v204, 0
    v_sub_f32 v237, 0, v20
    v_mov_b32 v205, 0
    v_sub_f32 v238, 0, v20
    v_mov_b32 v206, 0
    v_sub_f32 v239, 0, v20
    v_mov_b32 v207, 0
    s_mov_b32 s80, 0
L_tm2:
    buffer_load_dwordx4 v[136:139], v14, s[52:55], s80 offen sc1
    s_mov_b64 exec, s[88:89]
    buffer_load_dwordx4 v[144:147], v29, s[52:55], s80 offen offset:1024 sc1
    buffer_load_dwordx4 v[140:143], v29, s[52:55], s80 offen offset:1536 sc1
    s_mov_b64 exec, -1
    s_waitcnt vmcnt(0)
    v_mfma_f32_32x32x16_bf16 v[208:223], v[136:139], v[132:135], v[224:239]
    s_nop 11
    v_exp_f32 v208, v208
    v_exp_f32 v209, v209
    v_exp_f32 v210, v210
    v_exp_f32 v211, v211
    v_exp_f32 v212, v212
    v_exp_f32 v213, v213
    v_exp_f32 v214, v214
    v_exp_f32 v215, v215
    v_exp_f32 v216, v216
    v_exp_f32 v217, v217
    v_exp_f32 v218, v218
    v_exp_f32 v219, v219
    v_exp_f32 v220, v220
    v_exp_f32 v221, v221
    v_exp_f32 v222, v222
    v_exp_f32 v223, v223
    v_smfmac_f32_32x32x32_bf16 v[192:207], v[144:147], v[208:215], v154
    s_nop 0
    v_smfmac_f32_32x32x32_bf16 v[192:207], v[140:143], v[216:223], v154
    s_add_u32 s80, s80, 2048
    s_cmp_lt_u32 s80, 131072
    s_nop 7
    s_cbranch_scc1 L_tm2
    s_nop 7
    v_rcp_f32 v20, v193
    s_nop 0
    v_mul_f32 v20, v20, v152
    v_mul_f32 v192, v192, v20
    v_mul_f32 v194, v194, v20
    v_mul_f32 v196, v196, v20
    v_mul_f32 v198, v198, v20
    v_mul_f32 v200, v200, v20
    v_mul_f32 v202, v202, v20
    v_mul_f32 v204, v204, v20
    v_mul_f32 v206, v206, v20
    v_cvt_pk_bf16_f32 v128, v192, v194
    v_cvt_pk_bf16_f32 v129, v196, v198
    v_cvt_pk_bf16_f32 v130, v200, v202
    v_cvt_pk_bf16_f32 v131, v204, v206
    v_or_b32 v128, 1, v128
    s_branch L_norm
L_last:
.section .rodata,"a"
.p2align 6
.amdhsa_kernel gated_mix__grouped_kv_mqa__geglu_ffn__prompt_kernel
  .amdhsa_next_free_vgpr 256
  .amdhsa_next_free_sgpr 102
  .amdhsa_accum_offset 256
  .amdhsa_group_segment_fixed_size 0
  .amdhsa_kernarg_size 104
  .amdhsa_user_sgpr_count 2
  .amdhsa_user_sgpr_kernarg_segment_ptr 1
  .amdhsa_system_sgpr_workgroup_id_x 1
.end_amdhsa_kernel
```
